```python
import torch

def _softmax(x, axis=-1):
    return torch.softmax(x, dim=axis)
def _gelu(x):
    return torch.nn.functional.gelu(x, approximate="tanh")
def _silu(x):
    return torch.nn.functional.silu(x)
def _sigmoid(x):
    return torch.sigmoid(x)
def _layernorm(x, axis=-1, eps=1e-5):
    m = x.mean(dim=axis, keepdim=True)
    v = x.var(dim=axis, keepdim=True, unbiased=False)
    return (x - m) / torch.sqrt(v + eps)
def _scatter_add(tgt, idx, src, axis=0):
    return tgt.clone().index_add_(axis, idx, src)
def _segment_sum(src, seg, n):
    out = torch.zeros((n,) + src.shape[1:], dtype=src.dtype)
    return out.index_add_(0, seg, src)
def _pad(x, pw):
    flat = tuple(v for pair in reversed(pw) for v in pair)
    return torch.nn.functional.pad(x, flat)

kernel_name = 'standalone__mha_softmax__near_ridge'

def setup_inputs():

    _w = (lambda a: (lambda t: t.to(torch.bfloat16) if t.is_floating_point() else t)(torch.as_tensor(a)))
    B, H, Sq, Sk, D = 16, 32, 624, 624, 128
    return {
        "q": _w((lambda *s: torch.randn(*s, dtype=torch.bfloat16) * 0.8)(B, H, Sq, D)),
        "k": _w((lambda *s: torch.randn(*s, dtype=torch.bfloat16) * 0.8)(B, H, Sk, D)),
        "v": _w((lambda *s: torch.randn(*s, dtype=torch.bfloat16) * 0.05)(B, H, Sk, D)),
    }

def reference(q, k, v):
    scale = q.shape[-1] ** -0.5
    scores = torch.einsum("bhqd,bhkd->bhqk", q, k) * scale
    p = _softmax(scores, axis=-1)
    return torch.einsum("bhqk,bhkd->bhqd", p, v)
```

```asm
; @launch grid=(256,1,1) block=(256,1,1) lds=163840
.amdgcn_target "amdgcn-amd-amdhsa--gfx950"
.text
.globl standalone__mha_softmax__near_ridge_kernel
.p2align 8
.type standalone__mha_softmax__near_ridge_kernel,@function
standalone__mha_softmax__near_ridge_kernel:
  s_cmp_ge_u32 s2, 256
  s_cbranch_scc1 L_END
  s_load_dwordx4 s[4:7], s[0:1], 0
  s_load_dwordx4 s[8:11], s[0:1], 16
  s_getpc_b64 s[64:65]
  v_lshlrev_b32 v251, 7, v0
  global_load_dword a252, v251, s[64:65]
  v_lshrrev_b32 v251, 2, v251
  v_add_u32 v251, 0x8000, v251
  global_load_dword a253, v251, s[64:65]
  v_lshrrev_b32 v150, 6, v0
  v_and_b32 v151, 63, v0
  v_readfirstlane_b32 s28, v150
  s_and_b32 s46, s2, 7
  s_lshr_b32 s47, s2, 4
  s_lshl_b32 s47, s47, 3
  s_add_u32 s46, s46, s47
  s_mul_i32 s38, s46, 159744
  s_mov_b32 s41, s38
  s_bfe_u32 s46, s2, 0x10003
  s_mul_i32 s46, s46, 312
  s_add_u32 s49, s46, 312
  s_min_u32 s49, s49, 624
  s_lshl_b32 s49, s49, 8
  s_mul_i32 s48, s28, 80
  s_add_u32 s48, s48, s46
  s_lshl_b32 s48, s48, 8
  s_lshl_b32 s30, s28, 12
  s_mul_i32 s31, s28, 20480
  s_add_u32 s31, s31, 82176
  s_sub_u32 s49, s49, s48
  s_sub_u32 s50, 159744, s30
  s_mov_b32 s42, 4096
  s_mov_b32 s43, 8192
  s_mov_b32 s44, 12288
  s_mov_b32 s45, 16384
  s_mov_b32 s14, s49
  s_mov_b32 s15, 0x20000
  s_mov_b32 s18, s50
  s_mov_b32 s19, 0x20000
  s_mov_b32 s22, s50
  s_mov_b32 s23, 0x20000
  s_mov_b32 s26, 0
  s_mov_b32 s27, 0x20000
  v_lshrrev_b32 v150, 4, v151
  v_and_b32 v152, 15, v151
  v_xor_b32 v153, v150, v152
  v_lshlrev_b32 v154, 4, v153
  v_lshl_add_u32 v232, v150, 8, v154
  v_xor_b32 v233, 64, v232
  v_xor_b32 v234, 0x80, v232
  v_xor_b32 v235, 0xc0, v232
  v_lshlrev_b32 v153, 1, v150
  v_xor_b32 v153, v153, v152
  v_lshlrev_b32 v153, 4, v153
  v_lshl_add_u32 v236, v150, 8, v153
  v_xor_b32 v237, 0x80, v236
  s_waitcnt lgkmcnt(0)
  s_add_u32 s6, s6, s30
  s_addc_u32 s7, s7, 0
  s_add_u32 s16, s6, s38
  s_addc_u32 s17, s7, 0
  s_add_u32 m0, s30, 256
  s_nop 0
  buffer_load_dwordx4 v232, s[16:19], 0 offen offset:0 nt lds
  buffer_load_dwordx4 v233, s[16:19], 0 offen offset:1024 nt lds
  buffer_load_dwordx4 v234, s[16:19], 0 offen offset:2048 nt lds
  buffer_load_dwordx4 v235, s[16:19], 0 offen offset:3072 nt lds
  s_add_u32 s4, s4, s48
  s_addc_u32 s5, s5, 0
  s_add_u32 s12, s4, s38
  s_addc_u32 s13, s5, 0
  s_add_u32 m0, s31, 0
  s_nop 0
  buffer_load_dwordx4 v232, s[12:15], 0 offen offset:0 nt lds
  s_mov_b32 s54, 16384
  s_mov_b32 s55, 32768
  s_mov_b32 s56, 49152
  s_mov_b32 s57, 65536
  s_mov_b32 s58, 81920
  s_mov_b32 s59, 98304
  s_mov_b32 s60, 114688
  s_mov_b32 s61, 131072
  s_mov_b32 s62, 147456
  s_mov_b32 s32, 0
  s_mov_b32 s35, 0
  s_mov_b64 s[36:37], 0
  s_mov_b32 s33, 0x3e0293ee
  v_lshl_add_u32 v220, v152, 8, v154
  v_xor_b32 v221, 64, v220
  v_xor_b32 v222, 0x80, v220
  v_xor_b32 v223, 0xc0, v220
  v_add_u32 v240, s31, v220
  v_add_u32 v241, s31, v221
  v_add_u32 v242, s31, v222
  v_add_u32 v243, s31, v223
  v_add_u32 v220, 256, v220
  v_add_u32 v221, 256, v221
  v_add_u32 v222, 256, v222
  v_add_u32 v223, 256, v223
  v_mov_b32 v252, 0
  s_lshl_b32 s46, s28, 4
  v_mov_b32 v253, s46
  s_mov_b32 s68, 16000000
  s_mov_b32 s69, 0x23000000
  v_lshlrev_b32 v250, 4, v150
  v_lshrrev_b32 v153, 2, v151
  v_lshlrev_b32 v224, 8, v153
  v_and_b32 v153, 7, v153
  v_lshl_add_u32 v224, v153, 5, v224
  v_and_b32 v153, 3, v151
  v_lshl_add_u32 v224, v153, 3, v224
  v_add_u32 v224, 16640, v224
  v_xor_b32 v225, 32, v224
  v_xor_b32 v226, 64, v224
  v_xor_b32 v227, 96, v224
  v_xor_b32 v228, 128, v224
  v_xor_b32 v229, 160, v224
  v_xor_b32 v230, 192, v224
  v_xor_b32 v231, 224, v224
  v_lshlrev_b32 v238, 4, v151
  v_and_b32 v239, 7, v151
  v_xor_b32 v239, v239, v150
  v_lshlrev_b32 v239, 4, v239
  v_lshl_add_u32 v239, v150, 7, v239
  v_bfe_u32 v153, v151, 3, 1
  v_lshl_add_u32 v239, v153, 11, v239
  v_add_u32 v239, s31, v239
  v_xor_b32 v255, 64, v239
  v_lshrrev_b32 v153, 1, v150
  v_and_b32 v244, 7, v151
  v_xor_b32 v244, v244, v153
  v_lshlrev_b32 v244, 4, v244
  v_lshl_add_u32 v244, v152, 7, v244
  v_and_b32 v153, 1, v150
  v_lshl_add_u32 v244, v153, 3, v244
  v_add_u32 v244, s31, v244
  v_xor_b32 v245, 32, v244
  v_xor_b32 v246, 64, v244
  v_xor_b32 v247, 0x60, v244
  v_bfe_u32 v153, v151, 1, 1
  v_add_u32 v153, -1, v153
  v_and_b32 v153, 0x3f803f80, v153
  v_accvgpr_write_b32 a228, v153
  v_accvgpr_write_b32 a229, v153
  v_accvgpr_write_b32 a230, v153
  v_accvgpr_write_b32 a231, v153
  v_lshlrev_b32 v153, 2, v150
  v_sub_u32 v153, v152, v153
  v_lshrrev_b32 v154, 1, v153
  v_and_b32 v153, 1, v152
  v_lshlrev_b32 v153, 4, v153
  v_mov_b32 v140, 0x3e03
  v_mov_b32 v141, 0xb9d8
  v_lshlrev_b32 v140, v153, v140
  v_lshlrev_b32 v141, v153, v141
  v_cmp_eq_u32 vcc, 0, v154
  s_nop 1
  v_cndmask_b32 v142, 0, v140, vcc
  v_cndmask_b32 v143, 0, v141, vcc
  v_cmp_eq_u32 vcc, 1, v154
  s_nop 1
  v_cndmask_b32 v144, 0, v140, vcc
  v_cndmask_b32 v145, 0, v141, vcc
  v_accvgpr_write_b32 a248, v142
  v_accvgpr_write_b32 a249, v144
  v_accvgpr_write_b32 a250, v143
  v_accvgpr_write_b32 a251, v145
  v_and_b32 v153, 1, v151
  v_mul_u32_u24 v153, 0xaaaaaa, v153
  v_lshl_or_b32 v153, v153, 8, v153
  v_or_b32 v254, 0x44444444, v153
  v_accvgpr_write_b32 a208, 0
  v_accvgpr_write_b32 a209, 0
  v_accvgpr_write_b32 a210, 0
  v_accvgpr_write_b32 a211, 0
  v_accvgpr_write_b32 a212, 0
  v_accvgpr_write_b32 a213, 0
  v_accvgpr_write_b32 a214, 0
  v_accvgpr_write_b32 a215, 0
  v_accvgpr_write_b32 a216, 0
  v_accvgpr_write_b32 a217, 0
  v_accvgpr_write_b32 a218, 0
  v_accvgpr_write_b32 a219, 0
  v_accvgpr_write_b32 a220, 0
  v_accvgpr_write_b32 a221, 0
  v_accvgpr_write_b32 a222, 0
  v_accvgpr_write_b32 a223, 0
  v_accvgpr_write_b32 a224, 0
  v_accvgpr_write_b32 a225, 0
  v_accvgpr_write_b32 a226, 0
  v_accvgpr_write_b32 a227, 0
  buffer_load_dwordx4 v233, s[12:15], 0 offen offset:1024 nt lds
  buffer_load_dwordx4 v234, s[12:15], 0 offen offset:2048 nt lds
  buffer_load_dwordx4 v235, s[12:15], 0 offen offset:3072 nt lds
  s_add_u32 s8, s8, s30
  s_addc_u32 s9, s9, 0
  s_add_u32 s20, s8, s38
  s_addc_u32 s21, s9, 0
  s_add_u32 m0, s30, 16640
  s_nop 0
  buffer_load_dwordx4 v236, s[20:23], 0 offen offset:0  lds
  buffer_load_dwordx4 v237, s[20:23], 0 offen offset:1024  lds
  buffer_load_dwordx4 v236, s[20:23], 0 offen offset:2048  lds
  buffer_load_dwordx4 v237, s[20:23], 0 offen offset:3072  lds
  s_add_u32 m0, s31, 4096
  s_nop 0
  buffer_load_dwordx4 v232, s[12:15], s42 offen offset:0 nt lds
  buffer_load_dwordx4 v233, s[12:15], s42 offen offset:1024 nt lds
  buffer_load_dwordx4 v234, s[12:15], s42 offen offset:2048 nt lds
  buffer_load_dwordx4 v235, s[12:15], s42 offen offset:3072 nt lds
  s_add_u32 s10, s10, s48
  s_addc_u32 s11, s11, 0
  s_mov_b32 s24, s10
  s_mov_b32 s25, s11
  ds_write_b32 v253, v252
  s_waitcnt vmcnt(12) lgkmcnt(0)
  s_barrier
  ds_read_b128 a[232:235], v250 offset:256
  ds_read_b128 a[236:239], v250 offset:320
  ds_read_b128 a[80:83], v220 offset:0
  ds_read_b128 a[240:243], v250 offset:384
  ds_read_b128 a[244:247], v250 offset:448
  ds_read_b128 a[84:87], v221 offset:0
  ds_read_b128 a[92:95], v223 offset:0
  ds_read_b128 a[88:91], v222 offset:0
  ds_read_b128 a[108:111], v223 offset:4096
  ds_read_b128 a[104:107], v222 offset:4096
  ds_read_b128 a[100:103], v221 offset:4096
  ds_read_b128 a[112:115], v220 offset:8192
  ds_read_b128 a[96:99], v220 offset:4096
  ds_read_b128 a[116:119], v221 offset:8192
  ds_read_b128 a[124:127], v223 offset:8192
  ds_read_b128 a[120:123], v222 offset:8192
  ds_read_b128 a[140:143], v223 offset:12288
  ds_read_b128 a[132:135], v221 offset:12288
  ds_read_b128 a[136:139], v222 offset:12288
  ds_read_b128 a[128:131], v220 offset:12288
  s_waitcnt vmcnt(8)
  ds_read_b128 a[0:3], v240 offset:0
  ds_read_b128 a[4:7], v241 offset:0
  ds_read_b128 a[8:11], v242 offset:0
  ds_read_b128 a[12:15], v243 offset:0
  s_waitcnt lgkmcnt(3)
  v_mfma_f32_16x16x16_bf16 v[0:3], a[248:249], a[0:1], 0
  v_mfma_f32_16x16x16_bf16 v[0:3], a[250:251], a[0:1], v[0:3]
  v_mfma_f32_16x16x16_bf16 v[4:7], a[250:251], a[2:3], 0
  v_mfma_f32_16x16x16_bf16 v[4:7], a[248:249], a[2:3], v[4:7]
  s_waitcnt lgkmcnt(2)
  v_mfma_f32_16x16x16_bf16 v[8:11], a[248:249], a[4:5], 0
  s_add_u32 m0, s31, 8192
  s_nop 0
  buffer_load_dwordx4 v232, s[12:15], s43 offen offset:0 nt lds
  v_mfma_f32_16x16x16_bf16 v[8:11], a[250:251], a[4:5], v[8:11]
  v_mfma_f32_16x16x16_bf16 v[12:15], a[250:251], a[6:7], 0
  v_cvt_pk_bf16_f32 v0, v0, v1
  v_accvgpr_write_b32 a0, v0
  v_mfma_f32_16x16x16_bf16 v[12:15], a[248:249], a[6:7], v[12:15]
  v_cvt_pk_bf16_f32 v2, v2, v3
  v_accvgpr_write_b32 a1, v2
  s_waitcnt lgkmcnt(0)
  v_mfma_f32_16x16x16_bf16 v[16:19], a[248:249], a[8:9], 0
  v_cvt_pk_bf16_f32 v4, v4, v5
  v_cvt_pk_bf16_f32 v6, v6, v7
  v_mfma_f32_16x16x16_bf16 v[16:19], a[250:251], a[8:9], v[16:19]
  buffer_load_dwordx4 v233, s[12:15], s43 offen offset:1024 nt lds
  v_mfma_f32_16x16x16_bf16 v[20:23], a[250:251], a[10:11], 0
  v_accvgpr_write_b32 a2, v4
  v_cvt_pk_bf16_f32 v10, v10, v11
  v_mfma_f32_16x16x16_bf16 v[20:23], a[248:249], a[10:11], v[20:23]
  v_cvt_pk_bf16_f32 v8, v8, v9
  v_accvgpr_write_b32 a4, v8
  v_mfma_f32_16x16x16_bf16 v[24:27], a[248:249], a[12:13], 0
  v_cvt_pk_bf16_f32 v12, v12, v13
  v_cvt_pk_bf16_f32 v14, v14, v15
  v_mfma_f32_16x16x16_bf16 v[24:27], a[250:251], a[12:13], v[24:27]
  v_accvgpr_write_b32 a3, v6
  v_accvgpr_write_b32 a6, v12
  v_mfma_f32_16x16x16_bf16 v[28:31], a[250:251], a[14:15], 0
  buffer_load_dwordx4 v234, s[12:15], s43 offen offset:2048 nt lds
  v_accvgpr_write_b32 a5, v10
  v_cvt_pk_bf16_f32 v16, v16, v17
  v_mfma_f32_16x16x16_bf16 v[28:31], a[248:249], a[14:15], v[28:31]
  v_cvt_pk_bf16_f32 v18, v18, v19
  v_accvgpr_write_b32 a9, v18
  v_cvt_pk_bf16_f32 v22, v22, v23
  v_cvt_pk_bf16_f32 v24, v24, v25
  s_nop 3
  v_cvt_pk_bf16_f32 v30, v30, v31
  v_accvgpr_write_b32 a15, v30
  v_mfma_f32_16x16x32_bf16 v[192:195], a[232:235], a[0:3], 0
  v_accvgpr_write_b32 a7, v14
  v_accvgpr_write_b32 a8, v16
  v_cvt_pk_bf16_f32 v20, v20, v21
  v_cvt_pk_bf16_f32 v26, v26, v27
  v_accvgpr_write_b32 a13, v26
  v_mfma_f32_16x16x32_bf16 v[192:195], a[236:239], a[4:7], v[192:195]
  v_accvgpr_write_b32 a10, v20
  v_accvgpr_write_b32 a11, v22
  v_accvgpr_write_b32 a12, v24
  s_nop 0
  v_mfma_f32_16x16x32_bf16 v[192:195], a[240:243], a[8:11], v[192:195]
  v_cvt_pk_bf16_f32 v28, v28, v29
  v_accvgpr_write_b32 a14, v28
  s_nop 1
  v_mfma_f32_16x16x32_bf16 v[192:195], a[244:247], a[12:15], v[192:195]
  buffer_load_dwordx4 v235, s[12:15], s43 offen offset:3072 nt lds
  s_nop 6
  v_sub_f32 v192, 0xc2800000, v192
  v_sub_f32 v193, 0xc2800000, v193
  v_sub_f32 v194, 0xc2800000, v194
  v_sub_f32 v195, 0xc2800000, v195
  s_nop 1
  v_mfma_f32_16x16x32_bf16 v[160:163], a[80:83], a[0:3], v[192:195]
  v_mfma_f32_16x16x32_bf16 v[160:163], a[84:87], a[4:7], v[160:163]
  v_mfma_f32_16x16x32_bf16 v[160:163], a[88:91], a[8:11], v[160:163]
  v_mfma_f32_16x16x32_bf16 v[160:163], a[92:95], a[12:15], v[160:163]
  v_mfma_f32_16x16x32_bf16 v[164:167], a[108:111], a[12:15], v[192:195]
  s_add_u32 m0, s31, 12288
  s_nop 0
  buffer_load_dwordx4 v232, s[12:15], s44 offen offset:0 nt lds
  v_mfma_f32_16x16x32_bf16 v[164:167], a[104:107], a[8:11], v[164:167]
  v_mfma_f32_16x16x32_bf16 v[164:167], a[100:103], a[4:7], v[164:167]
  s_waitcnt vmcnt(5)
  ds_read_b128 a[16:19], v240 offset:4096
  v_mfma_f32_16x16x32_bf16 v[164:167], a[96:99], a[0:3], v[164:167]
  ds_read_b128 a[20:23], v241 offset:4096
  v_mfma_f32_16x16x32_bf16 v[168:171], a[112:115], a[0:3], v[192:195]
  v_exp_f32 v161, v161
  v_mfma_f32_16x16x32_bf16 v[168:171], a[116:119], a[4:7], v[168:171]
  buffer_load_dwordx4 v233, s[12:15], s44 offen offset:1024 nt lds
  v_mfma_f32_16x16x32_bf16 v[168:171], a[120:123], a[8:11], v[168:171]
  ds_read_b128 a[24:27], v242 offset:4096
  ds_read_b128 a[28:31], v243 offset:4096
  v_mfma_f32_16x16x32_bf16 v[168:171], a[124:127], a[12:15], v[168:171]
  v_exp_f32 v162, v162
  v_mfma_f32_16x16x32_bf16 v[172:175], a[140:143], a[12:15], v[192:195]
  v_exp_f32 v166, v166
  v_mfma_f32_16x16x32_bf16 v[172:175], a[136:139], a[8:11], v[172:175]
  v_exp_f32 v160, v160
  v_mfma_f32_16x16x32_bf16 v[172:175], a[132:135], a[4:7], v[172:175]
  buffer_load_dwordx4 v234, s[12:15], s44 offen offset:2048 nt lds
  v_mfma_f32_16x16x32_bf16 v[172:175], a[128:131], a[0:3], v[172:175]
  s_barrier
  s_waitcnt lgkmcnt(2)
  v_mfma_f32_16x16x16_bf16 v[32:35], a[248:249], a[16:17], 0
  ds_read_b64_tr_b16 a[148:149], v225 offset:0
  v_cvt_pk_bf16_f32 v160, v160, v161
  v_mfma_f32_16x16x16_bf16 v[32:35], a[250:251], a[16:17], v[32:35]
  v_exp_f32 v168, v168
  v_mfma_f32_16x16x16_bf16 v[36:39], a[250:251], a[18:19], 0
  ds_read_b64_tr_b16 a[188:189], v227 offset:8192
  ds_read_b64_tr_b16 a[166:167], v229 offset:4096
  v_mfma_f32_16x16x16_bf16 v[36:39], a[248:249], a[18:19], v[36:39]
  buffer_load_dwordx4 v235, s[12:15], s44 offen offset:3072 nt lds
  v_mfma_f32_16x16x16_bf16 v[40:43], a[248:249], a[20:21], 0
  ds_read_b64_tr_b16 a[178:179], v224 offset:12288
  ds_read_b64_tr_b16 a[194:195], v228 offset:12288
  v_mfma_f32_16x16x16_bf16 v[40:43], a[250:251], a[20:21], v[40:43]
  ds_read_b64_tr_b16 a[170:171], v230 offset:4096
  v_exp_f32 v174, v174
  v_mfma_f32_16x16x16_bf16 v[44:47], a[250:251], a[22:23], 0
  ds_read_b64_tr_b16 a[200:201], v230 offset:8192
  v_cvt_pk_bf16_f32 v34, v34, v35
  v_mfma_f32_16x16x16_bf16 v[44:47], a[248:249], a[22:23], v[44:47]
  ds_read_b64_tr_b16 a[154:155], v226 offset:4096
  v_accvgpr_write_b32 a17, v34
  s_waitcnt lgkmcnt(7)
  v_mfma_f32_16x16x16_bf16 v[48:51], a[248:249], a[24:25], 0
  s_add_u32 m0, s31, 16384
  s_nop 0
  buffer_load_dwordx4 v232, s[12:15], s45 offen offset:0 nt lds
  v_cvt_pk_bf16_f32 v38, v38, v39
  v_mfma_f32_16x16x16_bf16 v[48:51], a[250:251], a[24:25], v[48:51]
  ds_read_b64_tr_b16 a[164:165], v229 offset:0
  v_cvt_pk_bf16_f32 v32, v32, v33
  v_mfma_f32_16x16x16_bf16 v[52:55], a[250:251], a[26:27], 0
  v_cvt_pk_bf16_f32 v36, v36, v37
  v_cvt_pk_bf16_f32 v42, v42, v43
  v_mfma_f32_16x16x16_bf16 v[52:55], a[248:249], a[26:27], v[52:55]
  ds_read_b64_tr_b16 a[186:187], v226 offset:12288
  v_accvgpr_write_b32 a21, v42
  v_mfma_f32_16x16x16_bf16 v[56:59], a[248:249], a[28:29], 0
  ds_read_b64_tr_b16 a[192:193], v228 offset:8192
  v_cvt_pk_bf16_f32 v46, v46, v47
  v_accvgpr_write_b32 a23, v46
  v_mfma_f32_16x16x16_bf16 v[56:59], a[250:251], a[28:29], v[56:59]
  buffer_load_dwordx4 v233, s[12:15], s45 offen offset:1024 nt lds
  v_accvgpr_write_b32 a19, v38
  v_cvt_pk_bf16_f32 v40, v40, v41
  v_mfma_f32_16x16x16_bf16 v[60:63], a[250:251], a[30:31], 0
  v_accvgpr_write_b32 a20, v40
  v_cvt_pk_bf16_f32 v44, v44, v45
  v_mfma_f32_16x16x16_bf16 v[60:63], a[248:249], a[30:31], v[60:63]
  ds_read_b64_tr_b16 a[158:159], v227 offset:4096
  v_accvgpr_write_b32 a16, v32
  v_accvgpr_write_b32 a18, v36
  v_cvt_pk_bf16_f32 v54, v54, v55
  s_nop 3
  v_cvt_pk_bf16_f32 v62, v62, v63
  v_mfma_f32_16x16x32_bf16 v[196:199], a[232:235], a[16:19], 0
  v_accvgpr_write_b32 a22, v44
  v_cvt_pk_bf16_f32 v56, v56, v57
  v_cvt_pk_bf16_f32 v58, v58, v59
  v_accvgpr_write_b32 a29, v58
  v_cvt_pk_bf16_f32 v60, v60, v61
  v_accvgpr_write_b32 a31, v62
  v_mfma_f32_16x16x32_bf16 v[196:199], a[236:239], a[20:23], v[196:199]
  v_cvt_pk_bf16_f32 v48, v48, v49
  v_accvgpr_write_b32 a24, v48
  v_cvt_pk_bf16_f32 v50, v50, v51
  v_accvgpr_write_b32 a25, v50
  v_cvt_pk_bf16_f32 v52, v52, v53
  v_accvgpr_write_b32 a26, v52
  v_accvgpr_write_b32 a27, v54
  v_accvgpr_write_b32 a30, v60
  s_nop 0
  v_mfma_f32_16x16x32_bf16 v[196:199], a[240:243], a[24:27], v[196:199]
  buffer_load_dwordx4 v234, s[12:15], s45 offen offset:2048 nt lds
  v_accvgpr_write_b32 a28, v56
  s_nop 1
  v_mfma_f32_16x16x32_bf16 v[196:199], a[244:247], a[28:31], v[196:199]
  s_nop 7
  v_sub_f32 v196, 0xc2800000, v196
  v_sub_f32 v197, 0xc2800000, v197
  v_sub_f32 v198, 0xc2800000, v198
  v_sub_f32 v199, 0xc2800000, v199
  s_nop 1
  v_mfma_f32_16x16x32_bf16 v[176:179], a[80:83], a[16:19], v[196:199]
  ds_read_b64_tr_b16 a[146:147], v224 offset:4096
  v_exp_f32 v175, v175
  v_mfma_f32_16x16x32_bf16 v[176:179], a[84:87], a[20:23], v[176:179]
  v_exp_f32 v163, v163
  v_mfma_f32_16x16x32_bf16 v[176:179], a[88:91], a[24:27], v[176:179]
  ds_read_b64_tr_b16 a[176:177], v224 offset:8192
  ds_read_b64_tr_b16 a[206:207], v231 offset:12288
  v_mfma_f32_16x16x32_bf16 v[176:179], a[92:95], a[28:31], v[176:179]
  buffer_load_dwordx4 v235, s[12:15], s45 offen offset:3072 nt lds
  v_mfma_f32_16x16x32_bf16 v[180:183], a[108:111], a[28:31], v[196:199]
  ds_read_b64_tr_b16 a[184:185], v226 offset:8192
  ds_read_b64_tr_b16 a[198:199], v229 offset:12288
  v_mfma_f32_16x16x32_bf16 v[180:183], a[104:107], a[24:27], v[180:183]
  ds_read_b64_tr_b16 a[204:205], v231 offset:8192
  v_cvt_pk_bf16_f32 v161, v162, v163
  v_mfma_f32_16x16x32_bf16 v[180:183], a[100:103], a[20:23], v[180:183]
  ds_read_b64_tr_b16 a[180:181], v225 offset:8192
  s_waitcnt vmcnt(8)
  ds_read_b128 a[32:35], v240 offset:8192
  v_mfma_f32_16x16x32_bf16 v[180:183], a[96:99], a[16:19], v[180:183]
  ds_read_b64_tr_b16 a[156:157], v227 offset:0
  ds_read_b64_tr_b16 a[162:163], v228 offset:4096
  v_mfma_f32_16x16x32_bf16 v[184:187], a[112:115], a[16:19], v[196:199]
  v_mfma_f32_16x16x32_bf16 v[184:187], a[116:119], a[20:23], v[184:187]
  ds_read_b128 a[36:39], v241 offset:8192
  ds_read_b128 a[40:43], v242 offset:8192
  v_mfma_f32_16x16x32_bf16 v[184:187], a[120:123], a[24:27], v[184:187]
  ds_read_b64_tr_b16 a[174:175], v231 offset:4096
  ds_read_b128 a[44:47], v243 offset:8192
  v_mfma_f32_16x16x32_bf16 v[184:187], a[124:127], a[28:31], v[184:187]
  ds_read_b64_tr_b16 a[182:183], v225 offset:12288
  ds_read_b64_tr_b16 a[152:153], v226 offset:0
  v_mfma_f32_16x16x32_bf16 v[188:191], a[140:143], a[28:31], v[196:199]
  v_exp_f32 v172, v172
  v_mfma_f32_16x16x32_bf16 v[188:191], a[136:139], a[24:27], v[188:191]
  s_add_u32 m0, s30, 33024
  s_nop 0
  buffer_load_dwordx4 v232, s[16:19], s54 offen offset:0 nt lds
  v_exp_f32 v167, v167
  v_mfma_f32_16x16x32_bf16 v[188:191], a[132:135], a[20:23], v[188:191]
  v_exp_f32 v169, v169
  v_mfma_f32_16x16x32_bf16 v[188:191], a[128:131], a[16:19], v[188:191]
  v_exp_f32 v164, v164
  s_waitcnt lgkmcnt(4)
  v_mfma_f32_16x16x16_bf16 v[64:67], a[248:249], a[32:33], 0
  v_exp_f32 v165, v165
  v_mfma_f32_16x16x16_bf16 v[64:67], a[250:251], a[32:33], v[64:67]
  ds_read_b64_tr_b16 a[150:151], v225 offset:4096
  ds_read_b64_tr_b16 a[196:197], v229 offset:8192
  v_mfma_f32_16x16x16_bf16 v[68:71], a[250:251], a[34:35], 0
  v_exp_f32 v173, v173
  v_mfma_f32_16x16x16_bf16 v[68:71], a[248:249], a[34:35], v[68:71]
  ds_read_b64_tr_b16 a[168:169], v230 offset:0
  v_cvt_pk_bf16_f32 v162, v164, v165
  v_mfma_f32_16x16x16_bf16 v[72:75], a[248:249], a[36:37], 0
  ds_read_b64_tr_b16 a[202:203], v230 offset:12288
  v_cvt_pk_bf16_f32 v163, v166, v167
  v_mfma_f32_16x16x16_bf16 v[72:75], a[250:251], a[36:37], v[72:75]
  ds_read_b64_tr_b16 a[144:145], v224 offset:0
  v_cvt_pk_bf16_f32 v164, v168, v169
  v_mfma_f32_16x16x16_bf16 v[76:79], a[250:251], a[38:39], 0
  ds_read_b64_tr_b16 a[190:191], v227 offset:12288
  ds_read_b64_tr_b16 a[172:173], v231 offset:0
  v_mfma_f32_16x16x16_bf16 v[76:79], a[248:249], a[38:39], v[76:79]
  buffer_load_dwordx4 v233, s[16:19], s54 offen offset:1024 nt lds
  ds_read_b64_tr_b16 a[160:161], v228 offset:0
  v_cvt_pk_bf16_f32 v64, v64, v65
  v_mfma_f32_16x16x16_bf16 v[80:83], a[248:249], a[40:41], 0
  v_cvt_pk_bf16_f32 v66, v66, v67
  v_cvt_pk_bf16_f32 v68, v68, v69
  v_mfma_f32_16x16x16_bf16 v[80:83], a[250:251], a[40:41], v[80:83]
  v_accvgpr_write_b32 a32, v64
  v_accvgpr_write_b32 a33, v66
  v_mfma_f32_16x16x16_bf16 v[84:87], a[250:251], a[42:43], 0
  v_cvt_pk_bf16_f32 v72, v72, v73
  v_cvt_pk_bf16_f32 v74, v74, v75
  v_mfma_f32_16x16x16_bf16 v[84:87], a[248:249], a[42:43], v[84:87]
  v_exp_f32 v170, v170
  s_waitcnt lgkmcnt(3)
  v_mfma_f32_16x16x16_bf16 v[88:91], a[248:249], a[44:45], 0
  v_accvgpr_write_b32 a36, v72
  v_cvt_pk_bf16_f32 v78, v78, v79
  v_mfma_f32_16x16x16_bf16 v[88:91], a[250:251], a[44:45], v[88:91]
  v_exp_f32 v171, v171
  v_mfma_f32_16x16x16_bf16 v[92:95], a[250:251], a[46:47], 0
  v_cvt_pk_bf16_f32 v70, v70, v71
  v_accvgpr_write_b32 a37, v74
  v_mfma_f32_16x16x16_bf16 v[92:95], a[248:249], a[46:47], v[92:95]
  v_cvt_pk_bf16_f32 v165, v170, v171
  v_cvt_pk_bf16_f32 v166, v172, v173
  v_cvt_pk_bf16_f32 v167, v174, v175
  v_cvt_pk_bf16_f32 v80, v80, v81
  v_mfma_f32_16x16x32_bf16 v[0:3], a[144:147], v[160:163], 0
  v_cvt_pk_bf16_f32 v84, v84, v85
  v_cvt_pk_bf16_f32 v86, v86, v87
  v_mfma_f32_16x16x32_bf16 v[0:3], a[176:179], v[164:167], v[0:3]
  buffer_load_dwordx4 v234, s[16:19], s54 offen offset:2048 nt lds
  v_accvgpr_write_b32 a34, v68
  v_cvt_pk_bf16_f32 v82, v82, v83
  v_mfma_f32_16x16x32_bf16 v[4:7], a[180:183], v[164:167], 0
  v_accvgpr_write_b32 a39, v78
  v_cvt_pk_bf16_f32 v88, v88, v89
  v_mfma_f32_16x16x32_bf16 v[4:7], a[148:151], v[160:163], v[4:7]
  v_accvgpr_write_b32 a40, v80
  v_accvgpr_write_b32 a43, v86
  v_mfma_f32_16x16x32_bf16 v[8:11], a[152:155], v[160:163], 0
  v_cvt_pk_bf16_f32 v76, v76, v77
  v_accvgpr_write_b32 a41, v82
  v_mfma_f32_16x16x32_bf16 v[8:11], a[184:187], v[164:167], v[8:11]
  v_accvgpr_write_b32 a35, v70
  v_cvt_pk_bf16_f32 v92, v92, v93
  s_waitcnt lgkmcnt(0)
  v_mfma_f32_16x16x32_bf16 v[12:15], a[188:191], v[164:167], 0
  v_cvt_pk_bf16_f32 v90, v90, v91
  v_accvgpr_write_b32 a46, v92
  v_mfma_f32_16x16x32_bf16 v[12:15], a[156:159], v[160:163], v[12:15]
  v_accvgpr_write_b32 a38, v76
  v_accvgpr_write_b32 a45, v90
  v_mfma_f32_16x16x32_bf16 v[200:203], a[232:235], a[32:35], 0
  v_accvgpr_write_b32 a42, v84
  v_accvgpr_write_b32 a44, v88
  v_mfma_f32_16x16x32_bf16 v[200:203], a[236:239], a[36:39], v[200:203]
  v_cvt_pk_bf16_f32 v94, v94, v95
  v_accvgpr_write_b32 a47, v94
  v_mfma_f32_16x16x32_bf16 v[200:203], a[240:243], a[40:43], v[200:203]
  v_exp_f32 v180, v180
  v_mfma_f32_16x16x32_bf16 v[200:203], a[244:247], a[44:47], v[200:203]
  buffer_load_dwordx4 v235, s[16:19], s54 offen offset:3072 nt lds
  v_exp_f32 v188, v188
  v_mfma_f32_16x16x32_bf16 v[16:19], a[160:163], v[160:163], 0
  v_exp_f32 v178, v178
  v_mfma_f32_16x16x32_bf16 v[16:19], a[192:195], v[164:167], v[16:19]
  v_exp_f32 v190, v190
  v_mfma_f32_16x16x32_bf16 v[20:23], a[196:199], v[164:167], 0
  v_exp_f32 v176, v176
  v_mfma_f32_16x16x32_bf16 v[20:23], a[164:167], v[160:163], v[20:23]
  v_exp_f32 v181, v181
  v_mfma_f32_16x16x32_bf16 v[24:27], a[168:171], v[160:163], 0
  v_sub_f32 v200, 0xc2800000, v200
  v_mfma_f32_16x16x32_bf16 v[24:27], a[200:203], v[164:167], v[24:27]
  v_sub_f32 v202, 0xc2800000, v202
  v_mfma_f32_16x16x32_bf16 v[28:31], a[204:207], v[164:167], 0
  v_exp_f32 v177, v177
  v_mfma_f32_16x16x32_bf16 v[28:31], a[172:175], v[160:163], v[28:31]
  v_sub_f32 v201, 0xc2800000, v201
  v_sub_f32 v203, 0xc2800000, v203
  v_smfmac_f32_16x16x64_bf16 a[208:211], a[228:231], v[160:167], v254
  s_nop 0
  v_mfma_f32_16x16x32_bf16 v[160:163], a[80:83], a[32:35], v[200:203]
  s_add_u32 m0, s30, 49408
  s_nop 0
  buffer_load_dwordx4 v236, s[20:23], s54 offen offset:0  lds
  v_exp_f32 v185, v185
  v_mfma_f32_16x16x32_bf16 v[160:163], a[84:87], a[36:39], v[160:163]
  v_exp_f32 v186, v186
  v_mfma_f32_16x16x32_bf16 v[160:163], a[88:91], a[40:43], v[160:163]
  v_mfma_f32_16x16x32_bf16 v[160:163], a[92:95], a[44:47], v[160:163]
  v_exp_f32 v187, v187
  v_mfma_f32_16x16x32_bf16 v[164:167], a[108:111], a[44:47], v[200:203]
  v_exp_f32 v179, v179
  v_mfma_f32_16x16x32_bf16 v[164:167], a[104:107], a[40:43], v[164:167]
  v_exp_f32 v191, v191
  v_mfma_f32_16x16x32_bf16 v[164:167], a[100:103], a[36:39], v[164:167]
  v_mfma_f32_16x16x32_bf16 v[164:167], a[96:99], a[32:35], v[164:167]
  s_waitcnt vmcnt(9)
  ds_read_b128 a[48:51], v240 offset:12288
  v_cvt_pk_bf16_f32 v176, v176, v177
  v_mfma_f32_16x16x32_bf16 v[168:171], a[112:115], a[32:35], v[200:203]
  ds_read_b128 a[52:55], v241 offset:12288
  v_cvt_pk_bf16_f32 v177, v178, v179
  v_mfma_f32_16x16x32_bf16 v[168:171], a[116:119], a[36:39], v[168:171]
  v_exp_f32 v183, v183
  v_mfma_f32_16x16x32_bf16 v[168:171], a[120:123], a[40:43], v[168:171]
  buffer_load_dwordx4 v237, s[20:23], s54 offen offset:1024  lds
  ds_read_b128 a[56:59], v242 offset:12288
  v_mfma_f32_16x16x32_bf16 v[168:171], a[124:127], a[44:47], v[168:171]
  ds_read_b128 a[60:63], v243 offset:12288
  v_mfma_f32_16x16x32_bf16 v[172:175], a[140:143], a[44:47], v[200:203]
  v_exp_f32 v189, v189
  v_mfma_f32_16x16x32_bf16 v[172:175], a[136:139], a[40:43], v[172:175]
  v_exp_f32 v182, v182
  v_mfma_f32_16x16x32_bf16 v[172:175], a[132:135], a[36:39], v[172:175]
  v_cvt_pk_bf16_f32 v178, v180, v181
  v_mfma_f32_16x16x32_bf16 v[172:175], a[128:131], a[32:35], v[172:175]
  v_exp_f32 v160, v160
  s_waitcnt lgkmcnt(2)
  v_mfma_f32_16x16x16_bf16 v[96:99], a[248:249], a[48:49], 0
  v_cvt_pk_bf16_f32 v179, v182, v183
  v_mfma_f32_16x16x16_bf16 v[96:99], a[250:251], a[48:49], v[96:99]
  v_exp_f32 v184, v184
  v_mfma_f32_16x16x16_bf16 v[100:103], a[250:251], a[50:51], 0
  v_exp_f32 v163, v163
  v_mfma_f32_16x16x16_bf16 v[100:103], a[248:249], a[50:51], v[100:103]
  v_cvt_pk_bf16_f32 v180, v184, v185
  v_cvt_pk_bf16_f32 v181, v186, v187
  v_mfma_f32_16x16x16_bf16 v[104:107], a[248:249], a[52:53], 0
  buffer_load_dwordx4 v236, s[20:23], s54 offen offset:2048  lds
  v_cvt_pk_bf16_f32 v182, v188, v189
  v_mfma_f32_16x16x16_bf16 v[104:107], a[250:251], a[52:53], v[104:107]
  v_mfma_f32_16x16x16_bf16 v[108:111], a[250:251], a[54:55], 0
  v_exp_f32 v164, v164
  v_mfma_f32_16x16x16_bf16 v[108:111], a[248:249], a[54:55], v[108:111]
  v_exp_f32 v166, v166
  s_waitcnt lgkmcnt(0)
  v_mfma_f32_16x16x16_bf16 v[112:115], a[248:249], a[56:57], 0
  v_cvt_pk_bf16_f32 v98, v98, v99
  v_cvt_pk_bf16_f32 v100, v100, v101
  v_mfma_f32_16x16x16_bf16 v[112:115], a[250:251], a[56:57], v[112:115]
  v_cvt_pk_bf16_f32 v183, v190, v191
  v_cvt_pk_bf16_f32 v102, v102, v103
  v_mfma_f32_16x16x16_bf16 v[116:119], a[250:251], a[58:59], 0
  v_cvt_pk_bf16_f32 v96, v96, v97
  v_accvgpr_write_b32 a48, v96
  v_mfma_f32_16x16x16_bf16 v[116:119], a[248:249], a[58:59], v[116:119]
  v_accvgpr_write_b32 a50, v100
  v_cvt_pk_bf16_f32 v106, v106, v107
  v_mfma_f32_16x16x16_bf16 v[120:123], a[248:249], a[60:61], 0
  v_cvt_pk_bf16_f32 v104, v104, v105
  v_mfma_f32_16x16x16_bf16 v[120:123], a[250:251], a[60:61], v[120:123]
  v_exp_f32 v174, v174
  v_mfma_f32_16x16x16_bf16 v[124:127], a[250:251], a[62:63], 0
  buffer_load_dwordx4 v237, s[20:23], s54 offen offset:3072  lds
  v_accvgpr_write_b32 a49, v98
  v_accvgpr_write_b32 a52, v104
  v_mfma_f32_16x16x16_bf16 v[124:127], a[248:249], a[62:63], v[124:127]
  v_accvgpr_write_b32 a51, v102
  v_cvt_pk_bf16_f32 v108, v108, v109
  v_accvgpr_write_b32 a54, v108
  v_cvt_pk_bf16_f32 v114, v114, v115
  v_mfma_f32_16x16x32_bf16 v[32:35], a[144:147], v[176:179], 0
  v_cvt_pk_bf16_f32 v116, v116, v117
  v_mfma_f32_16x16x32_bf16 v[32:35], a[176:179], v[180:183], v[32:35]
  v_cvt_pk_bf16_f32 v112, v112, v113
  v_accvgpr_write_b32 a56, v112
  v_mfma_f32_16x16x32_bf16 v[36:39], a[180:183], v[180:183], 0
  v_cvt_pk_bf16_f32 v110, v110, v111
  v_cvt_pk_bf16_f32 v122, v122, v123
  v_mfma_f32_16x16x32_bf16 v[36:39], a[148:151], v[176:179], v[36:39]
  v_accvgpr_write_b32 a55, v110
  v_accvgpr_write_b32 a61, v122
  v_mfma_f32_16x16x32_bf16 v[40:43], a[152:155], v[176:179], 0
  v_accvgpr_write_b32 a58, v116
  v_cvt_pk_bf16_f32 v126, v126, v127
  v_mfma_f32_16x16x32_bf16 v[40:43], a[184:187], v[180:183], v[40:43]
  v_accvgpr_write_b32 a53, v106
  v_cvt_pk_bf16_f32 v118, v118, v119
  v_mfma_f32_16x16x32_bf16 v[44:47], a[188:191], v[180:183], 0
  v_accvgpr_write_b32 a57, v114
  v_cvt_pk_bf16_f32 v124, v124, v125
  v_mfma_f32_16x16x32_bf16 v[44:47], a[156:159], v[176:179], v[44:47]
  v_accvgpr_write_b32 a59, v118
  v_mfma_f32_16x16x32_bf16 v[204:207], a[232:235], a[48:51], 0
  s_add_u32 m0, s30, 65792
  s_nop 0
  buffer_load_dwordx4 v232, s[16:19], s55 offen offset:0 nt lds
  v_cvt_pk_bf16_f32 v120, v120, v121
  v_accvgpr_write_b32 a60, v120
  v_mfma_f32_16x16x32_bf16 v[204:207], a[236:239], a[52:55], v[204:207]
  v_accvgpr_write_b32 a62, v124
  v_accvgpr_write_b32 a63, v126
  v_mfma_f32_16x16x32_bf16 v[204:207], a[240:243], a[56:59], v[204:207]
  v_exp_f32 v173, v173
  v_mfma_f32_16x16x32_bf16 v[204:207], a[244:247], a[60:63], v[204:207]
  v_exp_f32 v168, v168
  v_mfma_f32_16x16x32_bf16 v[48:51], a[160:163], v[176:179], 0
  v_exp_f32 v162, v162
  v_mfma_f32_16x16x32_bf16 v[48:51], a[192:195], v[180:183], v[48:51]
  v_exp_f32 v172, v172
  v_mfma_f32_16x16x32_bf16 v[52:55], a[196:199], v[180:183], 0
  v_mfma_f32_16x16x32_bf16 v[52:55], a[164:167], v[176:179], v[52:55]
  v_exp_f32 v161, v161
  v_mfma_f32_16x16x32_bf16 v[56:59], a[168:171], v[176:179], 0
  v_mfma_f32_16x16x32_bf16 v[56:59], a[200:203], v[180:183], v[56:59]
  v_sub_f32 v204, 0xc2800000, v204
  v_sub_f32 v207, 0xc2800000, v207
  v_mfma_f32_16x16x32_bf16 v[60:63], a[204:207], v[180:183], 0
  buffer_load_dwordx4 v233, s[16:19], s55 offen offset:1024 nt lds
  v_sub_f32 v205, 0xc2800000, v205
  v_mfma_f32_16x16x32_bf16 v[60:63], a[172:175], v[176:179], v[60:63]
  v_sub_f32 v206, 0xc2800000, v206
  v_smfmac_f32_16x16x64_bf16 a[212:215], a[228:231], v[176:183], v254
  s_nop 0
  v_mfma_f32_16x16x32_bf16 v[176:179], a[80:83], a[48:51], v[204:207]
  v_exp_f32 v165, v165
  v_mfma_f32_16x16x32_bf16 v[176:179], a[84:87], a[52:55], v[176:179]
  v_exp_f32 v169, v169
  v_mfma_f32_16x16x32_bf16 v[176:179], a[88:91], a[56:59], v[176:179]
  v_cvt_pk_bf16_f32 v160, v160, v161
  v_mfma_f32_16x16x32_bf16 v[176:179], a[92:95], a[60:63], v[176:179]
  v_exp_f32 v167, v167
  v_mfma_f32_16x16x32_bf16 v[180:183], a[108:111], a[60:63], v[204:207]
  v_cvt_pk_bf16_f32 v161, v162, v163
  v_mfma_f32_16x16x32_bf16 v[180:183], a[104:107], a[56:59], v[180:183]
  v_exp_f32 v171, v171
  v_mfma_f32_16x16x32_bf16 v[180:183], a[100:103], a[52:55], v[180:183]
  v_cvt_pk_bf16_f32 v162, v164, v165
  v_mfma_f32_16x16x32_bf16 v[180:183], a[96:99], a[48:51], v[180:183]
  buffer_load_dwordx4 v234, s[16:19], s55 offen offset:2048 nt lds
  s_waitcnt vmcnt(11)
  ds_read_b128 a[64:67], v240 offset:16384
  v_mfma_f32_16x16x32_bf16 v[184:187], a[112:115], a[48:51], v[204:207]
  ds_read_b128 a[72:75], v242 offset:16384
  v_cvt_pk_bf16_f32 v163, v166, v167
  v_mfma_f32_16x16x32_bf16 v[184:187], a[116:119], a[52:55], v[184:187]
  ds_read_b128 a[68:71], v241 offset:16384
  v_cvt_pk_bf16_f32 v164, v168, v169
  v_mfma_f32_16x16x32_bf16 v[184:187], a[120:123], a[56:59], v[184:187]
  v_exp_f32 v176, v176
  v_mfma_f32_16x16x32_bf16 v[184:187], a[124:127], a[60:63], v[184:187]
  ds_read_b128 a[76:79], v243 offset:16384
  v_mfma_f32_16x16x32_bf16 v[188:191], a[140:143], a[60:63], v[204:207]
  v_exp_f32 v175, v175
  v_mfma_f32_16x16x32_bf16 v[188:191], a[136:139], a[56:59], v[188:191]
  v_exp_f32 v178, v178
  v_mfma_f32_16x16x32_bf16 v[188:191], a[132:135], a[52:55], v[188:191]
  v_exp_f32 v170, v170
  v_mfma_f32_16x16x32_bf16 v[188:191], a[128:131], a[48:51], v[188:191]
  v_exp_f32 v179, v179
  s_waitcnt lgkmcnt(1)
  v_mfma_f32_16x16x16_bf16 v[128:131], a[248:249], a[64:65], 0
  v_cvt_pk_bf16_f32 v165, v170, v171
  v_mfma_f32_16x16x16_bf16 v[128:131], a[250:251], a[64:65], v[128:131]
  buffer_load_dwordx4 v235, s[16:19], s55 offen offset:3072 nt lds
  v_mfma_f32_16x16x16_bf16 v[132:135], a[250:251], a[66:67], 0
  v_exp_f32 v177, v177
  v_mfma_f32_16x16x16_bf16 v[132:135], a[248:249], a[66:67], v[132:135]
  v_exp_f32 v183, v183
  v_mfma_f32_16x16x16_bf16 v[136:139], a[248:249], a[68:69], 0
  v_exp_f32 v189, v189
  v_mfma_f32_16x16x16_bf16 v[136:139], a[250:251], a[68:69], v[136:139]
  v_exp_f32 v181, v181
  v_mfma_f32_16x16x16_bf16 v[140:143], a[250:251], a[70:71], 0
  v_mfma_f32_16x16x16_bf16 v[140:143], a[248:249], a[70:71], v[140:143]
  v_mfma_f32_16x16x16_bf16 v[144:147], a[248:249], a[72:73], 0
  v_exp_f32 v187, v187
  v_mfma_f32_16x16x16_bf16 v[144:147], a[250:251], a[72:73], v[144:147]
  v_cvt_pk_bf16_f32 v130, v130, v131
  v_cvt_pk_bf16_f32 v132, v132, v133
  v_mfma_f32_16x16x16_bf16 v[148:151], a[250:251], a[74:75], 0
  v_cvt_pk_bf16_f32 v138, v138, v139
  v_accvgpr_write_b32 a69, v138
  v_mfma_f32_16x16x16_bf16 v[148:151], a[248:249], a[74:75], v[148:151]
  s_add_u32 m0, s30, 256
  s_nop 0
  buffer_load_dwordx4 v236, s[20:23], s55 offen offset:0  lds
  v_cvt_pk_bf16_f32 v166, v172, v173
  v_cvt_pk_bf16_f32 v136, v136, v137
  s_waitcnt lgkmcnt(0)
  v_mfma_f32_16x16x16_bf16 v[152:155], a[248:249], a[76:77], 0
  v_cvt_pk_bf16_f32 v128, v128, v129
  v_cvt_pk_bf16_f32 v142, v142, v143
  v_mfma_f32_16x16x16_bf16 v[152:155], a[250:251], a[76:77], v[152:155]
  v_cvt_pk_bf16_f32 v167, v174, v175
  v_cvt_pk_bf16_f32 v140, v140, v141
  v_mfma_f32_16x16x16_bf16 v[156:159], a[250:251], a[78:79], 0
  v_accvgpr_write_b32 a68, v136
  v_cvt_pk_bf16_f32 v144, v144, v145
  v_mfma_f32_16x16x16_bf16 v[156:159], a[248:249], a[78:79], v[156:159]
  v_exp_f32 v182, v182
  v_accvgpr_write_b32 a64, v128
  v_accvgpr_write_b32 a70, v140
  v_mfma_f32_16x16x32_bf16 v[64:67], a[144:147], v[160:163], 0
  v_accvgpr_write_b32 a66, v132
  v_cvt_pk_bf16_f32 v150, v150, v151
  v_mfma_f32_16x16x32_bf16 v[64:67], a[176:179], v[164:167], v[64:67]
  v_accvgpr_write_b32 a65, v130
  v_accvgpr_write_b32 a71, v142
  v_mfma_f32_16x16x32_bf16 v[68:71], a[180:183], v[164:167], 0
  v_cvt_pk_bf16_f32 v146, v146, v147
  v_cvt_pk_bf16_f32 v152, v152, v153
  v_mfma_f32_16x16x32_bf16 v[68:71], a[148:151], v[160:163], v[68:71]
  v_cvt_pk_bf16_f32 v134, v134, v135
  v_cvt_pk_bf16_f32 v148, v148, v149
  v_mfma_f32_16x16x32_bf16 v[72:75], a[152:155], v[160:163], 0
  v_accvgpr_write_b32 a73, v146
  v_accvgpr_write_b32 a74, v148
  v_mfma_f32_16x16x32_bf16 v[72:75], a[184:187], v[164:167], v[72:75]
  buffer_load_dwordx4 v237, s[20:23], s55 offen offset:1024  lds
  v_accvgpr_write_b32 a67, v134
  v_accvgpr_write_b32 a72, v144
  v_mfma_f32_16x16x32_bf16 v[76:79], a[188:191], v[164:167], 0
  v_accvgpr_write_b32 a75, v150
  v_cvt_pk_bf16_f32 v158, v158, v159
  v_mfma_f32_16x16x32_bf16 v[76:79], a[156:159], v[160:163], v[76:79]
  v_cvt_pk_bf16_f32 v156, v156, v157
  v_accvgpr_write_b32 a79, v158
  v_mfma_f32_16x16x32_bf16 v[208:211], a[232:235], a[64:67], 0
  v_accvgpr_write_b32 a76, v152
  v_accvgpr_write_b32 a78, v156
  v_mfma_f32_16x16x32_bf16 v[208:211], a[236:239], a[68:71], v[208:211]
  v_cvt_pk_bf16_f32 v154, v154, v155
  v_accvgpr_write_b32 a77, v154
  v_mfma_f32_16x16x32_bf16 v[208:211], a[240:243], a[72:75], v[208:211]
  v_exp_f32 v186, v186
  v_mfma_f32_16x16x32_bf16 v[208:211], a[244:247], a[76:79], v[208:211]
  v_exp_f32 v190, v190
  v_mfma_f32_16x16x32_bf16 v[80:83], a[160:163], v[160:163], 0
  v_exp_f32 v191, v191
  v_mfma_f32_16x16x32_bf16 v[80:83], a[192:195], v[164:167], v[80:83]
  v_exp_f32 v184, v184
  v_mfma_f32_16x16x32_bf16 v[84:87], a[196:199], v[164:167], 0
  v_exp_f32 v188, v188
  v_mfma_f32_16x16x32_bf16 v[84:87], a[164:167], v[160:163], v[84:87]
  buffer_load_dwordx4 v236, s[20:23], s55 offen offset:2048  lds
  v_exp_f32 v185, v185
  v_mfma_f32_16x16x32_bf16 v[88:91], a[168:171], v[160:163], 0
  v_sub_f32 v209, 0xc2800000, v209
  v_sub_f32 v210, 0xc2800000, v210
  v_mfma_f32_16x16x32_bf16 v[88:91], a[200:203], v[164:167], v[88:91]
  v_exp_f32 v180, v180
  v_mfma_f32_16x16x32_bf16 v[92:95], a[204:207], v[164:167], 0
  v_cvt_pk_bf16_f32 v176, v176, v177
  v_mfma_f32_16x16x32_bf16 v[92:95], a[172:175], v[160:163], v[92:95]
  v_sub_f32 v208, 0xc2800000, v208
  v_sub_f32 v211, 0xc2800000, v211
  v_smfmac_f32_16x16x64_bf16 a[216:219], a[228:231], v[160:167], v254
  s_nop 0
  v_mfma_f32_16x16x32_bf16 v[160:163], a[80:83], a[64:67], v[208:211]
  s_waitcnt vmcnt(11)
  s_barrier
  v_mfma_f32_16x16x32_bf16 v[160:163], a[84:87], a[68:71], v[160:163]
  ds_read_b128 a[80:83], v220 offset:32768
  v_cvt_pk_bf16_f32 v177, v178, v179
  v_mfma_f32_16x16x32_bf16 v[160:163], a[88:91], a[72:75], v[160:163]
  ds_read_b128 a[84:87], v221 offset:32768
  v_cvt_pk_bf16_f32 v178, v180, v181
  v_mfma_f32_16x16x32_bf16 v[160:163], a[92:95], a[76:79], v[160:163]
  ds_read_b128 a[88:91], v222 offset:32768
  v_mfma_f32_16x16x32_bf16 v[164:167], a[108:111], a[76:79], v[208:211]
  buffer_load_dwordx4 v237, s[20:23], s55 offen offset:3072  lds
  ds_read_b128 a[108:111], v223 offset:36864
  v_cvt_pk_bf16_f32 v179, v182, v183
  v_mfma_f32_16x16x32_bf16 v[164:167], a[104:107], a[72:75], v[164:167]
  ds_read_b128 a[104:107], v222 offset:36864
  v_cvt_pk_bf16_f32 v180, v184, v185
  v_mfma_f32_16x16x32_bf16 v[164:167], a[100:103], a[68:71], v[164:167]
  ds_read_b128 a[100:103], v221 offset:36864
  v_mfma_f32_16x16x32_bf16 v[164:167], a[96:99], a[64:67], v[164:167]
  ds_read_b128 a[92:95], v223 offset:32768
  v_mfma_f32_16x16x32_bf16 v[168:171], a[112:115], a[64:67], v[208:211]
  ds_read_b128 a[96:99], v220 offset:36864
  v_mfma_f32_16x16x32_bf16 v[168:171], a[116:119], a[68:71], v[168:171]
  ds_read_b128 a[116:119], v221 offset:40960
  v_cvt_pk_bf16_f32 v181, v186, v187
  v_mfma_f32_16x16x32_bf16 v[168:171], a[120:123], a[72:75], v[168:171]
  ds_read_b128 a[120:123], v222 offset:40960
  v_cvt_pk_bf16_f32 v182, v188, v189
  v_mfma_f32_16x16x32_bf16 v[168:171], a[124:127], a[76:79], v[168:171]
  ds_read_b128 a[112:115], v220 offset:40960
  v_cvt_pk_bf16_f32 v183, v190, v191
  v_mfma_f32_16x16x32_bf16 v[172:175], a[140:143], a[76:79], v[208:211]
  ds_read_b128 a[140:143], v223 offset:45056
  v_mfma_f32_16x16x32_bf16 v[172:175], a[136:139], a[72:75], v[172:175]
  ds_read_b128 a[136:139], v222 offset:45056
  v_mfma_f32_16x16x32_bf16 v[172:175], a[132:135], a[68:71], v[172:175]
  s_add_u32 s39, s38, 20447232
  s_add_u32 s12, s4, s39
  s_addc_u32 s13, s5, 0
  s_cmp_lt_u32 s32, 3
  s_cselect_b32 s40, -1, 0
  s_and_b32 s14, s49, s40
  s_add_u32 m0, s31, 0
  s_nop 0
  buffer_load_dwordx4 v232, s[12:15], 0 offen offset:0 nt lds
  ds_read_b128 a[124:127], v223 offset:40960
  v_mfma_f32_16x16x32_bf16 v[172:175], a[128:131], a[64:67], v[172:175]
  ds_read_b128 a[132:135], v221 offset:45056
  ds_read_b128 a[128:131], v220 offset:45056
  v_mfma_f32_16x16x32_bf16 v[96:99], a[144:147], v[176:179], 0
  v_add_u32 v252, 1, v252
  v_mfma_f32_16x16x32_bf16 v[96:99], a[176:179], v[180:183], v[96:99]
  v_exp_f32 v166, v166
  v_mfma_f32_16x16x32_bf16 v[100:103], a[180:183], v[180:183], 0
  v_exp_f32 v163, v163
  v_mfma_f32_16x16x32_bf16 v[100:103], a[148:151], v[176:179], v[100:103]
  v_exp_f32 v160, v160
  v_mfma_f32_16x16x32_bf16 v[104:107], a[152:155], v[176:179], 0
  v_exp_f32 v168, v168
  v_mfma_f32_16x16x32_bf16 v[104:107], a[184:187], v[180:183], v[104:107]
  v_mfma_f32_16x16x32_bf16 v[108:111], a[188:191], v[180:183], 0
  v_exp_f32 v162, v162
  v_mfma_f32_16x16x32_bf16 v[108:111], a[156:159], v[176:179], v[108:111]
  v_exp_f32 v172, v172
  v_mfma_f32_16x16x32_bf16 v[112:115], a[160:163], v[176:179], 0
  s_add_u32 m0, s30, 16640
  s_nop 0
  buffer_load_dwordx4 v232, s[16:19], s56 offen offset:0 nt lds
  s_waitcnt vmcnt(10) lgkmcnt(0)
  ds_write_b32 v253, v252
  v_mfma_f32_16x16x32_bf16 v[112:115], a[192:195], v[180:183], v[112:115]
  v_exp_f32 v161, v161
  v_mfma_f32_16x16x32_bf16 v[116:119], a[196:199], v[180:183], 0
  v_exp_f32 v167, v167
  v_mfma_f32_16x16x32_bf16 v[116:119], a[164:167], v[176:179], v[116:119]
  v_mfma_f32_16x16x32_bf16 v[120:123], a[168:171], v[176:179], 0
  v_cvt_pk_bf16_f32 v160, v160, v161
  v_cvt_pk_bf16_f32 v161, v162, v163
  v_mfma_f32_16x16x32_bf16 v[120:123], a[200:203], v[180:183], v[120:123]
  v_exp_f32 v165, v165
  v_mfma_f32_16x16x32_bf16 v[124:127], a[204:207], v[180:183], 0
  v_exp_f32 v169, v169
  v_mfma_f32_16x16x32_bf16 v[124:127], a[172:175], v[176:179], v[124:127]
  v_smfmac_f32_16x16x64_bf16 a[220:223], a[228:231], v[176:183], v254
  v_mfma_f32_16x16x32_bf16 v[176:179], a[80:83], a[0:3], v[192:195]
  v_exp_f32 v175, v175
  v_mfma_f32_16x16x32_bf16 v[176:179], a[84:87], a[4:7], v[176:179]
  buffer_load_dwordx4 v233, s[16:19], s56 offen offset:1024 nt lds
  v_exp_f32 v170, v170
  v_mfma_f32_16x16x32_bf16 v[176:179], a[88:91], a[8:11], v[176:179]
  v_exp_f32 v164, v164
  v_mfma_f32_16x16x32_bf16 v[176:179], a[92:95], a[12:15], v[176:179]
  v_mfma_f32_16x16x32_bf16 v[180:183], a[108:111], a[12:15], v[192:195]
  v_exp_f32 v171, v171
  v_mfma_f32_16x16x32_bf16 v[180:183], a[104:107], a[8:11], v[180:183]
  v_cvt_pk_bf16_f32 v162, v164, v165
  v_mfma_f32_16x16x32_bf16 v[180:183], a[100:103], a[4:7], v[180:183]
  v_exp_f32 v173, v173
  v_mfma_f32_16x16x32_bf16 v[180:183], a[96:99], a[0:3], v[180:183]
  v_mfma_f32_16x16x32_bf16 v[184:187], a[112:115], a[0:3], v[192:195]
  ds_read_b32 v251, v250
  v_cvt_pk_bf16_f32 v163, v166, v167
  v_mfma_f32_16x16x32_bf16 v[184:187], a[116:119], a[4:7], v[184:187]
  v_exp_f32 v174, v174
  v_mfma_f32_16x16x32_bf16 v[184:187], a[120:123], a[8:11], v[184:187]
  v_exp_f32 v177, v177
  v_mfma_f32_16x16x32_bf16 v[184:187], a[124:127], a[12:15], v[184:187]
  buffer_load_dwordx4 v234, s[16:19], s56 offen offset:2048 nt lds
  v_mfma_f32_16x16x32_bf16 v[188:191], a[140:143], a[12:15], v[192:195]
  v_cvt_pk_bf16_f32 v164, v168, v169
  v_cvt_pk_bf16_f32 v165, v170, v171
  v_mfma_f32_16x16x32_bf16 v[188:191], a[136:139], a[8:11], v[188:191]
  v_cvt_pk_bf16_f32 v166, v172, v173
  v_cvt_pk_bf16_f32 v167, v174, v175
  v_mfma_f32_16x16x32_bf16 v[188:191], a[132:135], a[4:7], v[188:191]
  s_waitcnt lgkmcnt(0)
  v_cmp_gt_u32 vcc, v252, v251
  buffer_load_dwordx4 v235, s[16:19], s56 offen offset:3072 nt lds
  s_add_u32 m0, s31, 0
  s_branch L_ENTRY
.p2align 3
L_PASS:
  v_mfma_f32_16x16x32_bf16 v[160:163], a[80:83], a[0:3], v[192:195]
  v_cvt_pk_bf16_f32 v204, v204, v205
  v_accvgpr_read_b32 v249, a220
  v_mfma_f32_16x16x32_bf16 v[160:163], a[84:87], a[4:7], v[160:163]
  v_cvt_pk_bf16_f32 v57, v58, v59
  v_accvgpr_read_b32 v248, a221
  v_mfma_f32_16x16x32_bf16 v[160:163], a[88:91], a[8:11], v[160:163]
  ds_read_b128 a[68:71], v241 offset:16384
  v_cvt_pk_bf16_f32 v81, v82, v83
  v_mfma_f32_16x16x32_bf16 v[160:163], a[92:95], a[12:15], v[160:163]
  s_waitcnt lgkmcnt(1)
  ds_write_b32 v253, v252
  v_mfma_f32_16x16x32_bf16 v[164:167], a[108:111], a[12:15], v[192:195]
  v_exp_f32 v185, v185
  v_mfma_f32_16x16x32_bf16 v[164:167], a[104:107], a[8:11], v[164:167]
  v_accvgpr_write_b32 a57, v218
  v_cvt_pk_bf16_f32 v214, v214, v215
  v_mfma_f32_16x16x32_bf16 v[164:167], a[100:103], a[4:7], v[164:167]
  v_exp_f32 v179, v179
  v_mfma_f32_16x16x32_bf16 v[164:167], a[96:99], a[0:3], v[164:167]
  v_cvt_pk_bf16_f32 v212, v212, v213
  v_cvt_pk_bf16_f32 v177, v178, v179
  v_add_f32 v249, v249, v248
  v_mfma_f32_16x16x32_bf16 v[168:171], a[112:115], a[0:3], v[192:195]
  ds_read_b128 a[72:75], v242 offset:16384
  v_rcp_f32 v248, v249
  v_mfma_f32_16x16x32_bf16 v[168:171], a[116:119], a[4:7], v[168:171]
  v_cvt_pk_bf16_f32 v208, v208, v209
  v_cvt_pk_bf16_f32 v178, v180, v181
  v_cvt_pk_bf16_f32 v76, v76, v77
  v_mfma_f32_16x16x32_bf16 v[168:171], a[120:123], a[8:11], v[168:171]
  v_accvgpr_write_b32 a66, v208
  v_cvt_pk_bf16_f32 v69, v70, v71
  v_mfma_f32_16x16x32_bf16 v[168:171], a[124:127], a[12:15], v[168:171]
  v_exp_f32 v161, v161
  v_subrev_u32 v249, 0x1c800000, v249
  v_cmp_lt_u32 s[66:67], s69, v249
  v_mfma_f32_16x16x32_bf16 v[172:175], a[140:143], a[12:15], v[192:195]
  v_cvt_pk_bf16_f32 v206, v206, v207
  v_cvt_pk_bf16_f32 v37, v38, v39
  v_mfma_f32_16x16x32_bf16 v[172:175], a[136:139], a[8:11], v[172:175]
  v_cvt_pk_bf16_f32 v216, v216, v217
  v_accvgpr_write_b32 a64, v212
  v_cvt_pk_bf16_f32 v210, v210, v211
  v_mfma_f32_16x16x32_bf16 v[172:175], a[132:135], a[4:7], v[172:175]
  v_accvgpr_write_b32 a59, v206
  v_cvt_pk_bf16_f32 v179, v182, v183
  v_cvt_pk_bf16_f32 v77, v78, v79
  v_mfma_f32_16x16x32_bf16 v[172:175], a[128:131], a[0:3], v[172:175]
  v_accvgpr_write_b32 a56, v216
  v_accvgpr_write_b32 a58, v204
  v_mfma_f32_16x16x32_bf16 v[196:199], a[232:235], a[16:19], 0
  v_exp_f32 v171, v171
  v_mfma_f32_16x16x32_bf16 v[196:199], a[236:239], a[20:23], v[196:199]
  v_exp_f32 v165, v165
  v_mfma_f32_16x16x32_bf16 v[196:199], a[240:243], a[24:27], v[196:199]
  ds_write2st64_b64 v245, v[36:37], v[52:53] offset0:8 offset1:12
  v_accvgpr_write_b32 a65, v214
  v_pk_mul_f32 v[96:97], v[96:97], v[248:249] op_sel_hi:[1,0]
  v_pk_mul_f32 v[98:99], v[98:99], v[248:249] op_sel_hi:[1,0]
  v_pk_mul_f32 v[112:113], v[112:113], v[248:249] op_sel_hi:[1,0]
  v_pk_mul_f32 v[114:115], v[114:115], v[248:249] op_sel_hi:[1,0]
  v_pk_mul_f32 v[100:101], v[100:101], v[248:249] op_sel_hi:[1,0]
  v_pk_mul_f32 v[102:103], v[102:103], v[248:249] op_sel_hi:[1,0]
  v_pk_mul_f32 v[116:117], v[116:117], v[248:249] op_sel_hi:[1,0]
  v_pk_mul_f32 v[118:119], v[118:119], v[248:249] op_sel_hi:[1,0]
  v_mfma_f32_16x16x32_bf16 v[196:199], a[244:247], a[28:31], v[196:199]
  v_exp_f32 v160, v160
  v_mfma_f32_16x16x16_bf16 v[216:219], a[248:249], a[60:61], 0
  v_exp_f32 v162, v162
  v_mfma_f32_16x16x16_bf16 v[216:219], a[250:251], a[60:61], v[216:219]
  ds_read_b32 v251, v250
  v_exp_f32 v170, v170
  v_mfma_f32_16x16x16_bf16 v[204:207], a[250:251], a[62:63], 0
  v_exp_f32 v169, v169
  v_cvt_pk_bf16_f32 v84, v84, v85
  v_mfma_f32_16x16x16_bf16 v[204:207], a[248:249], a[62:63], v[204:207]
  v_accvgpr_write_b32 a67, v210
  v_mov_b32 v183, 0
  s_waitcnt lgkmcnt(2)
  v_mfma_f32_16x16x16_bf16 v[212:215], a[248:249], a[68:69], 0
  v_exp_f32 v184, v184
  v_mfma_f32_16x16x16_bf16 v[212:215], a[250:251], a[68:69], v[212:215]
  v_cvt_pk_bf16_f32 v180, v184, v185
  v_cvt_pk_bf16_f32 v92, v92, v93
  v_mfma_f32_16x16x16_bf16 v[208:211], a[250:251], a[70:71], 0
  s_waitcnt lgkmcnt(0)
  v_cmp_gt_u32 vcc, v252, v251
  v_mfma_f32_16x16x16_bf16 v[208:211], a[248:249], a[70:71], v[208:211]
  ds_write2st64_b64 v247, v[44:45], v[60:61] offset0:8 offset1:12
  v_cvt_pk_bf16_f32 v72, v72, v73
  v_cvt_pk_bf16_f32 v96, v96, v97
  v_mfma_f32_16x16x32_bf16 v[128:131], a[144:147], v[176:179], v[128:131]
  s_cbranch_vccnz L_SPIN1
  L_BACK1:
  v_mfma_f32_16x16x32_bf16 v[132:135], a[148:151], v[176:179], v[132:135]
  ds_read_b64_tr_b16 a[144:145], v224 offset:0
  s_or_b64 s[36:37], s[36:37], s[66:67]
  v_mfma_f32_16x16x32_bf16 v[136:139], a[152:155], v[176:179], v[136:139]
  ds_read_b64_tr_b16 a[146:147], v224 offset:4096
  v_sub_f32 v197, 0xc2800000, v197
  v_mfma_f32_16x16x32_bf16 v[140:143], a[156:159], v[176:179], v[140:143]
  v_mov_b32 v182, 0
  v_cvt_pk_bf16_f32 v93, v94, v95
  v_mfma_f32_16x16x32_bf16 v[144:147], a[160:163], v[176:179], v[144:147]
  v_exp_f32 v166, v166
  v_mfma_f32_16x16x32_bf16 v[148:151], a[164:167], v[176:179], v[148:151]
  v_cvt_pk_bf16_f32 v181, v186, v187
  v_accvgpr_write_b32 a220, 0
  v_mfma_f32_16x16x32_bf16 v[152:155], a[168:171], v[176:179], v[152:155]
  v_exp_f32 v172, v172
  v_mfma_f32_16x16x32_bf16 v[156:159], a[172:175], v[176:179], v[156:159]
  ds_write2st64_b64 v247, v[76:77], v[92:93] offset0:16 offset1:20
  v_smfmac_f32_16x16x64_bf16 a[224:227], a[228:231], v[176:183], v254
  ds_read_b64_tr_b16 a[148:149], v225 offset:0
  v_cvt_pk_bf16_f32 v212, v212, v213
  v_accvgpr_write_b32 a68, v212
  v_mfma_f32_16x16x16_bf16 v[128:131], a[176:177], v[180:181], v[128:131]
  ds_read_b64_tr_b16 a[150:151], v225 offset:4096
  v_exp_f32 v164, v164
  v_mfma_f32_16x16x16_bf16 v[132:135], a[180:181], v[180:181], v[132:135]
  ds_read_b64_tr_b16 a[176:177], v224 offset:8192
  v_cvt_pk_bf16_f32 v208, v208, v209
  v_cvt_pk_bf16_f32 v210, v210, v211
  v_mfma_f32_16x16x16_bf16 v[136:139], a[184:185], v[180:181], v[136:139]
  ds_read_b64_tr_b16 a[180:181], v225 offset:8192
  v_accvgpr_write_b32 a71, v210
  v_mfma_f32_16x16x16_bf16 v[140:143], a[188:189], v[180:181], v[140:143]
  ds_read_b64_tr_b16 a[152:153], v226 offset:0
  v_cvt_pk_bf16_f32 v214, v214, v215
  v_exp_f32 v168, v168
  v_cvt_pk_bf16_f32 v112, v112, v113
  v_mfma_f32_16x16x16_bf16 v[144:147], a[192:193], v[180:181], v[144:147]
  ds_read_b64_tr_b16 a[178:179], v224 offset:12288
  v_sub_f32 v198, 0xc2800000, v198
  v_accvgpr_write_b32 a70, v208
  v_cvt_pk_bf16_f32 v160, v160, v161
  v_mfma_f32_16x16x16_bf16 v[148:151], a[196:197], v[180:181], v[148:151]
  ds_read_b64_tr_b16 a[182:183], v225 offset:12288
  v_accvgpr_write_b32 a213, 0
  v_mfma_f32_16x16x16_bf16 v[152:155], a[200:201], v[180:181], v[152:155]
  ds_read_b64_tr_b16 a[186:187], v226 offset:12288
  v_sub_f32 v199, 0xc2800000, v199
  v_mfma_f32_16x16x16_bf16 v[156:159], a[204:205], v[180:181], v[156:159]
  v_sub_f32 v196, 0xc2800000, v196
  v_accvgpr_write_b32 a69, v214
  v_mfma_f32_16x16x16_bf16 v[212:215], a[248:249], a[72:73], 0
  ds_read_b64_tr_b16 a[154:155], v226 offset:4096
  v_cvt_pk_bf16_f32 v218, v218, v219
  v_mfma_f32_16x16x16_bf16 v[212:215], a[250:251], a[72:73], v[212:215]
  ds_read_b64_tr_b16 a[184:185], v226 offset:8192
  v_exp_f32 v174, v174
  v_accvgpr_write_b32 a209, 0
  v_mfma_f32_16x16x16_bf16 v[208:211], a[250:251], a[74:75], 0
  v_exp_f32 v163, v163
  v_cvt_pk_bf16_f32 v64, v64, v65
  v_mfma_f32_16x16x16_bf16 v[208:211], a[248:249], a[74:75], v[208:211]
  ds_write2st64_b64 v246, v[40:41], v[56:57] offset0:8 offset1:12
  v_cvt_pk_bf16_f32 v97, v98, v99
  v_pk_mul_f32 v[104:105], v[104:105], v[248:249] op_sel_hi:[1,0]
  v_pk_mul_f32 v[106:107], v[106:107], v[248:249] op_sel_hi:[1,0]
  v_pk_mul_f32 v[120:121], v[120:121], v[248:249] op_sel_hi:[1,0]
  v_pk_mul_f32 v[122:123], v[122:123], v[248:249] op_sel_hi:[1,0]
  v_pk_mul_f32 v[108:109], v[108:109], v[248:249] op_sel_hi:[1,0]
  v_pk_mul_f32 v[110:111], v[110:111], v[248:249] op_sel_hi:[1,0]
  v_pk_mul_f32 v[124:125], v[124:125], v[248:249] op_sel_hi:[1,0]
  v_pk_mul_f32 v[126:127], v[126:127], v[248:249] op_sel_hi:[1,0]
  v_mfma_f32_16x16x32_bf16 v[176:179], a[80:83], a[16:19], v[196:199]
  ds_read_b64_tr_b16 a[190:191], v227 offset:12288
  v_cvt_pk_bf16_f32 v33, v34, v35
  v_mfma_f32_16x16x32_bf16 v[176:179], a[84:87], a[20:23], v[176:179]
  ds_read_b64_tr_b16 a[156:157], v227 offset:0
  v_cvt_pk_bf16_f32 v88, v88, v89
  v_mfma_f32_16x16x32_bf16 v[176:179], a[88:91], a[24:27], v[176:179]
  ds_read_b64_tr_b16 a[188:189], v227 offset:8192
  v_cvt_pk_bf16_f32 v214, v214, v215
  v_exp_f32 v175, v175
  v_mfma_f32_16x16x32_bf16 v[176:179], a[92:95], a[28:31], v[176:179]
  v_exp_f32 v167, v167
  v_mfma_f32_16x16x32_bf16 v[180:183], a[108:111], a[28:31], v[196:199]
  ds_read_b64_tr_b16 a[158:159], v227 offset:4096
  v_exp_f32 v173, v173
  v_accvgpr_read_b32 v249, a224
  v_mfma_f32_16x16x32_bf16 v[180:183], a[104:107], a[24:27], v[180:183]
  ds_read_b64_tr_b16 a[162:163], v228 offset:4096
  v_cvt_pk_bf16_f32 v206, v206, v207
  v_mfma_f32_16x16x32_bf16 v[180:183], a[100:103], a[20:23], v[180:183]
  ds_read_b64_tr_b16 a[196:197], v229 offset:8192
  v_accvgpr_write_b32 a73, v214
  v_mfma_f32_16x16x32_bf16 v[180:183], a[96:99], a[16:19], v[180:183]
  ds_write2st64_b64 v244, v[32:33], v[48:49] offset0:8 offset1:12
  v_mfma_f32_16x16x32_bf16 v[184:187], a[112:115], a[16:19], v[196:199]
  ds_read_b64_tr_b16 a[160:161], v228 offset:0
  v_cvt_pk_bf16_f32 v161, v162, v163
  v_cvt_pk_bf16_f32 v162, v164, v165
  v_mfma_f32_16x16x32_bf16 v[184:187], a[116:119], a[20:23], v[184:187]
  ds_read_b64_tr_b16 a[164:165], v229 offset:0
  v_cvt_pk_bf16_f32 v108, v108, v109
  v_mfma_f32_16x16x32_bf16 v[184:187], a[120:123], a[24:27], v[184:187]
  v_cvt_pk_bf16_f32 v163, v166, v167
  v_accvgpr_read_b32 v248, a225
  v_mfma_f32_16x16x32_bf16 v[184:187], a[124:127], a[28:31], v[184:187]
  ds_read_b64_tr_b16 a[192:193], v228 offset:8192
  v_cvt_pk_bf16_f32 v210, v210, v211
  v_accvgpr_write_b32 a75, v210
  v_mfma_f32_16x16x32_bf16 v[188:191], a[140:143], a[28:31], v[196:199]
  ds_read_b64_tr_b16 a[194:195], v228 offset:12288
  v_cvt_pk_bf16_f32 v113, v114, v115
  v_mfma_f32_16x16x32_bf16 v[188:191], a[136:139], a[24:27], v[188:191]
  v_cvt_pk_bf16_f32 v212, v212, v213
  v_accvgpr_write_b32 a72, v212
  v_cvt_pk_bf16_f32 v164, v168, v169
  v_mfma_f32_16x16x32_bf16 v[188:191], a[132:135], a[20:23], v[188:191]
  ds_read_b64_tr_b16 a[198:199], v229 offset:12288
  v_cvt_pk_bf16_f32 v208, v208, v209
  v_mfma_f32_16x16x32_bf16 v[188:191], a[128:131], a[16:19], v[188:191]
  ds_read_b64_tr_b16 a[166:167], v229 offset:4096
  v_add_f32 v249, v249, v248
  v_mfma_f32_16x16x32_bf16 v[200:203], a[232:235], a[32:35], 0
  ds_read_b64_tr_b16 a[168:169], v230 offset:0
  v_accvgpr_write_b32 a74, v208
  v_mfma_f32_16x16x32_bf16 v[200:203], a[236:239], a[36:39], v[200:203]
  ds_write2st64_b64 v244, v[96:97], v[112:113] offset0:24 offset1:28
  v_cvt_pk_bf16_f32 v109, v110, v111
  v_mfma_f32_16x16x32_bf16 v[200:203], a[240:243], a[40:43], v[200:203]
  v_cvt_pk_bf16_f32 v165, v170, v171
  v_cvt_pk_bf16_f32 v166, v172, v173
  v_mfma_f32_16x16x32_bf16 v[200:203], a[244:247], a[44:47], v[200:203]
  ds_read_b64_tr_b16 a[170:171], v230 offset:4096
  v_add_u32 v252, 1, v252
  v_cvt_pk_bf16_f32 v216, v216, v217
  v_cvt_pk_bf16_f32 v124, v124, v125
  v_mfma_f32_16x16x16_bf16 v[212:215], a[248:249], a[76:77], 0
  ds_read_b64_tr_b16 a[200:201], v230 offset:8192
  v_cvt_pk_bf16_f32 v85, v86, v87
  v_mfma_f32_16x16x16_bf16 v[212:215], a[250:251], a[76:77], v[212:215]
  v_exp_f32 v176, v176
  v_mfma_f32_16x16x16_bf16 v[208:211], a[250:251], a[78:79], 0
  ds_read_b64_tr_b16 a[202:203], v230 offset:12288
  v_exp_f32 v187, v187
  v_mfma_f32_16x16x16_bf16 v[208:211], a[248:249], a[78:79], v[208:211]
  ds_read_b64_tr_b16 a[172:173], v231 offset:0
  v_cvt_pk_bf16_f32 v167, v174, v175
  v_cvt_pk_bf16_f32 v125, v126, v127
  s_waitcnt lgkmcnt(4)
  v_mfma_f32_16x16x32_bf16 v[0:3], a[144:147], v[160:163], 0
  ds_read_b64_tr_b16 a[174:175], v231 offset:4096
  v_sub_f32 v202, 0xc2800000, v202
  v_exp_f32 v186, v186
  v_cvt_pk_bf16_f32 v65, v66, v67
  v_mfma_f32_16x16x32_bf16 v[0:3], a[176:179], v[164:167], v[0:3]
  ds_write2st64_b64 v245, v[68:69], v[84:85] offset0:16 offset1:20
  v_mfma_f32_16x16x32_bf16 v[4:7], a[180:183], v[164:167], 0
  ds_read_b64_tr_b16 a[204:205], v231 offset:8192
  v_sub_f32 v203, 0xc2800000, v203
  v_mfma_f32_16x16x32_bf16 v[4:7], a[148:151], v[160:163], v[4:7]
  ds_read_b64_tr_b16 a[206:207], v231 offset:12288
  v_cvt_pk_bf16_f32 v116, v116, v117
  v_mfma_f32_16x16x32_bf16 v[8:11], a[152:155], v[160:163], 0
  v_sub_f32 v200, 0xc2800000, v200
  v_cvt_pk_bf16_f32 v208, v208, v209
  v_mfma_f32_16x16x32_bf16 v[8:11], a[184:187], v[164:167], v[8:11]
  v_cvt_pk_bf16_f32 v73, v74, v75
  v_mfma_f32_16x16x32_bf16 v[12:15], a[188:191], v[164:167], 0
  v_accvgpr_write_b32 a60, v216
  v_cvt_pk_bf16_f32 v204, v204, v205
  v_exp_f32 v181, v181
  v_mfma_f32_16x16x32_bf16 v[12:15], a[156:159], v[160:163], v[12:15]
  v_exp_f32 v177, v177
  v_mfma_f32_16x16x32_bf16 v[16:19], a[160:163], v[160:163], 0
  ds_read_b128 a[252:255], v239 offset:0
  s_add_u32 m0, s30, 256
  v_mfma_f32_16x16x32_bf16 v[16:19], a[192:195], v[164:167], v[16:19]
  buffer_load_dwordx4 v236, s[20:23], s55 offen offset:0  lds
  v_mfma_f32_16x16x32_bf16 v[20:23], a[196:199], v[164:167], 0
  v_accvgpr_write_b32 a63, v206
  v_exp_f32 v178, v178
  v_mfma_f32_16x16x32_bf16 v[20:23], a[164:167], v[160:163], v[20:23]
  v_accvgpr_write_b32 a61, v218
  s_waitcnt lgkmcnt(1)
  v_mfma_f32_16x16x32_bf16 v[24:27], a[168:171], v[160:163], 0
  v_rcp_f32 v248, v249
  v_mfma_f32_16x16x32_bf16 v[24:27], a[200:203], v[164:167], v[24:27]
  ds_write2st64_b64 v247, v[108:109], v[124:125] offset0:24 offset1:28
  v_mfma_f32_16x16x32_bf16 v[28:31], a[204:207], v[164:167], 0
  v_exp_f32 v179, v179
  v_mfma_f32_16x16x32_bf16 v[28:31], a[172:175], v[160:163], v[28:31]
  v_sub_f32 v201, 0xc2800000, v201
  v_cvt_pk_bf16_f32 v176, v176, v177
  v_smfmac_f32_16x16x64_bf16 a[208:211], a[228:231], v[160:167], v254
  v_cvt_pk_bf16_f32 v212, v212, v213
  v_mfma_f32_16x16x32_bf16 v[160:163], a[80:83], a[32:35], v[200:203]
  v_cvt_pk_bf16_f32 v117, v118, v119
  v_subrev_u32 v249, 0x1c800000, v249
  v_mfma_f32_16x16x32_bf16 v[160:163], a[84:87], a[36:39], v[160:163]
  buffer_load_dwordx4 v237, s[20:23], s55 offen offset:1024  lds
  v_mfma_f32_16x16x32_bf16 v[160:163], a[88:91], a[40:43], v[160:163]
  v_exp_f32 v184, v184
  v_mfma_f32_16x16x32_bf16 v[160:163], a[92:95], a[44:47], v[160:163]
  v_exp_f32 v185, v185
  v_mfma_f32_16x16x32_bf16 v[164:167], a[108:111], a[44:47], v[200:203]
  v_exp_f32 v189, v189
  v_mfma_f32_16x16x32_bf16 v[164:167], a[104:107], a[40:43], v[164:167]
  v_exp_f32 v180, v180
  v_mfma_f32_16x16x32_bf16 v[164:167], a[100:103], a[36:39], v[164:167]
  v_cvt_pk_bf16_f32 v177, v178, v179
  v_cvt_pk_bf16_f32 v178, v180, v181
  v_mfma_f32_16x16x32_bf16 v[164:167], a[96:99], a[32:35], v[164:167]
  v_exp_f32 v183, v183
  v_mfma_f32_16x16x32_bf16 v[168:171], a[112:115], a[32:35], v[200:203]
  v_exp_f32 v182, v182
  v_mfma_f32_16x16x32_bf16 v[168:171], a[116:119], a[36:39], v[168:171]
  s_waitcnt lgkmcnt(0)
  buffer_store_dwordx4 a[252:255], v238, s[24:27], 0 offen offset:0
  v_cmp_lt_u32 s[66:67], s69, v249
  v_pk_mul_f32 v[128:129], v[128:129], v[248:249] op_sel_hi:[1,0]
  v_pk_mul_f32 v[130:131], v[130:131], v[248:249] op_sel_hi:[1,0]
  v_pk_mul_f32 v[144:145], v[144:145], v[248:249] op_sel_hi:[1,0]
  v_pk_mul_f32 v[146:147], v[146:147], v[248:249] op_sel_hi:[1,0]
  v_pk_mul_f32 v[132:133], v[132:133], v[248:249] op_sel_hi:[1,0]
  v_pk_mul_f32 v[134:135], v[134:135], v[248:249] op_sel_hi:[1,0]
  v_pk_mul_f32 v[148:149], v[148:149], v[248:249] op_sel_hi:[1,0]
  v_pk_mul_f32 v[150:151], v[150:151], v[248:249] op_sel_hi:[1,0]
  v_mfma_f32_16x16x32_bf16 v[168:171], a[120:123], a[40:43], v[168:171]
  v_accvgpr_write_b32 a62, v204
  v_cvt_pk_bf16_f32 v179, v182, v183
  v_mfma_f32_16x16x32_bf16 v[168:171], a[124:127], a[44:47], v[168:171]
  v_exp_f32 v160, v160
  v_mfma_f32_16x16x32_bf16 v[172:175], a[140:143], a[44:47], v[200:203]
  v_cvt_pk_bf16_f32 v180, v184, v185
  v_cvt_pk_bf16_f32 v181, v186, v187
  v_mfma_f32_16x16x32_bf16 v[172:175], a[136:139], a[40:43], v[172:175]
  v_exp_f32 v190, v190
  v_mfma_f32_16x16x32_bf16 v[172:175], a[132:135], a[36:39], v[172:175]
  buffer_load_dwordx4 v236, s[20:23], s55 offen offset:2048  lds
  v_accvgpr_write_b32 a78, v208
  v_mfma_f32_16x16x32_bf16 v[172:175], a[128:131], a[32:35], v[172:175]
  v_exp_f32 v188, v188
  v_exp_f32 v191, v191
  v_mfma_f32_16x16x32_bf16 v[204:207], a[232:235], a[48:51], 0
  v_cvt_pk_bf16_f32 v182, v188, v189
  v_cvt_pk_bf16_f32 v183, v190, v191
  v_accvgpr_write_b32 a221, 0
  v_mfma_f32_16x16x32_bf16 v[204:207], a[236:239], a[52:55], v[204:207]
  v_exp_f32 v171, v171
  v_mfma_f32_16x16x32_bf16 v[204:207], a[240:243], a[56:59], v[204:207]
  v_cvt_pk_bf16_f32 v89, v90, v91
  v_cvt_pk_bf16_f32 v132, v132, v133
  v_mfma_f32_16x16x32_bf16 v[204:207], a[244:247], a[60:63], v[204:207]
  v_cvt_pk_bf16_f32 v214, v214, v215
  v_cvt_pk_bf16_f32 v120, v120, v121
  v_mfma_f32_16x16x32_bf16 v[32:35], a[144:147], v[176:179], 0
  v_exp_f32 v163, v163
  v_mfma_f32_16x16x32_bf16 v[32:35], a[176:179], v[180:183], v[32:35]
  v_exp_f32 v164, v164
  v_mfma_f32_16x16x32_bf16 v[36:39], a[180:183], v[180:183], 0
  buffer_load_dwordx4 v237, s[20:23], s55 offen offset:3072  lds
  v_mfma_f32_16x16x32_bf16 v[36:39], a[148:151], v[176:179], v[36:39]
  v_exp_f32 v174, v174
  v_mfma_f32_16x16x32_bf16 v[40:43], a[152:155], v[176:179], 0
  s_add_u32 s39, s38, 20447232
  v_cvt_pk_bf16_f32 v148, v148, v149
  v_mfma_f32_16x16x32_bf16 v[40:43], a[184:187], v[180:183], v[40:43]
  v_exp_f32 v161, v161
  v_cvt_pk_bf16_f32 v100, v100, v101
  v_mfma_f32_16x16x32_bf16 v[44:47], a[188:191], v[180:183], 0
  v_sub_f32 v204, 0xc2800000, v204
  v_cvt_pk_bf16_f32 v101, v102, v103
  v_mfma_f32_16x16x32_bf16 v[44:47], a[156:159], v[176:179], v[44:47]
  v_exp_f32 v172, v172
  v_mfma_f32_16x16x32_bf16 v[48:51], a[160:163], v[176:179], 0
  v_sub_f32 v205, 0xc2800000, v205
  v_sub_f32 v206, 0xc2800000, v206
  v_mfma_f32_16x16x32_bf16 v[48:51], a[192:195], v[180:183], v[48:51]
  v_exp_f32 v162, v162
  v_mfma_f32_16x16x32_bf16 v[52:55], a[196:199], v[180:183], 0
  ds_write2st64_b64 v245, v[100:101], v[116:117] offset0:24 offset1:28
  v_mfma_f32_16x16x32_bf16 v[52:55], a[164:167], v[176:179], v[52:55]
  v_exp_f32 v165, v165
  v_mfma_f32_16x16x32_bf16 v[56:59], a[168:171], v[176:179], 0
  s_add_u32 s12, s4, s39
  s_addc_u32 s13, s5, 0
  v_mfma_f32_16x16x32_bf16 v[56:59], a[200:203], v[180:183], v[56:59]
  v_cvt_pk_bf16_f32 v160, v160, v161
  v_exp_f32 v170, v170
  v_accvgpr_write_b32 a225, 0
  v_mfma_f32_16x16x32_bf16 v[60:63], a[204:207], v[180:183], 0
  v_sub_f32 v207, 0xc2800000, v207
  v_cvt_pk_bf16_f32 v144, v144, v145
  v_mfma_f32_16x16x32_bf16 v[60:63], a[172:175], v[176:179], v[60:63]
  s_cmp_lt_u32 s32, 3
  s_cselect_b32 s40, -1, 0
  v_smfmac_f32_16x16x64_bf16 a[212:215], a[228:231], v[176:183], v254
  ds_write2st64_b64 v246, v[72:73], v[88:89] offset0:16 offset1:20
  v_mfma_f32_16x16x32_bf16 v[176:179], a[80:83], a[48:51], v[204:207]
  v_exp_f32 v169, v169
  v_mfma_f32_16x16x32_bf16 v[176:179], a[84:87], a[52:55], v[176:179]
  v_cvt_pk_bf16_f32 v210, v210, v211
  v_exp_f32 v167, v167
  v_mfma_f32_16x16x32_bf16 v[176:179], a[88:91], a[56:59], v[176:179]
  v_exp_f32 v166, v166
  v_accvgpr_write_b32 a224, 0
  v_mfma_f32_16x16x32_bf16 v[176:179], a[92:95], a[60:63], v[176:179]
  v_cvt_pk_bf16_f32 v161, v162, v163
  v_cvt_pk_bf16_f32 v104, v104, v105
  v_mfma_f32_16x16x32_bf16 v[180:183], a[108:111], a[60:63], v[204:207]
  s_and_b32 s14, s49, s40
  v_accvgpr_write_b32 a77, v214
  v_mfma_f32_16x16x32_bf16 v[180:183], a[104:107], a[56:59], v[180:183]
  ds_read_b128 a[252:255], v255 offset:512
  v_accvgpr_write_b32 a79, v210
  v_mfma_f32_16x16x32_bf16 v[180:183], a[100:103], a[52:55], v[180:183]
  ds_write2st64_b64 v244, v[64:65], v[80:81] offset0:16 offset1:20
  v_pk_mul_f32 v[136:137], v[136:137], v[248:249] op_sel_hi:[1,0]
  v_pk_mul_f32 v[138:139], v[138:139], v[248:249] op_sel_hi:[1,0]
  v_pk_mul_f32 v[152:153], v[152:153], v[248:249] op_sel_hi:[1,0]
  v_pk_mul_f32 v[154:155], v[154:155], v[248:249] op_sel_hi:[1,0]
  v_pk_mul_f32 v[140:141], v[140:141], v[248:249] op_sel_hi:[1,0]
  v_pk_mul_f32 v[142:143], v[142:143], v[248:249] op_sel_hi:[1,0]
  v_pk_mul_f32 v[156:157], v[156:157], v[248:249] op_sel_hi:[1,0]
  v_pk_mul_f32 v[158:159], v[158:159], v[248:249] op_sel_hi:[1,0]
  v_mfma_f32_16x16x32_bf16 v[180:183], a[96:99], a[48:51], v[180:183]
  v_exp_f32 v175, v175
  v_mfma_f32_16x16x32_bf16 v[184:187], a[112:115], a[48:51], v[204:207]
  v_cvt_pk_bf16_f32 v162, v164, v165
  v_cvt_pk_bf16_f32 v152, v152, v153
  v_mfma_f32_16x16x32_bf16 v[184:187], a[116:119], a[52:55], v[184:187]
  v_cvt_pk_bf16_f32 v163, v166, v167
  v_cvt_pk_bf16_f32 v105, v106, v107
  v_mfma_f32_16x16x32_bf16 v[184:187], a[120:123], a[56:59], v[184:187]
  v_exp_f32 v173, v173
  v_mfma_f32_16x16x32_bf16 v[184:187], a[124:127], a[60:63], v[184:187]
  v_exp_f32 v168, v168
  v_mfma_f32_16x16x32_bf16 v[188:191], a[140:143], a[60:63], v[204:207]
  v_cvt_pk_bf16_f32 v121, v122, v123
  v_cvt_pk_bf16_f32 v128, v128, v129
  v_mfma_f32_16x16x32_bf16 v[188:191], a[136:139], a[56:59], v[188:191]
  v_accvgpr_write_b32 a76, v212
  v_cvt_pk_bf16_f32 v164, v168, v169
  v_exp_f32 v178, v178
  v_mfma_f32_16x16x32_bf16 v[188:191], a[132:135], a[52:55], v[188:191]
  s_waitcnt vmcnt(15)
  ds_write_b32 v253, v252
  v_cvt_pk_bf16_f32 v165, v170, v171
  v_mfma_f32_16x16x32_bf16 v[188:191], a[128:131], a[48:51], v[188:191]
  s_add_u32 m0, s31, 0
  v_cvt_pk_bf16_f32 v166, v172, v173
  v_mfma_f32_16x16x32_bf16 v[208:211], a[232:235], a[64:67], 0
  v_exp_f32 v183, v183
  v_mfma_f32_16x16x32_bf16 v[208:211], a[236:239], a[68:71], v[208:211]
  v_exp_f32 v182, v182
  v_mfma_f32_16x16x32_bf16 v[208:211], a[240:243], a[72:75], v[208:211]
  v_cvt_pk_bf16_f32 v167, v174, v175
  v_exp_f32 v181, v181
  v_mfma_f32_16x16x32_bf16 v[208:211], a[244:247], a[76:79], v[208:211]
  v_exp_f32 v187, v187
  v_mfma_f32_16x16x32_bf16 v[64:67], a[144:147], v[160:163], 0
  v_exp_f32 v188, v188
  v_mfma_f32_16x16x32_bf16 v[64:67], a[176:179], v[164:167], v[64:67]
  ds_write2st64_b64 v246, v[104:105], v[120:121] offset0:24 offset1:28
  v_mfma_f32_16x16x32_bf16 v[68:71], a[180:183], v[164:167], 0
  v_exp_f32 v191, v191
  v_mfma_f32_16x16x32_bf16 v[68:71], a[148:151], v[160:163], v[68:71]
  v_exp_f32 v180, v180
  v_mfma_f32_16x16x32_bf16 v[72:75], a[152:155], v[160:163], 0
  v_sub_f32 v208, 0xc2800000, v208
  v_cvt_pk_bf16_f32 v140, v140, v141
  v_mfma_f32_16x16x32_bf16 v[72:75], a[184:187], v[164:167], v[72:75]
  v_exp_f32 v186, v186
  v_mfma_f32_16x16x32_bf16 v[76:79], a[188:191], v[164:167], 0
  v_sub_f32 v211, 0xc2800000, v211
  v_exp_f32 v177, v177
  v_mfma_f32_16x16x32_bf16 v[76:79], a[156:159], v[160:163], v[76:79]
  s_waitcnt lgkmcnt(0)
  buffer_load_dwordx4 v232, s[12:15], 0 offen offset:0 nt lds
  v_sub_f32 v209, 0xc2800000, v209
  v_mfma_f32_16x16x32_bf16 v[80:83], a[160:163], v[160:163], 0
  v_exp_f32 v176, v176
  v_mfma_f32_16x16x32_bf16 v[80:83], a[192:195], v[164:167], v[80:83]
  v_exp_f32 v190, v190
  v_mfma_f32_16x16x32_bf16 v[84:87], a[196:199], v[164:167], 0
  ds_read_b32 v251, v250
  v_cvt_pk_bf16_f32 v141, v142, v143
  v_mfma_f32_16x16x32_bf16 v[84:87], a[164:167], v[160:163], v[84:87]
  v_sub_f32 v210, 0xc2800000, v210
  v_cvt_pk_bf16_f32 v176, v176, v177
  v_mfma_f32_16x16x32_bf16 v[88:91], a[168:171], v[160:163], 0
  v_exp_f32 v189, v189
  v_mfma_f32_16x16x32_bf16 v[88:91], a[200:203], v[164:167], v[88:91]
  v_exp_f32 v179, v179
  v_cvt_pk_bf16_f32 v145, v146, v147
  v_mfma_f32_16x16x32_bf16 v[92:95], a[204:207], v[164:167], 0
  s_waitcnt lgkmcnt(0)
  v_cmp_gt_u32 vcc, v252, v251
  v_cvt_pk_bf16_f32 v177, v178, v179
  v_mfma_f32_16x16x32_bf16 v[92:95], a[172:175], v[160:163], v[92:95]
  buffer_store_dwordx4 a[252:255], v238, s[24:27], 0 offen offset:1024
  v_smfmac_f32_16x16x64_bf16 a[216:219], a[228:231], v[160:167], v254
  v_cvt_pk_bf16_f32 v178, v180, v181
  v_mfma_f32_16x16x32_bf16 v[160:163], a[80:83], a[64:67], v[208:211]
  s_cbranch_vccnz L_SPIN2
  L_BACK2:
  v_mfma_f32_16x16x32_bf16 v[160:163], a[84:87], a[68:71], v[160:163]
  ds_read_b128 a[80:83], v220 offset:32768
  v_exp_f32 v184, v184
  v_mfma_f32_16x16x32_bf16 v[160:163], a[88:91], a[72:75], v[160:163]
  ds_read_b128 a[84:87], v221 offset:32768
  v_cvt_pk_bf16_f32 v129, v130, v131
  v_mfma_f32_16x16x32_bf16 v[160:163], a[92:95], a[76:79], v[160:163]
  ds_read_b128 a[88:91], v222 offset:32768
  s_add_u32 m0, s30, 16640
  v_mfma_f32_16x16x32_bf16 v[164:167], a[108:111], a[76:79], v[208:211]
  buffer_load_dwordx4 v232, s[16:19], s56 offen offset:0 nt lds
  v_cvt_pk_bf16_f32 v156, v156, v157
  v_mfma_f32_16x16x32_bf16 v[164:167], a[104:107], a[72:75], v[164:167]
  ds_read_b128 a[104:107], v222 offset:36864
  v_exp_f32 v185, v185
  v_mfma_f32_16x16x32_bf16 v[164:167], a[100:103], a[68:71], v[164:167]
  ds_read_b128 a[108:111], v223 offset:36864
  v_cvt_pk_bf16_f32 v153, v154, v155
  v_mfma_f32_16x16x32_bf16 v[164:167], a[96:99], a[64:67], v[164:167]
  ds_read_b128 a[92:95], v223 offset:32768
  v_cvt_pk_bf16_f32 v179, v182, v183
  v_mfma_f32_16x16x32_bf16 v[168:171], a[112:115], a[64:67], v[208:211]
  ds_read_b128 a[96:99], v220 offset:36864
  v_cvt_pk_bf16_f32 v180, v184, v185
  v_mfma_f32_16x16x32_bf16 v[168:171], a[116:119], a[68:71], v[168:171]
  ds_read_b128 a[112:115], v220 offset:40960
  v_cvt_pk_bf16_f32 v181, v186, v187
  v_mfma_f32_16x16x32_bf16 v[168:171], a[120:123], a[72:75], v[168:171]
  ds_read_b128 a[100:103], v221 offset:36864
  ds_read_b128 a[120:123], v222 offset:40960
  v_mfma_f32_16x16x32_bf16 v[168:171], a[124:127], a[76:79], v[168:171]
  ds_read_b128 a[116:119], v221 offset:40960
  ds_read_b128 a[124:127], v223 offset:40960
  v_cvt_pk_bf16_f32 v182, v188, v189
  v_mfma_f32_16x16x32_bf16 v[172:175], a[140:143], a[76:79], v[208:211]
  ds_read_b128 a[140:143], v223 offset:45056
  v_add_u32 v252, 1, v252
  v_mfma_f32_16x16x32_bf16 v[172:175], a[136:139], a[72:75], v[172:175]
  buffer_load_dwordx4 v233, s[16:19], s56 offen offset:1024 nt lds
  v_mfma_f32_16x16x32_bf16 v[172:175], a[132:135], a[68:71], v[172:175]
  ds_read_b128 a[136:139], v222 offset:45056
  ds_read_b128 a[132:135], v221 offset:45056
  v_mfma_f32_16x16x32_bf16 v[172:175], a[128:131], a[64:67], v[172:175]
  ds_read_b128 a[128:131], v220 offset:45056
  v_cvt_pk_bf16_f32 v183, v190, v191
  v_mfma_f32_16x16x32_bf16 v[96:99], a[144:147], v[176:179], 0
  v_exp_f32 v160, v160
  v_mfma_f32_16x16x32_bf16 v[96:99], a[176:179], v[180:183], v[96:99]
  v_exp_f32 v162, v162
  v_mfma_f32_16x16x32_bf16 v[100:103], a[180:183], v[180:183], 0
  ds_write2st64_b64 v244, v[128:129], v[144:145] offset0:32 offset1:36
  v_mfma_f32_16x16x32_bf16 v[100:103], a[148:151], v[176:179], v[100:103]
  v_exp_f32 v163, v163
  v_mfma_f32_16x16x32_bf16 v[104:107], a[152:155], v[176:179], 0
  v_exp_f32 v164, v164
  v_mfma_f32_16x16x32_bf16 v[104:107], a[184:187], v[180:183], v[104:107]
  buffer_load_dwordx4 v234, s[16:19], s56 offen offset:2048 nt lds
  v_cvt_pk_bf16_f32 v136, v136, v137
  v_mfma_f32_16x16x32_bf16 v[108:111], a[188:191], v[180:183], 0
  v_exp_f32 v165, v165
  v_cvt_pk_bf16_f32 v157, v158, v159
  v_mfma_f32_16x16x32_bf16 v[108:111], a[156:159], v[176:179], v[108:111]
  v_exp_f32 v171, v171
  v_mfma_f32_16x16x32_bf16 v[112:115], a[160:163], v[176:179], 0
  v_exp_f32 v161, v161
  v_mfma_f32_16x16x32_bf16 v[112:115], a[192:195], v[180:183], v[112:115]
  v_exp_f32 v168, v168
  v_cvt_pk_bf16_f32 v137, v138, v139
  v_mfma_f32_16x16x32_bf16 v[116:119], a[196:199], v[180:183], 0
  s_waitcnt vmcnt(15) lgkmcnt(0)
  ds_write_b32 v253, v252
  v_mfma_f32_16x16x32_bf16 v[116:119], a[164:167], v[176:179], v[116:119]
  v_exp_f32 v174, v174
  v_mfma_f32_16x16x32_bf16 v[120:123], a[168:171], v[176:179], 0
  v_exp_f32 v169, v169
  v_mfma_f32_16x16x32_bf16 v[120:123], a[200:203], v[180:183], v[120:123]
  v_exp_f32 v170, v170
  v_mfma_f32_16x16x32_bf16 v[124:127], a[204:207], v[180:183], 0
  buffer_load_dwordx4 v235, s[16:19], s56 offen offset:3072 nt lds
  v_mfma_f32_16x16x32_bf16 v[124:127], a[172:175], v[176:179], v[124:127]
  s_or_b64 s[36:37], s[36:37], s[66:67]
  v_cvt_pk_bf16_f32 v149, v150, v151
  v_smfmac_f32_16x16x64_bf16 a[220:223], a[228:231], v[176:183], v254
  v_cvt_pk_bf16_f32 v133, v134, v135
  v_mfma_f32_16x16x32_bf16 v[176:179], a[80:83], a[0:3], v[192:195]
  v_exp_f32 v167, v167
  v_mfma_f32_16x16x32_bf16 v[176:179], a[84:87], a[4:7], v[176:179]
  v_exp_f32 v166, v166
  v_mfma_f32_16x16x32_bf16 v[176:179], a[88:91], a[8:11], v[176:179]
  v_exp_f32 v175, v175
  v_mfma_f32_16x16x32_bf16 v[176:179], a[92:95], a[12:15], v[176:179]
  ds_write2st64_b64 v246, v[136:137], v[152:153] offset0:32 offset1:36
  v_mfma_f32_16x16x32_bf16 v[180:183], a[108:111], a[12:15], v[192:195]
  v_cvt_pk_bf16_f32 v160, v160, v161
  v_cvt_pk_bf16_f32 v161, v162, v163
  v_mfma_f32_16x16x32_bf16 v[180:183], a[104:107], a[8:11], v[180:183]
  v_cvt_pk_bf16_f32 v162, v164, v165
  v_cvt_pk_bf16_f32 v163, v166, v167
  v_mfma_f32_16x16x32_bf16 v[180:183], a[100:103], a[4:7], v[180:183]
  v_exp_f32 v173, v173
  v_mfma_f32_16x16x32_bf16 v[180:183], a[96:99], a[0:3], v[180:183]
  ds_write2st64_b64 v247, v[140:141], v[156:157] offset0:32 offset1:36
  v_mfma_f32_16x16x32_bf16 v[184:187], a[112:115], a[0:3], v[192:195]
  ds_read_b32 v251, v250
  s_add_u32 m0, s31, 0
  v_mfma_f32_16x16x32_bf16 v[184:187], a[116:119], a[4:7], v[184:187]
  v_exp_f32 v172, v172
  v_mfma_f32_16x16x32_bf16 v[184:187], a[120:123], a[8:11], v[184:187]
  v_exp_f32 v177, v177
  v_mfma_f32_16x16x32_bf16 v[184:187], a[124:127], a[12:15], v[184:187]
  ds_write2st64_b64 v245, v[132:133], v[148:149] offset0:32 offset1:36
  v_mfma_f32_16x16x32_bf16 v[188:191], a[140:143], a[12:15], v[192:195]
  v_cvt_pk_bf16_f32 v164, v168, v169
  v_cvt_pk_bf16_f32 v165, v170, v171
  v_mfma_f32_16x16x32_bf16 v[188:191], a[136:139], a[8:11], v[188:191]
  v_cvt_pk_bf16_f32 v166, v172, v173
  v_cvt_pk_bf16_f32 v167, v174, v175
  v_mfma_f32_16x16x32_bf16 v[188:191], a[132:135], a[4:7], v[188:191]
  s_waitcnt lgkmcnt(1)
  v_cmp_gt_u32 vcc, v252, v251
  L_ENTRY:
  v_mfma_f32_16x16x32_bf16 v[188:191], a[128:131], a[0:3], v[188:191]
  buffer_load_dwordx4 v234, s[12:15], 0 offen offset:2048 nt lds
  v_mfma_f32_16x16x32_bf16 v[128:131], a[144:147], v[160:163], 0
  s_cbranch_vccnz L_SPIN3
  L_BACK3:
  v_mfma_f32_16x16x32_bf16 v[128:131], a[176:179], v[164:167], v[128:131]
  v_exp_f32 v176, v176
  v_mfma_f32_16x16x32_bf16 v[132:135], a[180:183], v[164:167], 0
  ds_read_b64_tr_b16 a[144:145], v224 offset:32768
  ds_read_b64_tr_b16 a[176:177], v224 offset:40960
  v_mfma_f32_16x16x32_bf16 v[132:135], a[148:151], v[160:163], v[132:135]
  ds_read_b64_tr_b16 a[148:149], v225 offset:32768
  v_cvt_pk_bf16_f32 v176, v176, v177
  v_mfma_f32_16x16x32_bf16 v[136:139], a[152:155], v[160:163], 0
  ds_read_b64_tr_b16 a[146:147], v224 offset:36864
  v_exp_f32 v186, v186
  v_mfma_f32_16x16x32_bf16 v[136:139], a[184:187], v[164:167], v[136:139]
  ds_read_b64_tr_b16 a[180:181], v225 offset:40960
  v_exp_f32 v191, v191
  v_mfma_f32_16x16x32_bf16 v[140:143], a[188:191], v[164:167], 0
  ds_read_b64_tr_b16 a[182:183], v225 offset:45056
  ds_read_b64_tr_b16 a[152:153], v226 offset:32768
  v_mfma_f32_16x16x32_bf16 v[140:143], a[156:159], v[160:163], v[140:143]
  ds_read_b64_tr_b16 a[150:151], v225 offset:36864
  ds_read_b64_tr_b16 a[154:155], v226 offset:36864
  v_mfma_f32_16x16x32_bf16 v[144:147], a[160:163], v[160:163], 0
  ds_read_b64_tr_b16 a[178:179], v224 offset:45056
  v_exp_f32 v182, v182
  v_mfma_f32_16x16x32_bf16 v[144:147], a[192:195], v[164:167], v[144:147]
  ds_read_b64_tr_b16 a[184:185], v226 offset:40960
  ds_read_b64_tr_b16 a[186:187], v226 offset:45056
  v_mfma_f32_16x16x32_bf16 v[148:151], a[196:199], v[164:167], 0
  v_exp_f32 v178, v178
  v_mfma_f32_16x16x32_bf16 v[148:151], a[164:167], v[160:163], v[148:151]
  v_exp_f32 v179, v179
  v_mfma_f32_16x16x32_bf16 v[152:155], a[168:171], v[160:163], 0
  v_exp_f32 v180, v180
  v_mfma_f32_16x16x32_bf16 v[152:155], a[200:203], v[164:167], v[152:155]
  v_exp_f32 v181, v181
  v_mfma_f32_16x16x32_bf16 v[156:159], a[204:207], v[164:167], 0
  ds_read_b64_tr_b16 a[190:191], v227 offset:45056
  v_cvt_pk_bf16_f32 v177, v178, v179
  v_mfma_f32_16x16x32_bf16 v[156:159], a[172:175], v[160:163], v[156:159]
  v_exp_f32 v184, v184
  v_smfmac_f32_16x16x64_bf16 a[224:227], a[228:231], v[160:167], v254
  ds_read_b64_tr_b16 a[156:157], v227 offset:32768
  v_mfma_f32_16x16x32_bf16 v[160:163], a[80:83], a[16:19], v[196:199]
  ds_read_b64_tr_b16 a[188:189], v227 offset:40960
  ds_read_b64_tr_b16 a[192:193], v228 offset:40960
  v_mfma_f32_16x16x32_bf16 v[160:163], a[84:87], a[20:23], v[160:163]
  v_exp_f32 v188, v188
  v_mfma_f32_16x16x32_bf16 v[160:163], a[88:91], a[24:27], v[160:163]
  ds_read_b64_tr_b16 a[158:159], v227 offset:36864
  v_exp_f32 v183, v183
  v_mfma_f32_16x16x32_bf16 v[160:163], a[92:95], a[28:31], v[160:163]
  ds_read_b64_tr_b16 a[162:163], v228 offset:36864
  v_cvt_pk_bf16_f32 v178, v180, v181
  v_mfma_f32_16x16x32_bf16 v[164:167], a[108:111], a[28:31], v[196:199]
  v_exp_f32 v185, v185
  v_mfma_f32_16x16x32_bf16 v[164:167], a[104:107], a[24:27], v[164:167]
  ds_read_b64_tr_b16 a[160:161], v228 offset:32768
  ds_read_b64_tr_b16 a[194:195], v228 offset:45056
  v_mfma_f32_16x16x32_bf16 v[164:167], a[100:103], a[20:23], v[164:167]
  ds_read_b64_tr_b16 a[196:197], v229 offset:40960
  ds_read_b64_tr_b16 a[164:165], v229 offset:32768
  v_mfma_f32_16x16x32_bf16 v[164:167], a[96:99], a[16:19], v[164:167]
  v_exp_f32 v187, v187
  v_mfma_f32_16x16x32_bf16 v[168:171], a[112:115], a[16:19], v[196:199]
  ds_read_b64_tr_b16 a[198:199], v229 offset:45056
  v_cvt_pk_bf16_f32 v179, v182, v183
  v_mfma_f32_16x16x32_bf16 v[168:171], a[116:119], a[20:23], v[168:171]
  v_exp_f32 v189, v189
  v_mfma_f32_16x16x32_bf16 v[168:171], a[120:123], a[24:27], v[168:171]
  ds_read_b64_tr_b16 a[166:167], v229 offset:36864
  v_cvt_pk_bf16_f32 v180, v184, v185
  v_mfma_f32_16x16x32_bf16 v[168:171], a[124:127], a[28:31], v[168:171]
  ds_read_b64_tr_b16 a[200:201], v230 offset:40960
  v_cvt_pk_bf16_f32 v181, v186, v187
  v_mfma_f32_16x16x32_bf16 v[172:175], a[140:143], a[28:31], v[196:199]
  ds_read_b64_tr_b16 a[168:169], v230 offset:32768
  v_cvt_pk_bf16_f32 v182, v188, v189
  v_mfma_f32_16x16x32_bf16 v[172:175], a[136:139], a[24:27], v[172:175]
  v_exp_f32 v190, v190
  v_mfma_f32_16x16x32_bf16 v[172:175], a[132:135], a[20:23], v[172:175]
  ds_read_b64_tr_b16 a[170:171], v230 offset:36864
  v_cvt_pk_bf16_f32 v183, v190, v191
  v_mfma_f32_16x16x32_bf16 v[172:175], a[128:131], a[16:19], v[172:175]
  ds_read_b64_tr_b16 a[172:173], v231 offset:32768
  s_waitcnt lgkmcnt(5)
  v_mfma_f32_16x16x32_bf16 v[0:3], a[144:147], v[176:179], v[0:3]
  ds_read_b64_tr_b16 a[174:175], v231 offset:36864
  v_add_u32 v220, 0x4000, v220
  v_mfma_f32_16x16x32_bf16 v[0:3], a[176:179], v[180:183], v[0:3]
  ds_read_b64_tr_b16 a[202:203], v230 offset:45056
  v_mfma_f32_16x16x32_bf16 v[4:7], a[180:183], v[180:183], v[4:7]
  v_exp_f32 v170, v170
  v_mfma_f32_16x16x32_bf16 v[4:7], a[148:151], v[176:179], v[4:7]
  ds_read_b64_tr_b16 a[204:205], v231 offset:40960
  ds_read_b64_tr_b16 a[206:207], v231 offset:45056
  v_mfma_f32_16x16x32_bf16 v[8:11], a[152:155], v[176:179], v[8:11]
  v_exp_f32 v169, v169
  v_mfma_f32_16x16x32_bf16 v[8:11], a[184:187], v[180:183], v[8:11]
  ds_read_b128 a[252:255], v239 offset:1024
  v_mfma_f32_16x16x32_bf16 v[12:15], a[188:191], v[180:183], v[12:15]
  v_exp_f32 v175, v175
  v_mfma_f32_16x16x32_bf16 v[12:15], a[156:159], v[176:179], v[12:15]
  v_exp_f32 v165, v165
  v_mfma_f32_16x16x32_bf16 v[16:19], a[160:163], v[176:179], v[16:19]
  s_add_u32 m0, s30, 33024
  v_mfma_f32_16x16x32_bf16 v[16:19], a[192:195], v[180:183], v[16:19]
  buffer_load_dwordx4 v236, s[20:23], s56 offen offset:0  lds
  v_mfma_f32_16x16x32_bf16 v[20:23], a[196:199], v[180:183], v[20:23]
  s_cmp_lg_u64 s[36:37], 0
  s_cselect_b32 s46, 1, 0
  s_waitcnt lgkmcnt(1)
  v_mfma_f32_16x16x32_bf16 v[20:23], a[164:167], v[176:179], v[20:23]
  s_lshl_b32 s46, s46, s32
  v_mfma_f32_16x16x32_bf16 v[24:27], a[168:171], v[176:179], v[24:27]
  v_exp_f32 v161, v161
  v_mfma_f32_16x16x32_bf16 v[24:27], a[200:203], v[180:183], v[24:27]
  v_exp_f32 v163, v163
  v_mfma_f32_16x16x32_bf16 v[28:31], a[204:207], v[180:183], v[28:31]
  v_exp_f32 v173, v173
  v_mfma_f32_16x16x32_bf16 v[28:31], a[172:175], v[176:179], v[28:31]
  s_or_b32 s35, s35, s46
  s_mov_b64 s[36:37], 0
  v_smfmac_f32_16x16x64_bf16 a[208:211], a[228:231], v[176:183], v254
  v_add_u32 v222, 0x4000, v222
  v_mfma_f32_16x16x32_bf16 v[176:179], a[80:83], a[32:35], v[200:203]
  buffer_load_dwordx4 v237, s[20:23], s56 offen offset:1024  lds
  v_mfma_f32_16x16x32_bf16 v[176:179], a[84:87], a[36:39], v[176:179]
  v_exp_f32 v168, v168
  v_mfma_f32_16x16x32_bf16 v[176:179], a[88:91], a[40:43], v[176:179]
  v_exp_f32 v162, v162
  v_mfma_f32_16x16x32_bf16 v[176:179], a[92:95], a[44:47], v[176:179]
  v_exp_f32 v160, v160
  v_mfma_f32_16x16x32_bf16 v[180:183], a[108:111], a[44:47], v[200:203]
  v_exp_f32 v164, v164
  v_mfma_f32_16x16x32_bf16 v[180:183], a[104:107], a[40:43], v[180:183]
  v_exp_f32 v166, v166
  v_mfma_f32_16x16x32_bf16 v[180:183], a[100:103], a[36:39], v[180:183]
  s_waitcnt lgkmcnt(0)
  buffer_store_dwordx4 a[252:255], v238, s[24:27], 0 offen offset:2048
  v_mfma_f32_16x16x32_bf16 v[180:183], a[96:99], a[32:35], v[180:183]
  v_exp_f32 v174, v174
  v_mfma_f32_16x16x32_bf16 v[184:187], a[112:115], a[32:35], v[200:203]
  v_exp_f32 v172, v172
  v_mfma_f32_16x16x32_bf16 v[184:187], a[116:119], a[36:39], v[184:187]
  v_exp_f32 v167, v167
  v_mfma_f32_16x16x32_bf16 v[184:187], a[120:123], a[40:43], v[184:187]
  v_cvt_pk_bf16_f32 v160, v160, v161
  v_cvt_pk_bf16_f32 v161, v162, v163
  v_mfma_f32_16x16x32_bf16 v[184:187], a[124:127], a[44:47], v[184:187]
  v_exp_f32 v171, v171
  v_mfma_f32_16x16x32_bf16 v[188:191], a[140:143], a[44:47], v[200:203]
  v_cvt_pk_bf16_f32 v162, v164, v165
  v_cvt_pk_bf16_f32 v163, v166, v167
  v_mfma_f32_16x16x32_bf16 v[188:191], a[136:139], a[40:43], v[188:191]
  v_cvt_pk_bf16_f32 v164, v168, v169
  v_cvt_pk_bf16_f32 v165, v170, v171
  v_mfma_f32_16x16x32_bf16 v[188:191], a[132:135], a[36:39], v[188:191]
  buffer_load_dwordx4 v236, s[20:23], s56 offen offset:2048  lds
  v_mfma_f32_16x16x32_bf16 v[188:191], a[128:131], a[32:35], v[188:191]
  v_cvt_pk_bf16_f32 v166, v172, v173
  v_cvt_pk_bf16_f32 v167, v174, v175
  v_mfma_f32_16x16x32_bf16 v[32:35], a[144:147], v[160:163], v[32:35]
  v_exp_f32 v177, v177
  v_mfma_f32_16x16x32_bf16 v[32:35], a[176:179], v[164:167], v[32:35]
  v_exp_f32 v181, v181
  v_mfma_f32_16x16x32_bf16 v[36:39], a[180:183], v[164:167], v[36:39]
  v_exp_f32 v179, v179
  v_mfma_f32_16x16x32_bf16 v[36:39], a[148:151], v[160:163], v[36:39]
  v_add_u32 v221, 0x4000, v221
  v_mfma_f32_16x16x32_bf16 v[40:43], a[152:155], v[160:163], v[40:43]
  v_exp_f32 v190, v190
  v_mfma_f32_16x16x32_bf16 v[40:43], a[184:187], v[164:167], v[40:43]
  v_exp_f32 v183, v183
  v_mfma_f32_16x16x32_bf16 v[44:47], a[188:191], v[164:167], v[44:47]
  v_exp_f32 v186, v186
  v_mfma_f32_16x16x32_bf16 v[44:47], a[156:159], v[160:163], v[44:47]
  v_exp_f32 v191, v191
  v_mfma_f32_16x16x32_bf16 v[48:51], a[160:163], v[160:163], v[48:51]
  buffer_load_dwordx4 v237, s[20:23], s56 offen offset:3072  lds
  v_mfma_f32_16x16x32_bf16 v[48:51], a[192:195], v[164:167], v[48:51]
  v_exp_f32 v185, v185
  v_mfma_f32_16x16x32_bf16 v[52:55], a[196:199], v[164:167], v[52:55]
  v_exp_f32 v188, v188
  v_mfma_f32_16x16x32_bf16 v[52:55], a[164:167], v[160:163], v[52:55]
  v_exp_f32 v176, v176
  v_mfma_f32_16x16x32_bf16 v[56:59], a[168:171], v[160:163], v[56:59]
  v_exp_f32 v182, v182
  v_mfma_f32_16x16x32_bf16 v[56:59], a[200:203], v[164:167], v[56:59]
  v_add_u32 v225, 0xffffc000, v225
  v_mfma_f32_16x16x32_bf16 v[60:63], a[204:207], v[164:167], v[60:63]
  v_exp_f32 v178, v178
  v_mfma_f32_16x16x32_bf16 v[60:63], a[172:175], v[160:163], v[60:63]
  v_exp_f32 v189, v189
  v_smfmac_f32_16x16x64_bf16 a[212:215], a[228:231], v[160:167], v254
  v_cvt_pk_bf16_f32 v176, v176, v177
  v_mfma_f32_16x16x32_bf16 v[160:163], a[80:83], a[48:51], v[204:207]
  ds_read_b128 a[252:255], v255 offset:1536
  v_mfma_f32_16x16x32_bf16 v[160:163], a[84:87], a[52:55], v[160:163]
  v_exp_f32 v180, v180
  v_mfma_f32_16x16x32_bf16 v[160:163], a[88:91], a[56:59], v[160:163]
  v_add_u32 v252, 1, v252
  v_cvt_pk_bf16_f32 v177, v178, v179
  v_mfma_f32_16x16x32_bf16 v[160:163], a[92:95], a[60:63], v[160:163]
  v_add_u32 v224, 0xffffc000, v224
  v_cvt_pk_bf16_f32 v178, v180, v181
  v_mfma_f32_16x16x32_bf16 v[164:167], a[108:111], a[60:63], v[204:207]
  v_exp_f32 v184, v184
  v_mfma_f32_16x16x32_bf16 v[164:167], a[104:107], a[56:59], v[164:167]
  v_add_u32 v230, 0xffffc000, v230
  v_mfma_f32_16x16x32_bf16 v[164:167], a[100:103], a[52:55], v[164:167]
  v_add_u32 v223, 0x4000, v223
  v_add_u32 v229, 0xffffc000, v229
  v_mfma_f32_16x16x32_bf16 v[164:167], a[96:99], a[48:51], v[164:167]
  v_exp_f32 v187, v187
  v_mfma_f32_16x16x32_bf16 v[168:171], a[112:115], a[48:51], v[204:207]
  v_cvt_pk_bf16_f32 v179, v182, v183
  v_cvt_pk_bf16_f32 v180, v184, v185
  v_mfma_f32_16x16x32_bf16 v[168:171], a[116:119], a[52:55], v[168:171]
  s_waitcnt vmcnt(15)
  ds_write_b32 v253, v252
  v_mfma_f32_16x16x32_bf16 v[168:171], a[120:123], a[56:59], v[168:171]
  s_add_u32 m0, s31, 0
  v_cvt_pk_bf16_f32 v181, v186, v187
  v_mfma_f32_16x16x32_bf16 v[168:171], a[124:127], a[60:63], v[168:171]
  v_cvt_pk_bf16_f32 v182, v188, v189
  v_cvt_pk_bf16_f32 v183, v190, v191
  v_mfma_f32_16x16x32_bf16 v[172:175], a[140:143], a[60:63], v[204:207]
  v_exp_f32 v165, v165
  v_mfma_f32_16x16x32_bf16 v[172:175], a[136:139], a[56:59], v[172:175]
  v_exp_f32 v161, v161
  v_mfma_f32_16x16x32_bf16 v[172:175], a[132:135], a[52:55], v[172:175]
  v_exp_f32 v160, v160
  v_mfma_f32_16x16x32_bf16 v[172:175], a[128:131], a[48:51], v[172:175]
  v_exp_f32 v163, v163
  v_mfma_f32_16x16x32_bf16 v[64:67], a[144:147], v[176:179], v[64:67]
  v_exp_f32 v164, v164
  v_mfma_f32_16x16x32_bf16 v[64:67], a[176:179], v[180:183], v[64:67]
  v_exp_f32 v166, v166
  v_mfma_f32_16x16x32_bf16 v[68:71], a[180:183], v[180:183], v[68:71]
  v_exp_f32 v167, v167
  v_mfma_f32_16x16x32_bf16 v[68:71], a[148:151], v[176:179], v[68:71]
  s_waitcnt lgkmcnt(0)
  buffer_load_dwordx4 v233, s[12:15], 0 offen offset:1024 nt lds
  v_mfma_f32_16x16x32_bf16 v[72:75], a[152:155], v[176:179], v[72:75]
  v_exp_f32 v169, v169
  v_mfma_f32_16x16x32_bf16 v[72:75], a[184:187], v[180:183], v[72:75]
  v_exp_f32 v170, v170
  v_mfma_f32_16x16x32_bf16 v[76:79], a[188:191], v[180:183], v[76:79]
  v_exp_f32 v162, v162
  v_mfma_f32_16x16x32_bf16 v[76:79], a[156:159], v[176:179], v[76:79]
  v_exp_f32 v174, v174
  v_mfma_f32_16x16x32_bf16 v[80:83], a[160:163], v[176:179], v[80:83]
  v_add_u32 v231, 0xffffc000, v231
  v_mfma_f32_16x16x32_bf16 v[80:83], a[192:195], v[180:183], v[80:83]
  ds_read_b32 v251, v250
  v_cvt_pk_bf16_f32 v160, v160, v161
  v_mfma_f32_16x16x32_bf16 v[84:87], a[196:199], v[180:183], v[84:87]
  v_exp_f32 v168, v168
  v_mfma_f32_16x16x32_bf16 v[84:87], a[164:167], v[176:179], v[84:87]
  v_exp_f32 v171, v171
  v_mfma_f32_16x16x32_bf16 v[88:91], a[168:171], v[176:179], v[88:91]
  v_exp_f32 v172, v172
  v_mfma_f32_16x16x32_bf16 v[88:91], a[200:203], v[180:183], v[88:91]
  buffer_store_dwordx4 a[252:255], v238, s[24:27], 0 offen offset:3072
  v_mfma_f32_16x16x32_bf16 v[92:95], a[204:207], v[180:183], v[92:95]
  v_exp_f32 v175, v175
  v_mfma_f32_16x16x32_bf16 v[92:95], a[172:175], v[176:179], v[92:95]
  s_waitcnt lgkmcnt(0)
  v_cmp_gt_u32 vcc, v252, v251
  v_smfmac_f32_16x16x64_bf16 a[216:219], a[228:231], v[176:183], v254
  v_cvt_pk_bf16_f32 v161, v162, v163
  v_mfma_f32_16x16x32_bf16 v[176:179], a[80:83], a[64:67], v[208:211]
  s_cbranch_vccnz L_SPIN4
  L_BACK4:
  v_mfma_f32_16x16x32_bf16 v[176:179], a[84:87], a[68:71], v[176:179]
  ds_read_b128 a[84:87], v221 offset:49152
  v_cvt_pk_bf16_f32 v162, v164, v165
  v_mfma_f32_16x16x32_bf16 v[176:179], a[88:91], a[72:75], v[176:179]
  ds_read_b128 a[88:91], v222 offset:49152
  s_add_u32 m0, s30, 49408
  v_mfma_f32_16x16x32_bf16 v[176:179], a[92:95], a[76:79], v[176:179]
  ds_read_b128 a[80:83], v220 offset:49152
  v_cvt_pk_bf16_f32 v163, v166, v167
  v_mfma_f32_16x16x32_bf16 v[180:183], a[108:111], a[76:79], v[208:211]
  buffer_load_dwordx4 v232, s[16:19], s57 offen offset:0 nt lds
  v_mfma_f32_16x16x32_bf16 v[180:183], a[104:107], a[72:75], v[180:183]
  v_exp_f32 v173, v173
  v_mfma_f32_16x16x32_bf16 v[180:183], a[100:103], a[68:71], v[180:183]
  ds_read_b128 a[92:95], v223 offset:49152
  v_cvt_pk_bf16_f32 v164, v168, v169
  v_mfma_f32_16x16x32_bf16 v[180:183], a[96:99], a[64:67], v[180:183]
  ds_read_b128 a[96:99], v220 offset:53248
  v_cvt_pk_bf16_f32 v165, v170, v171
  v_mfma_f32_16x16x32_bf16 v[184:187], a[112:115], a[64:67], v[208:211]
  ds_read_b128 a[108:111], v223 offset:53248
  ds_read_b128 a[104:107], v222 offset:53248
  v_mfma_f32_16x16x32_bf16 v[184:187], a[116:119], a[68:71], v[184:187]
  ds_read_b128 a[100:103], v221 offset:53248
  v_cvt_pk_bf16_f32 v166, v172, v173
  v_mfma_f32_16x16x32_bf16 v[184:187], a[120:123], a[72:75], v[184:187]
  ds_read_b128 a[112:115], v220 offset:57344
  v_cvt_pk_bf16_f32 v167, v174, v175
  v_mfma_f32_16x16x32_bf16 v[184:187], a[124:127], a[76:79], v[184:187]
  buffer_load_dwordx4 v233, s[16:19], s57 offen offset:1024 nt lds
  v_mfma_f32_16x16x32_bf16 v[188:191], a[140:143], a[76:79], v[208:211]
  ds_read_b128 a[116:119], v221 offset:57344
  v_add_u32 v227, 0xffffc000, v227
  v_mfma_f32_16x16x32_bf16 v[188:191], a[136:139], a[72:75], v[188:191]
  ds_read_b128 a[124:127], v223 offset:57344
  ds_read_b128 a[136:139], v222 offset:61440
  v_mfma_f32_16x16x32_bf16 v[188:191], a[132:135], a[68:71], v[188:191]
  ds_read_b128 a[120:123], v222 offset:57344
  ds_read_b128 a[140:143], v223 offset:61440
  v_mfma_f32_16x16x32_bf16 v[188:191], a[128:131], a[64:67], v[188:191]
  ds_read_b128 a[132:135], v221 offset:61440
  ds_read_b128 a[128:131], v220 offset:61440
  v_mfma_f32_16x16x32_bf16 v[96:99], a[144:147], v[160:163], v[96:99]
  v_exp_f32 v187, v187
  v_mfma_f32_16x16x32_bf16 v[96:99], a[176:179], v[164:167], v[96:99]
  v_exp_f32 v180, v180
  v_mfma_f32_16x16x32_bf16 v[100:103], a[180:183], v[164:167], v[100:103]
  v_exp_f32 v186, v186
  v_mfma_f32_16x16x32_bf16 v[100:103], a[148:151], v[160:163], v[100:103]
  buffer_load_dwordx4 v234, s[16:19], s57 offen offset:2048 nt lds
  v_mfma_f32_16x16x32_bf16 v[104:107], a[152:155], v[160:163], v[104:107]
  v_exp_f32 v189, v189
  v_mfma_f32_16x16x32_bf16 v[104:107], a[184:187], v[164:167], v[104:107]
  v_exp_f32 v177, v177
  v_mfma_f32_16x16x32_bf16 v[108:111], a[188:191], v[164:167], v[108:111]
  v_exp_f32 v179, v179
  v_mfma_f32_16x16x32_bf16 v[108:111], a[156:159], v[160:163], v[108:111]
  v_exp_f32 v185, v185
  v_mfma_f32_16x16x32_bf16 v[112:115], a[160:163], v[160:163], v[112:115]
  v_exp_f32 v188, v188
  v_mfma_f32_16x16x32_bf16 v[112:115], a[192:195], v[164:167], v[112:115]
  v_add_u32 v252, 1, v252
  v_add_u32 v228, 0xffffc000, v228
  v_mfma_f32_16x16x32_bf16 v[116:119], a[196:199], v[164:167], v[116:119]
  v_exp_f32 v178, v178
  v_mfma_f32_16x16x32_bf16 v[116:119], a[164:167], v[160:163], v[116:119]
  s_waitcnt vmcnt(16) lgkmcnt(0)
  ds_write_b32 v253, v252
  v_mfma_f32_16x16x32_bf16 v[120:123], a[168:171], v[160:163], v[120:123]
  v_exp_f32 v176, v176
  v_mfma_f32_16x16x32_bf16 v[120:123], a[200:203], v[164:167], v[120:123]
  v_exp_f32 v183, v183
  v_mfma_f32_16x16x32_bf16 v[124:127], a[204:207], v[164:167], v[124:127]
  v_exp_f32 v191, v191
  v_mfma_f32_16x16x32_bf16 v[124:127], a[172:175], v[160:163], v[124:127]
  v_cvt_pk_bf16_f32 v176, v176, v177
  v_cvt_pk_bf16_f32 v177, v178, v179
  v_smfmac_f32_16x16x64_bf16 a[220:223], a[228:231], v[160:167], v254
  v_mfma_f32_16x16x32_bf16 v[160:163], a[80:83], a[0:3], v[192:195]
  v_exp_f32 v190, v190
  v_mfma_f32_16x16x32_bf16 v[160:163], a[84:87], a[4:7], v[160:163]
  v_exp_f32 v182, v182
  v_mfma_f32_16x16x32_bf16 v[160:163], a[88:91], a[8:11], v[160:163]
  buffer_load_dwordx4 v235, s[16:19], s57 offen offset:3072 nt lds
  v_mfma_f32_16x16x32_bf16 v[160:163], a[92:95], a[12:15], v[160:163]
  v_exp_f32 v181, v181
  v_mfma_f32_16x16x32_bf16 v[164:167], a[108:111], a[12:15], v[192:195]
  v_exp_f32 v184, v184
  v_mfma_f32_16x16x32_bf16 v[164:167], a[104:107], a[8:11], v[164:167]
  v_cvt_pk_bf16_f32 v178, v180, v181
  v_mfma_f32_16x16x32_bf16 v[164:167], a[100:103], a[4:7], v[164:167]
  s_add_u32 m0, s31, 0
  v_cvt_pk_bf16_f32 v179, v182, v183
  v_mfma_f32_16x16x32_bf16 v[164:167], a[96:99], a[0:3], v[164:167]
  ds_read_b32 v251, v250
  v_cvt_pk_bf16_f32 v180, v184, v185
  v_mfma_f32_16x16x32_bf16 v[168:171], a[112:115], a[0:3], v[192:195]
  v_exp_f32 v160, v160
  v_mfma_f32_16x16x32_bf16 v[168:171], a[116:119], a[4:7], v[168:171]
  v_exp_f32 v161, v161
  v_mfma_f32_16x16x32_bf16 v[168:171], a[120:123], a[8:11], v[168:171]
  v_add_u32 v226, 0xffffc000, v226
  v_cvt_pk_bf16_f32 v181, v186, v187
  v_mfma_f32_16x16x32_bf16 v[168:171], a[124:127], a[12:15], v[168:171]
  v_exp_f32 v162, v162
  v_mfma_f32_16x16x32_bf16 v[172:175], a[140:143], a[12:15], v[192:195]
  v_exp_f32 v163, v163
  v_mfma_f32_16x16x32_bf16 v[172:175], a[136:139], a[8:11], v[172:175]
  s_waitcnt lgkmcnt(0)
  v_cmp_gt_u32 vcc, v252, v251
  v_mfma_f32_16x16x32_bf16 v[172:175], a[132:135], a[4:7], v[172:175]
  v_cvt_pk_bf16_f32 v182, v188, v189
  v_cvt_pk_bf16_f32 v183, v190, v191
  v_mfma_f32_16x16x32_bf16 v[172:175], a[128:131], a[0:3], v[172:175]
  buffer_load_dwordx4 v235, s[12:15], 0 offen offset:3072 nt lds
  v_mfma_f32_16x16x32_bf16 v[128:131], a[144:147], v[176:179], v[128:131]
  s_cbranch_vccnz L_SPIN5
  L_BACK5:
  v_mfma_f32_16x16x32_bf16 v[128:131], a[176:179], v[180:183], v[128:131]
  v_exp_f32 v166, v166
  v_mfma_f32_16x16x32_bf16 v[132:135], a[180:183], v[180:183], v[132:135]
  ds_read_b64_tr_b16 a[146:147], v224 offset:4096
  v_mfma_f32_16x16x32_bf16 v[132:135], a[148:151], v[176:179], v[132:135]
  ds_read_b64_tr_b16 a[144:145], v224 offset:0
  ds_read_b64_tr_b16 a[176:177], v224 offset:8192
  v_mfma_f32_16x16x32_bf16 v[136:139], a[152:155], v[176:179], v[136:139]
  ds_read_b64_tr_b16 a[180:181], v225 offset:8192
  ds_read_b64_tr_b16 a[150:151], v225 offset:4096
  v_mfma_f32_16x16x32_bf16 v[136:139], a[184:187], v[180:183], v[136:139]
  ds_read_b64_tr_b16 a[182:183], v225 offset:12288
  ds_read_b64_tr_b16 a[148:149], v225 offset:0
  v_mfma_f32_16x16x32_bf16 v[140:143], a[188:191], v[180:183], v[140:143]
  v_exp_f32 v164, v164
  v_mfma_f32_16x16x32_bf16 v[140:143], a[156:159], v[176:179], v[140:143]
  v_exp_f32 v174, v174
  v_mfma_f32_16x16x32_bf16 v[144:147], a[160:163], v[176:179], v[144:147]
  ds_read_b64_tr_b16 a[178:179], v224 offset:12288
  ds_read_b64_tr_b16 a[154:155], v226 offset:4096
  v_mfma_f32_16x16x32_bf16 v[144:147], a[192:195], v[180:183], v[144:147]
  v_exp_f32 v165, v165
  v_mfma_f32_16x16x32_bf16 v[148:151], a[196:199], v[180:183], v[148:151]
  ds_read_b64_tr_b16 a[184:185], v226 offset:8192
  v_cvt_pk_bf16_f32 v160, v160, v161
  v_mfma_f32_16x16x32_bf16 v[148:151], a[164:167], v[176:179], v[148:151]
  v_exp_f32 v169, v169
  v_mfma_f32_16x16x32_bf16 v[152:155], a[168:171], v[176:179], v[152:155]
  ds_read_b64_tr_b16 a[152:153], v226 offset:0
  ds_read_b64_tr_b16 a[186:187], v226 offset:12288
  v_mfma_f32_16x16x32_bf16 v[152:155], a[200:203], v[180:183], v[152:155]
  ds_read_b64_tr_b16 a[188:189], v227 offset:8192
  v_mfma_f32_16x16x32_bf16 v[156:159], a[204:207], v[180:183], v[156:159]
  ds_read_b64_tr_b16 a[190:191], v227 offset:12288
  v_cvt_pk_bf16_f32 v161, v162, v163
  v_mfma_f32_16x16x32_bf16 v[156:159], a[172:175], v[176:179], v[156:159]
  v_exp_f32 v175, v175
  v_smfmac_f32_16x16x64_bf16 a[224:227], a[228:231], v[176:183], v254
  ds_read_b64_tr_b16 a[160:161], v228 offset:0
  v_mfma_f32_16x16x32_bf16 v[176:179], a[80:83], a[16:19], v[196:199]
  ds_read_b64_tr_b16 a[162:163], v228 offset:4096
  v_cvt_pk_bf16_f32 v162, v164, v165
  v_mfma_f32_16x16x32_bf16 v[176:179], a[84:87], a[20:23], v[176:179]
  ds_read_b64_tr_b16 a[156:157], v227 offset:0
  ds_read_b64_tr_b16 a[192:193], v228 offset:8192
  v_mfma_f32_16x16x32_bf16 v[176:179], a[88:91], a[24:27], v[176:179]
  v_exp_f32 v170, v170
  v_mfma_f32_16x16x32_bf16 v[176:179], a[92:95], a[28:31], v[176:179]
  ds_read_b64_tr_b16 a[158:159], v227 offset:4096
  ds_read_b64_tr_b16 a[194:195], v228 offset:12288
  v_mfma_f32_16x16x32_bf16 v[180:183], a[108:111], a[28:31], v[196:199]
  v_exp_f32 v167, v167
  v_mfma_f32_16x16x32_bf16 v[180:183], a[104:107], a[24:27], v[180:183]
  v_exp_f32 v168, v168
  v_mfma_f32_16x16x32_bf16 v[180:183], a[100:103], a[20:23], v[180:183]
  v_exp_f32 v173, v173
  v_mfma_f32_16x16x32_bf16 v[180:183], a[96:99], a[16:19], v[180:183]
  v_exp_f32 v172, v172
  v_mfma_f32_16x16x32_bf16 v[184:187], a[112:115], a[16:19], v[196:199]
  ds_read_b64_tr_b16 a[198:199], v229 offset:12288
  v_cvt_pk_bf16_f32 v163, v166, v167
  v_mfma_f32_16x16x32_bf16 v[184:187], a[116:119], a[20:23], v[184:187]
  ds_read_b64_tr_b16 a[196:197], v229 offset:8192
  ds_read_b64_tr_b16 a[168:169], v230 offset:0
  v_mfma_f32_16x16x32_bf16 v[184:187], a[120:123], a[24:27], v[184:187]
  ds_read_b64_tr_b16 a[170:171], v230 offset:4096
  v_cvt_pk_bf16_f32 v164, v168, v169
  v_mfma_f32_16x16x32_bf16 v[184:187], a[124:127], a[28:31], v[184:187]
  v_exp_f32 v171, v171
  v_mfma_f32_16x16x32_bf16 v[188:191], a[140:143], a[28:31], v[196:199]
  ds_read_b64_tr_b16 a[164:165], v229 offset:0
  v_cvt_pk_bf16_f32 v165, v170, v171
  v_mfma_f32_16x16x32_bf16 v[188:191], a[136:139], a[24:27], v[188:191]
  ds_read_b64_tr_b16 a[166:167], v229 offset:4096
  v_cvt_pk_bf16_f32 v166, v172, v173
  v_mfma_f32_16x16x32_bf16 v[188:191], a[132:135], a[20:23], v[188:191]
  ds_read_b64_tr_b16 a[206:207], v231 offset:12288
  v_cvt_pk_bf16_f32 v167, v174, v175
  v_mfma_f32_16x16x32_bf16 v[188:191], a[128:131], a[16:19], v[188:191]
  ds_read_b64_tr_b16 a[200:201], v230 offset:8192
  s_waitcnt lgkmcnt(5)
  v_mfma_f32_16x16x32_bf16 v[0:3], a[144:147], v[160:163], v[0:3]
  ds_read_b64_tr_b16 a[202:203], v230 offset:12288
  v_mfma_f32_16x16x32_bf16 v[0:3], a[176:179], v[164:167], v[0:3]
  ds_read_b64_tr_b16 a[174:175], v231 offset:4096
  v_mfma_f32_16x16x32_bf16 v[4:7], a[180:183], v[164:167], v[4:7]
  ds_read_b64_tr_b16 a[204:205], v231 offset:8192
  v_mfma_f32_16x16x32_bf16 v[4:7], a[148:151], v[160:163], v[4:7]
  ds_read_b64_tr_b16 a[172:173], v231 offset:0
  v_mfma_f32_16x16x32_bf16 v[8:11], a[152:155], v[160:163], v[8:11]
  v_exp_f32 v179, v179
  v_mfma_f32_16x16x32_bf16 v[8:11], a[184:187], v[164:167], v[8:11]
  ds_read_b128 a[252:255], v239 offset:4096
  v_mfma_f32_16x16x32_bf16 v[12:15], a[188:191], v[164:167], v[12:15]
  v_exp_f32 v190, v190
  v_mfma_f32_16x16x32_bf16 v[12:15], a[156:159], v[160:163], v[12:15]
  v_exp_f32 v178, v178
  v_mfma_f32_16x16x32_bf16 v[16:19], a[160:163], v[160:163], v[16:19]
  s_add_u32 m0, s30, 65792
  v_mfma_f32_16x16x32_bf16 v[16:19], a[192:195], v[164:167], v[16:19]
  buffer_load_dwordx4 v236, s[20:23], s57 offen offset:0  lds
  v_mfma_f32_16x16x32_bf16 v[20:23], a[196:199], v[164:167], v[20:23]
  v_exp_f32 v184, v184
  s_waitcnt lgkmcnt(1)
  v_mfma_f32_16x16x32_bf16 v[20:23], a[164:167], v[160:163], v[20:23]
  v_mfma_f32_16x16x32_bf16 v[24:27], a[168:171], v[160:163], v[24:27]
  v_exp_f32 v183, v183
  v_mfma_f32_16x16x32_bf16 v[24:27], a[200:203], v[164:167], v[24:27]
  v_exp_f32 v182, v182
  v_mfma_f32_16x16x32_bf16 v[28:31], a[204:207], v[164:167], v[28:31]
  v_exp_f32 v187, v187
  v_mfma_f32_16x16x32_bf16 v[28:31], a[172:175], v[160:163], v[28:31]
  v_exp_f32 v180, v180
  v_smfmac_f32_16x16x64_bf16 a[208:211], a[228:231], v[160:167], v254
  v_mfma_f32_16x16x32_bf16 v[160:163], a[80:83], a[32:35], v[200:203]
  buffer_load_dwordx4 v237, s[20:23], s57 offen offset:1024  lds
  v_mfma_f32_16x16x32_bf16 v[160:163], a[84:87], a[36:39], v[160:163]
  v_exp_f32 v189, v189
  v_mfma_f32_16x16x32_bf16 v[160:163], a[88:91], a[40:43], v[160:163]
  v_exp_f32 v177, v177
  v_mfma_f32_16x16x32_bf16 v[160:163], a[92:95], a[44:47], v[160:163]
  v_exp_f32 v188, v188
  v_mfma_f32_16x16x32_bf16 v[164:167], a[108:111], a[44:47], v[200:203]
  v_exp_f32 v176, v176
  v_mfma_f32_16x16x32_bf16 v[164:167], a[104:107], a[40:43], v[164:167]
  v_exp_f32 v181, v181
  v_mfma_f32_16x16x32_bf16 v[164:167], a[100:103], a[36:39], v[164:167]
  v_cvt_pk_bf16_f32 v176, v176, v177
  v_mfma_f32_16x16x32_bf16 v[164:167], a[96:99], a[32:35], v[164:167]
  s_waitcnt lgkmcnt(0)
  buffer_store_dwordx4 a[252:255], v238, s[24:27], s42 offen offset:0
  v_mfma_f32_16x16x32_bf16 v[168:171], a[112:115], a[32:35], v[200:203]
  v_exp_f32 v185, v185
  v_mfma_f32_16x16x32_bf16 v[168:171], a[116:119], a[36:39], v[168:171]
  v_cvt_pk_bf16_f32 v177, v178, v179
  v_mfma_f32_16x16x32_bf16 v[168:171], a[120:123], a[40:43], v[168:171]
  v_cvt_pk_bf16_f32 v178, v180, v181
  v_cvt_pk_bf16_f32 v179, v182, v183
  v_mfma_f32_16x16x32_bf16 v[168:171], a[124:127], a[44:47], v[168:171]
  v_exp_f32 v191, v191
  v_mfma_f32_16x16x32_bf16 v[172:175], a[140:143], a[44:47], v[200:203]
  v_exp_f32 v186, v186
  v_mfma_f32_16x16x32_bf16 v[172:175], a[136:139], a[40:43], v[172:175]
  v_cvt_pk_bf16_f32 v180, v184, v185
  v_cvt_pk_bf16_f32 v181, v186, v187
  v_mfma_f32_16x16x32_bf16 v[172:175], a[132:135], a[36:39], v[172:175]
  v_cvt_pk_bf16_f32 v182, v188, v189
  v_cvt_pk_bf16_f32 v183, v190, v191
  v_mfma_f32_16x16x32_bf16 v[172:175], a[128:131], a[32:35], v[172:175]
  buffer_load_dwordx4 v236, s[20:23], s57 offen offset:2048  lds
  v_mfma_f32_16x16x32_bf16 v[32:35], a[144:147], v[176:179], v[32:35]
  v_exp_f32 v170, v170
  v_mfma_f32_16x16x32_bf16 v[32:35], a[176:179], v[180:183], v[32:35]
  v_exp_f32 v163, v163
  v_mfma_f32_16x16x32_bf16 v[36:39], a[180:183], v[180:183], v[36:39]
  v_exp_f32 v166, v166
  v_mfma_f32_16x16x32_bf16 v[36:39], a[148:151], v[176:179], v[36:39]
  v_mfma_f32_16x16x32_bf16 v[40:43], a[152:155], v[176:179], v[40:43]
  v_mfma_f32_16x16x32_bf16 v[40:43], a[184:187], v[180:183], v[40:43]
  v_exp_f32 v160, v160
  v_mfma_f32_16x16x32_bf16 v[44:47], a[188:191], v[180:183], v[44:47]
  v_exp_f32 v168, v168
  v_mfma_f32_16x16x32_bf16 v[44:47], a[156:159], v[176:179], v[44:47]
  v_exp_f32 v161, v161
  v_mfma_f32_16x16x32_bf16 v[48:51], a[160:163], v[176:179], v[48:51]
  v_mfma_f32_16x16x32_bf16 v[48:51], a[192:195], v[180:183], v[48:51]
  buffer_load_dwordx4 v237, s[20:23], s57 offen offset:3072  lds
  v_mfma_f32_16x16x32_bf16 v[52:55], a[196:199], v[180:183], v[52:55]
  v_exp_f32 v164, v164
  v_mfma_f32_16x16x32_bf16 v[52:55], a[164:167], v[176:179], v[52:55]
  v_exp_f32 v165, v165
  v_mfma_f32_16x16x32_bf16 v[56:59], a[168:171], v[176:179], v[56:59]
  v_exp_f32 v162, v162
  v_mfma_f32_16x16x32_bf16 v[56:59], a[200:203], v[180:183], v[56:59]
  v_exp_f32 v167, v167
  v_mfma_f32_16x16x32_bf16 v[60:63], a[204:207], v[180:183], v[60:63]
  v_exp_f32 v171, v171
  v_mfma_f32_16x16x32_bf16 v[60:63], a[172:175], v[176:179], v[60:63]
  v_exp_f32 v169, v169
  v_smfmac_f32_16x16x64_bf16 a[212:215], a[228:231], v[176:183], v254
  v_mfma_f32_16x16x32_bf16 v[176:179], a[80:83], a[48:51], v[204:207]
  v_cvt_pk_bf16_f32 v160, v160, v161
  v_cvt_pk_bf16_f32 v161, v162, v163
  v_mfma_f32_16x16x32_bf16 v[176:179], a[84:87], a[52:55], v[176:179]
  ds_read_b128 a[252:255], v255 offset:4608
  v_cvt_pk_bf16_f32 v162, v164, v165
  v_mfma_f32_16x16x32_bf16 v[176:179], a[88:91], a[56:59], v[176:179]
  v_exp_f32 v174, v174
  v_mfma_f32_16x16x32_bf16 v[176:179], a[92:95], a[60:63], v[176:179]
  v_add_u32 v252, 1, v252
  v_cvt_pk_bf16_f32 v163, v166, v167
  v_mfma_f32_16x16x32_bf16 v[180:183], a[108:111], a[60:63], v[204:207]
  v_exp_f32 v172, v172
  v_mfma_f32_16x16x32_bf16 v[180:183], a[104:107], a[56:59], v[180:183]
  v_exp_f32 v175, v175
  v_mfma_f32_16x16x32_bf16 v[180:183], a[100:103], a[52:55], v[180:183]
  v_exp_f32 v173, v173
  v_mfma_f32_16x16x32_bf16 v[180:183], a[96:99], a[48:51], v[180:183]
  v_cvt_pk_bf16_f32 v164, v168, v169
  v_cvt_pk_bf16_f32 v165, v170, v171
  v_mfma_f32_16x16x32_bf16 v[184:187], a[112:115], a[48:51], v[204:207]
  v_exp_f32 v178, v178
  v_mfma_f32_16x16x32_bf16 v[184:187], a[116:119], a[52:55], v[184:187]
  v_exp_f32 v176, v176
  v_mfma_f32_16x16x32_bf16 v[184:187], a[120:123], a[56:59], v[184:187]
  s_waitcnt vmcnt(18)
  ds_write_b32 v253, v252
  v_mfma_f32_16x16x32_bf16 v[184:187], a[124:127], a[60:63], v[184:187]
  v_exp_f32 v179, v179
  v_mfma_f32_16x16x32_bf16 v[188:191], a[140:143], a[60:63], v[204:207]
  v_exp_f32 v181, v181
  v_mfma_f32_16x16x32_bf16 v[188:191], a[136:139], a[56:59], v[188:191]
  v_cvt_pk_bf16_f32 v166, v172, v173
  v_cvt_pk_bf16_f32 v167, v174, v175
  v_mfma_f32_16x16x32_bf16 v[188:191], a[132:135], a[52:55], v[188:191]
  v_exp_f32 v180, v180
  v_mfma_f32_16x16x32_bf16 v[188:191], a[128:131], a[48:51], v[188:191]
  v_exp_f32 v177, v177
  v_mfma_f32_16x16x32_bf16 v[64:67], a[144:147], v[160:163], v[64:67]
  v_cvt_pk_bf16_f32 v176, v176, v177
  v_cvt_pk_bf16_f32 v177, v178, v179
  v_mfma_f32_16x16x32_bf16 v[64:67], a[176:179], v[164:167], v[64:67]
  v_exp_f32 v185, v185
  v_mfma_f32_16x16x32_bf16 v[68:71], a[180:183], v[164:167], v[68:71]
  v_exp_f32 v183, v183
  v_mfma_f32_16x16x32_bf16 v[68:71], a[148:151], v[160:163], v[68:71]
  s_waitcnt lgkmcnt(0)
  buffer_store_dwordx4 a[252:255], v238, s[24:27], s42 offen offset:1024
  v_mfma_f32_16x16x32_bf16 v[72:75], a[152:155], v[160:163], v[72:75]
  v_exp_f32 v184, v184
  v_mfma_f32_16x16x32_bf16 v[72:75], a[184:187], v[164:167], v[72:75]
  s_add_u32 m0, s31, 4096
  v_mfma_f32_16x16x32_bf16 v[76:79], a[188:191], v[164:167], v[76:79]
  v_exp_f32 v191, v191
  v_mfma_f32_16x16x32_bf16 v[76:79], a[156:159], v[160:163], v[76:79]
  v_exp_f32 v190, v190
  v_mfma_f32_16x16x32_bf16 v[80:83], a[160:163], v[160:163], v[80:83]
  v_exp_f32 v186, v186
  v_mfma_f32_16x16x32_bf16 v[80:83], a[192:195], v[164:167], v[80:83]
  ds_read_b32 v251, v250
  v_mfma_f32_16x16x32_bf16 v[84:87], a[196:199], v[164:167], v[84:87]
  v_exp_f32 v189, v189
  v_mfma_f32_16x16x32_bf16 v[84:87], a[164:167], v[160:163], v[84:87]
  buffer_load_dwordx4 v232, s[12:15], s42 offen offset:0 nt lds
  v_mfma_f32_16x16x32_bf16 v[88:91], a[168:171], v[160:163], v[88:91]
  v_exp_f32 v182, v182
  v_mfma_f32_16x16x32_bf16 v[88:91], a[200:203], v[164:167], v[88:91]
  v_exp_f32 v187, v187
  v_mfma_f32_16x16x32_bf16 v[92:95], a[204:207], v[164:167], v[92:95]
  v_exp_f32 v188, v188
  v_mfma_f32_16x16x32_bf16 v[92:95], a[172:175], v[160:163], v[92:95]
  s_waitcnt lgkmcnt(0)
  v_cmp_gt_u32 vcc, v252, v251
  v_smfmac_f32_16x16x64_bf16 a[216:219], a[228:231], v[160:167], v254
  v_cvt_pk_bf16_f32 v178, v180, v181
  v_mfma_f32_16x16x32_bf16 v[160:163], a[80:83], a[64:67], v[208:211]
  s_cbranch_vccnz L_SPIN6
  L_BACK6:
  v_mfma_f32_16x16x32_bf16 v[160:163], a[84:87], a[68:71], v[160:163]
  ds_read_b128 a[84:87], v221 offset:0
  s_add_u32 m0, s30, 256
  v_mfma_f32_16x16x32_bf16 v[160:163], a[88:91], a[72:75], v[160:163]
  buffer_load_dwordx4 v232, s[16:19], s58 offen offset:0 nt lds
  v_mfma_f32_16x16x32_bf16 v[160:163], a[92:95], a[76:79], v[160:163]
  ds_read_b128 a[88:91], v222 offset:0
  v_cvt_pk_bf16_f32 v179, v182, v183
  v_mfma_f32_16x16x32_bf16 v[164:167], a[108:111], a[76:79], v[208:211]
  ds_read_b128 a[92:95], v223 offset:0
  v_cvt_pk_bf16_f32 v180, v184, v185
  v_mfma_f32_16x16x32_bf16 v[164:167], a[104:107], a[72:75], v[164:167]
  ds_read_b128 a[80:83], v220 offset:0
  v_mfma_f32_16x16x32_bf16 v[164:167], a[100:103], a[68:71], v[164:167]
  ds_read_b128 a[104:107], v222 offset:4096
  v_cvt_pk_bf16_f32 v181, v186, v187
  v_mfma_f32_16x16x32_bf16 v[164:167], a[96:99], a[64:67], v[164:167]
  ds_read_b128 a[108:111], v223 offset:4096
  v_mfma_f32_16x16x32_bf16 v[168:171], a[112:115], a[64:67], v[208:211]
  ds_read_b128 a[100:103], v221 offset:4096
  v_cvt_pk_bf16_f32 v182, v188, v189
  v_mfma_f32_16x16x32_bf16 v[168:171], a[116:119], a[68:71], v[168:171]
  ds_read_b128 a[96:99], v220 offset:4096
  v_add_u32 v252, 1, v252
  v_mfma_f32_16x16x32_bf16 v[168:171], a[120:123], a[72:75], v[168:171]
  ds_read_b128 a[112:115], v220 offset:8192
  v_cvt_pk_bf16_f32 v183, v190, v191
  v_mfma_f32_16x16x32_bf16 v[168:171], a[124:127], a[76:79], v[168:171]
  buffer_load_dwordx4 v233, s[16:19], s58 offen offset:1024 nt lds
  v_mfma_f32_16x16x32_bf16 v[172:175], a[140:143], a[76:79], v[208:211]
  ds_read_b128 a[116:119], v221 offset:8192
  v_mfma_f32_16x16x32_bf16 v[172:175], a[136:139], a[72:75], v[172:175]
  ds_read_b128 a[120:123], v222 offset:8192
  ds_read_b128 a[140:143], v223 offset:12288
  v_mfma_f32_16x16x32_bf16 v[172:175], a[132:135], a[68:71], v[172:175]
  ds_read_b128 a[136:139], v222 offset:12288
  ds_read_b128 a[132:135], v221 offset:12288
  v_mfma_f32_16x16x32_bf16 v[172:175], a[128:131], a[64:67], v[172:175]
  ds_read_b128 a[124:127], v223 offset:8192
  ds_read_b128 a[128:131], v220 offset:12288
  v_mfma_f32_16x16x32_bf16 v[96:99], a[144:147], v[176:179], v[96:99]
  v_exp_f32 v164, v164
  v_mfma_f32_16x16x32_bf16 v[96:99], a[176:179], v[180:183], v[96:99]
  v_exp_f32 v162, v162
  v_mfma_f32_16x16x32_bf16 v[100:103], a[180:183], v[180:183], v[100:103]
  v_exp_f32 v169, v169
  v_mfma_f32_16x16x32_bf16 v[100:103], a[148:151], v[176:179], v[100:103]
  buffer_load_dwordx4 v234, s[16:19], s58 offen offset:2048 nt lds
  v_mfma_f32_16x16x32_bf16 v[104:107], a[152:155], v[176:179], v[104:107]
  v_exp_f32 v166, v166
  v_mfma_f32_16x16x32_bf16 v[104:107], a[184:187], v[180:183], v[104:107]
  v_exp_f32 v161, v161
  v_mfma_f32_16x16x32_bf16 v[108:111], a[188:191], v[180:183], v[108:111]
  v_exp_f32 v165, v165
  v_mfma_f32_16x16x32_bf16 v[108:111], a[156:159], v[176:179], v[108:111]
  v_exp_f32 v174, v174
  v_mfma_f32_16x16x32_bf16 v[112:115], a[160:163], v[176:179], v[112:115]
  v_exp_f32 v163, v163
  v_mfma_f32_16x16x32_bf16 v[112:115], a[192:195], v[180:183], v[112:115]
  v_exp_f32 v175, v175
  v_mfma_f32_16x16x32_bf16 v[116:119], a[196:199], v[180:183], v[116:119]
  v_exp_f32 v167, v167
  v_mfma_f32_16x16x32_bf16 v[116:119], a[164:167], v[176:179], v[116:119]
  s_waitcnt vmcnt(17) lgkmcnt(0)
  ds_write_b32 v253, v252
  v_mfma_f32_16x16x32_bf16 v[120:123], a[168:171], v[176:179], v[120:123]
  v_exp_f32 v168, v168
  v_mfma_f32_16x16x32_bf16 v[120:123], a[200:203], v[180:183], v[120:123]
  v_exp_f32 v160, v160
  v_mfma_f32_16x16x32_bf16 v[124:127], a[204:207], v[180:183], v[124:127]
  v_exp_f32 v171, v171
  v_mfma_f32_16x16x32_bf16 v[124:127], a[172:175], v[176:179], v[124:127]
  v_exp_f32 v172, v172
  v_smfmac_f32_16x16x64_bf16 a[220:223], a[228:231], v[176:183], v254
  v_mfma_f32_16x16x32_bf16 v[176:179], a[80:83], a[0:3], v[192:195]
  v_cvt_pk_bf16_f32 v160, v160, v161
  v_mfma_f32_16x16x32_bf16 v[176:179], a[84:87], a[4:7], v[176:179]
  v_cvt_pk_bf16_f32 v161, v162, v163
  v_cvt_pk_bf16_f32 v162, v164, v165
  v_mfma_f32_16x16x32_bf16 v[176:179], a[88:91], a[8:11], v[176:179]
  buffer_load_dwordx4 v235, s[16:19], s58 offen offset:3072 nt lds
  v_mfma_f32_16x16x32_bf16 v[176:179], a[92:95], a[12:15], v[176:179]
  v_exp_f32 v170, v170
  v_mfma_f32_16x16x32_bf16 v[180:183], a[108:111], a[12:15], v[192:195]
  v_cvt_pk_bf16_f32 v163, v166, v167
  v_mfma_f32_16x16x32_bf16 v[180:183], a[104:107], a[8:11], v[180:183]
  v_cvt_pk_bf16_f32 v164, v168, v169
  v_cvt_pk_bf16_f32 v165, v170, v171
  v_mfma_f32_16x16x32_bf16 v[180:183], a[100:103], a[4:7], v[180:183]
  v_exp_f32 v173, v173
  v_mfma_f32_16x16x32_bf16 v[180:183], a[96:99], a[0:3], v[180:183]
  ds_read_b32 v251, v250
  v_cvt_pk_bf16_f32 v166, v172, v173
  v_mfma_f32_16x16x32_bf16 v[184:187], a[112:115], a[0:3], v[192:195]
  s_add_u32 m0, s31, 4096
  v_cvt_pk_bf16_f32 v167, v174, v175
  v_mfma_f32_16x16x32_bf16 v[184:187], a[116:119], a[4:7], v[184:187]
  buffer_load_dwordx4 v234, s[12:15], s42 offen offset:2048 nt lds
  v_mfma_f32_16x16x32_bf16 v[184:187], a[120:123], a[8:11], v[184:187]
  v_exp_f32 v177, v177
  v_mfma_f32_16x16x32_bf16 v[184:187], a[124:127], a[12:15], v[184:187]
  v_exp_f32 v178, v178
  v_mfma_f32_16x16x32_bf16 v[188:191], a[140:143], a[12:15], v[192:195]
  v_exp_f32 v179, v179
  v_mfma_f32_16x16x32_bf16 v[188:191], a[136:139], a[8:11], v[188:191]
  v_exp_f32 v182, v182
  v_mfma_f32_16x16x32_bf16 v[188:191], a[132:135], a[4:7], v[188:191]
  s_waitcnt lgkmcnt(0)
  v_cmp_gt_u32 vcc, v252, v251
  v_mfma_f32_16x16x32_bf16 v[188:191], a[128:131], a[0:3], v[188:191]
  v_exp_f32 v176, v176
  v_mfma_f32_16x16x32_bf16 v[128:131], a[144:147], v[160:163], v[128:131]
  s_cbranch_vccnz L_SPIN7
  L_BACK7:
  v_mfma_f32_16x16x32_bf16 v[128:131], a[176:179], v[164:167], v[128:131]
  v_exp_f32 v183, v183
  v_mfma_f32_16x16x32_bf16 v[132:135], a[180:183], v[164:167], v[132:135]
  ds_read_b64_tr_b16 a[144:145], v224 offset:32768
  ds_read_b64_tr_b16 a[146:147], v224 offset:36864
  v_mfma_f32_16x16x32_bf16 v[132:135], a[148:151], v[160:163], v[132:135]
  ds_read_b64_tr_b16 a[176:177], v224 offset:40960
  ds_read_b64_tr_b16 a[180:181], v225 offset:40960
  v_mfma_f32_16x16x32_bf16 v[136:139], a[152:155], v[160:163], v[136:139]
  ds_read_b64_tr_b16 a[178:179], v224 offset:45056
  v_mfma_f32_16x16x32_bf16 v[136:139], a[184:187], v[164:167], v[136:139]
  v_exp_f32 v187, v187
  v_mfma_f32_16x16x32_bf16 v[140:143], a[188:191], v[164:167], v[140:143]
  v_exp_f32 v190, v190
  v_mfma_f32_16x16x32_bf16 v[140:143], a[156:159], v[160:163], v[140:143]
  v_exp_f32 v180, v180
  v_mfma_f32_16x16x32_bf16 v[144:147], a[160:163], v[160:163], v[144:147]
  v_exp_f32 v184, v184
  v_mfma_f32_16x16x32_bf16 v[144:147], a[192:195], v[164:167], v[144:147]
  ds_read_b64_tr_b16 a[182:183], v225 offset:45056
  ds_read_b64_tr_b16 a[150:151], v225 offset:36864
  v_mfma_f32_16x16x32_bf16 v[148:151], a[196:199], v[164:167], v[148:151]
  ds_read_b64_tr_b16 a[148:149], v225 offset:32768
  ds_read_b64_tr_b16 a[184:185], v226 offset:40960
  v_mfma_f32_16x16x32_bf16 v[148:151], a[164:167], v[160:163], v[148:151]
  v_exp_f32 v186, v186
  v_mfma_f32_16x16x32_bf16 v[152:155], a[168:171], v[160:163], v[152:155]
  ds_read_b64_tr_b16 a[152:153], v226 offset:32768
  v_cvt_pk_bf16_f32 v176, v176, v177
  v_mfma_f32_16x16x32_bf16 v[152:155], a[200:203], v[164:167], v[152:155]
  ds_read_b64_tr_b16 a[154:155], v226 offset:36864
  ds_read_b64_tr_b16 a[156:157], v227 offset:32768
  v_mfma_f32_16x16x32_bf16 v[156:159], a[204:207], v[164:167], v[156:159]
  v_exp_f32 v189, v189
  v_mfma_f32_16x16x32_bf16 v[156:159], a[172:175], v[160:163], v[156:159]
  ds_read_b64_tr_b16 a[186:187], v226 offset:45056
  v_add_u32 v252, 1, v252
  v_smfmac_f32_16x16x64_bf16 a[224:227], a[228:231], v[160:167], v254
  ds_read_b64_tr_b16 a[190:191], v227 offset:45056
  v_mfma_f32_16x16x32_bf16 v[160:163], a[80:83], a[16:19], v[196:199]
  ds_read_b64_tr_b16 a[188:189], v227 offset:40960
  v_cvt_pk_bf16_f32 v177, v178, v179
  v_mfma_f32_16x16x32_bf16 v[160:163], a[84:87], a[20:23], v[160:163]
  v_exp_f32 v188, v188
  v_mfma_f32_16x16x32_bf16 v[160:163], a[88:91], a[24:27], v[160:163]
  ds_read_b64_tr_b16 a[158:159], v227 offset:36864
  ds_read_b64_tr_b16 a[162:163], v228 offset:36864
  v_mfma_f32_16x16x32_bf16 v[160:163], a[92:95], a[28:31], v[160:163]
  v_exp_f32 v181, v181
  v_mfma_f32_16x16x32_bf16 v[164:167], a[108:111], a[28:31], v[196:199]
  v_exp_f32 v185, v185
  v_mfma_f32_16x16x32_bf16 v[164:167], a[104:107], a[24:27], v[164:167]
  ds_read_b64_tr_b16 a[160:161], v228 offset:32768
  v_cvt_pk_bf16_f32 v178, v180, v181
  v_mfma_f32_16x16x32_bf16 v[164:167], a[100:103], a[20:23], v[164:167]
  ds_read_b64_tr_b16 a[164:165], v229 offset:32768
  v_cvt_pk_bf16_f32 v179, v182, v183
  v_mfma_f32_16x16x32_bf16 v[164:167], a[96:99], a[16:19], v[164:167]
  ds_read_b128 a[252:255], v239 offset:5120
  v_cvt_pk_bf16_f32 v180, v184, v185
  v_mfma_f32_16x16x32_bf16 v[168:171], a[112:115], a[16:19], v[196:199]
  ds_read_b64_tr_b16 a[192:193], v228 offset:40960
  v_cvt_pk_bf16_f32 v181, v186, v187
  v_mfma_f32_16x16x32_bf16 v[168:171], a[116:119], a[20:23], v[168:171]
  ds_read_b64_tr_b16 a[194:195], v228 offset:45056
  v_cvt_pk_bf16_f32 v182, v188, v189
  v_mfma_f32_16x16x32_bf16 v[168:171], a[120:123], a[24:27], v[168:171]
  ds_read_b64_tr_b16 a[196:197], v229 offset:40960
  ds_read_b64_tr_b16 a[198:199], v229 offset:45056
  v_mfma_f32_16x16x32_bf16 v[168:171], a[124:127], a[28:31], v[168:171]
  v_exp_f32 v191, v191
  v_mfma_f32_16x16x32_bf16 v[172:175], a[140:143], a[28:31], v[196:199]
  ds_read_b64_tr_b16 a[166:167], v229 offset:36864
  v_cvt_pk_bf16_f32 v183, v190, v191
  v_mfma_f32_16x16x32_bf16 v[172:175], a[136:139], a[24:27], v[172:175]
  ds_read_b64_tr_b16 a[168:169], v230 offset:32768
  ds_read_b64_tr_b16 a[206:207], v231 offset:45056
  v_mfma_f32_16x16x32_bf16 v[172:175], a[132:135], a[20:23], v[172:175]
  ds_read_b64_tr_b16 a[202:203], v230 offset:45056
  v_mfma_f32_16x16x32_bf16 v[172:175], a[128:131], a[16:19], v[172:175]
  ds_read_b64_tr_b16 a[200:201], v230 offset:40960
  s_waitcnt lgkmcnt(7)
  v_mfma_f32_16x16x32_bf16 v[0:3], a[144:147], v[176:179], v[0:3]
  ds_read_b64_tr_b16 a[170:171], v230 offset:36864
  v_mfma_f32_16x16x32_bf16 v[0:3], a[176:179], v[180:183], v[0:3]
  ds_read_b64_tr_b16 a[172:173], v231 offset:32768
  v_mfma_f32_16x16x32_bf16 v[4:7], a[180:183], v[180:183], v[4:7]
  ds_read_b64_tr_b16 a[174:175], v231 offset:36864
  v_mfma_f32_16x16x32_bf16 v[4:7], a[148:151], v[176:179], v[4:7]
  ds_read_b64_tr_b16 a[204:205], v231 offset:40960
  v_mfma_f32_16x16x32_bf16 v[8:11], a[152:155], v[176:179], v[8:11]
  v_exp_f32 v162, v162
  v_mfma_f32_16x16x32_bf16 v[8:11], a[184:187], v[180:183], v[8:11]
  v_mfma_f32_16x16x32_bf16 v[12:15], a[188:191], v[180:183], v[12:15]
  buffer_store_dwordx4 a[252:255], v238, s[24:27], s42 offen offset:2048
  v_mfma_f32_16x16x32_bf16 v[12:15], a[156:159], v[176:179], v[12:15]
  v_exp_f32 v164, v164
  v_mfma_f32_16x16x32_bf16 v[16:19], a[160:163], v[176:179], v[16:19]
  v_exp_f32 v168, v168
  v_mfma_f32_16x16x32_bf16 v[16:19], a[192:195], v[180:183], v[16:19]
  s_add_u32 m0, s30, 16640
  s_waitcnt lgkmcnt(0)
  v_mfma_f32_16x16x32_bf16 v[20:23], a[196:199], v[180:183], v[20:23]
  v_exp_f32 v163, v163
  v_mfma_f32_16x16x32_bf16 v[20:23], a[164:167], v[176:179], v[20:23]
  v_mfma_f32_16x16x32_bf16 v[24:27], a[168:171], v[176:179], v[24:27]
  buffer_load_dwordx4 v236, s[20:23], s58 offen offset:0  lds
  v_mfma_f32_16x16x32_bf16 v[24:27], a[200:203], v[180:183], v[24:27]
  v_exp_f32 v160, v160
  v_mfma_f32_16x16x32_bf16 v[28:31], a[204:207], v[180:183], v[28:31]
  v_exp_f32 v161, v161
  v_mfma_f32_16x16x32_bf16 v[28:31], a[172:175], v[176:179], v[28:31]
  v_exp_f32 v171, v171
  v_smfmac_f32_16x16x64_bf16 a[208:211], a[228:231], v[176:183], v254
  v_cvt_pk_bf16_f32 v160, v160, v161
  v_mfma_f32_16x16x32_bf16 v[176:179], a[80:83], a[32:35], v[200:203]
  v_exp_f32 v170, v170
  v_mfma_f32_16x16x32_bf16 v[176:179], a[84:87], a[36:39], v[176:179]
  v_exp_f32 v175, v175
  v_mfma_f32_16x16x32_bf16 v[176:179], a[88:91], a[40:43], v[176:179]
  v_exp_f32 v165, v165
  v_mfma_f32_16x16x32_bf16 v[176:179], a[92:95], a[44:47], v[176:179]
  v_exp_f32 v173, v173
  v_mfma_f32_16x16x32_bf16 v[180:183], a[108:111], a[44:47], v[200:203]
  buffer_load_dwordx4 v237, s[20:23], s58 offen offset:1024  lds
  v_mfma_f32_16x16x32_bf16 v[180:183], a[104:107], a[40:43], v[180:183]
  v_exp_f32 v169, v169
  v_mfma_f32_16x16x32_bf16 v[180:183], a[100:103], a[36:39], v[180:183]
  v_exp_f32 v174, v174
  v_mfma_f32_16x16x32_bf16 v[180:183], a[96:99], a[32:35], v[180:183]
  v_exp_f32 v166, v166
  v_mfma_f32_16x16x32_bf16 v[184:187], a[112:115], a[32:35], v[200:203]
  v_exp_f32 v167, v167
  v_mfma_f32_16x16x32_bf16 v[184:187], a[116:119], a[36:39], v[184:187]
  v_cvt_pk_bf16_f32 v161, v162, v163
  v_cvt_pk_bf16_f32 v162, v164, v165
  v_mfma_f32_16x16x32_bf16 v[184:187], a[120:123], a[40:43], v[184:187]
  v_cvt_pk_bf16_f32 v163, v166, v167
  v_cvt_pk_bf16_f32 v164, v168, v169
  v_mfma_f32_16x16x32_bf16 v[184:187], a[124:127], a[44:47], v[184:187]
  v_cvt_pk_bf16_f32 v165, v170, v171
  v_mfma_f32_16x16x32_bf16 v[188:191], a[140:143], a[44:47], v[200:203]
  v_exp_f32 v172, v172
  v_mfma_f32_16x16x32_bf16 v[188:191], a[136:139], a[40:43], v[188:191]
  v_exp_f32 v183, v183
  v_mfma_f32_16x16x32_bf16 v[188:191], a[132:135], a[36:39], v[188:191]
  v_cvt_pk_bf16_f32 v166, v172, v173
  v_cvt_pk_bf16_f32 v167, v174, v175
  v_mfma_f32_16x16x32_bf16 v[188:191], a[128:131], a[32:35], v[188:191]
  buffer_load_dwordx4 v236, s[20:23], s58 offen offset:2048  lds
  v_mfma_f32_16x16x32_bf16 v[32:35], a[144:147], v[160:163], v[32:35]
  v_mfma_f32_16x16x32_bf16 v[32:35], a[176:179], v[164:167], v[32:35]
  v_exp_f32 v185, v185
  v_mfma_f32_16x16x32_bf16 v[36:39], a[180:183], v[164:167], v[36:39]
  v_exp_f32 v184, v184
  v_mfma_f32_16x16x32_bf16 v[36:39], a[148:151], v[160:163], v[36:39]
  v_exp_f32 v186, v186
  v_mfma_f32_16x16x32_bf16 v[40:43], a[152:155], v[160:163], v[40:43]
  v_exp_f32 v180, v180
  v_mfma_f32_16x16x32_bf16 v[40:43], a[184:187], v[164:167], v[40:43]
  v_exp_f32 v182, v182
  v_mfma_f32_16x16x32_bf16 v[44:47], a[188:191], v[164:167], v[44:47]
  v_exp_f32 v179, v179
  v_mfma_f32_16x16x32_bf16 v[44:47], a[156:159], v[160:163], v[44:47]
  v_add_u32 v228, 0x4000, v228
  v_add_u32 v229, 0x4000, v229
  v_mfma_f32_16x16x32_bf16 v[48:51], a[160:163], v[160:163], v[48:51]
  buffer_load_dwordx4 v237, s[20:23], s58 offen offset:3072  lds
  v_mfma_f32_16x16x32_bf16 v[48:51], a[192:195], v[164:167], v[48:51]
  v_exp_f32 v189, v189
  v_mfma_f32_16x16x32_bf16 v[52:55], a[196:199], v[164:167], v[52:55]
  v_exp_f32 v181, v181
  v_mfma_f32_16x16x32_bf16 v[52:55], a[164:167], v[160:163], v[52:55]
  v_mfma_f32_16x16x32_bf16 v[56:59], a[168:171], v[160:163], v[56:59]
  v_exp_f32 v176, v176
  v_mfma_f32_16x16x32_bf16 v[56:59], a[200:203], v[164:167], v[56:59]
  v_exp_f32 v177, v177
  v_mfma_f32_16x16x32_bf16 v[60:63], a[204:207], v[164:167], v[60:63]
  v_cvt_pk_bf16_f32 v176, v176, v177
  v_mfma_f32_16x16x32_bf16 v[60:63], a[172:175], v[160:163], v[60:63]
  v_exp_f32 v191, v191
  v_smfmac_f32_16x16x64_bf16 a[212:215], a[228:231], v[160:167], v254
  v_add_u32 v224, 0x4000, v224
  v_mfma_f32_16x16x32_bf16 v[160:163], a[80:83], a[48:51], v[204:207]
  v_exp_f32 v187, v187
  v_mfma_f32_16x16x32_bf16 v[160:163], a[84:87], a[52:55], v[160:163]
  v_exp_f32 v190, v190
  v_mfma_f32_16x16x32_bf16 v[160:163], a[88:91], a[56:59], v[160:163]
  v_exp_f32 v178, v178
  v_mfma_f32_16x16x32_bf16 v[160:163], a[92:95], a[60:63], v[160:163]
  v_cvt_pk_bf16_f32 v177, v178, v179
  v_mfma_f32_16x16x32_bf16 v[164:167], a[108:111], a[60:63], v[204:207]
  v_add_u32 v231, 0x4000, v231
  v_cvt_pk_bf16_f32 v178, v180, v181
  v_mfma_f32_16x16x32_bf16 v[164:167], a[104:107], a[56:59], v[164:167]
  v_cvt_pk_bf16_f32 v179, v182, v183
  v_cvt_pk_bf16_f32 v180, v184, v185
  v_mfma_f32_16x16x32_bf16 v[164:167], a[100:103], a[52:55], v[164:167]
  ds_read_b128 a[252:255], v255 offset:5632
  v_mfma_f32_16x16x32_bf16 v[164:167], a[96:99], a[48:51], v[164:167]
  v_exp_f32 v188, v188
  v_mfma_f32_16x16x32_bf16 v[168:171], a[112:115], a[48:51], v[204:207]
  v_add_u32 v225, 0x4000, v225
  v_cvt_pk_bf16_f32 v181, v186, v187
  v_mfma_f32_16x16x32_bf16 v[168:171], a[116:119], a[52:55], v[168:171]
  s_waitcnt vmcnt(18)
  ds_write_b32 v253, v252
  v_mfma_f32_16x16x32_bf16 v[168:171], a[120:123], a[56:59], v[168:171]
  v_cvt_pk_bf16_f32 v182, v188, v189
  v_cvt_pk_bf16_f32 v183, v190, v191
  v_mfma_f32_16x16x32_bf16 v[168:171], a[124:127], a[60:63], v[168:171]
  v_exp_f32 v162, v162
  v_mfma_f32_16x16x32_bf16 v[172:175], a[140:143], a[60:63], v[204:207]
  v_exp_f32 v163, v163
  v_mfma_f32_16x16x32_bf16 v[172:175], a[136:139], a[56:59], v[172:175]
  v_exp_f32 v164, v164
  v_mfma_f32_16x16x32_bf16 v[172:175], a[132:135], a[52:55], v[172:175]
  v_exp_f32 v165, v165
  v_mfma_f32_16x16x32_bf16 v[172:175], a[128:131], a[48:51], v[172:175]
  v_exp_f32 v161, v161
  v_mfma_f32_16x16x32_bf16 v[64:67], a[144:147], v[176:179], v[64:67]
  v_exp_f32 v169, v169
  v_mfma_f32_16x16x32_bf16 v[64:67], a[176:179], v[180:183], v[64:67]
  s_waitcnt lgkmcnt(0)
  buffer_store_dwordx4 a[252:255], v238, s[24:27], s42 offen offset:3072
  v_mfma_f32_16x16x32_bf16 v[68:71], a[180:183], v[180:183], v[68:71]
  v_exp_f32 v166, v166
  v_mfma_f32_16x16x32_bf16 v[68:71], a[148:151], v[176:179], v[68:71]
  v_exp_f32 v170, v170
  v_mfma_f32_16x16x32_bf16 v[72:75], a[152:155], v[176:179], v[72:75]
  v_exp_f32 v171, v171
  v_mfma_f32_16x16x32_bf16 v[72:75], a[184:187], v[180:183], v[72:75]
  v_add_u32 v227, 0x4000, v227
  v_add_u32 v230, 0x4000, v230
  v_mfma_f32_16x16x32_bf16 v[76:79], a[188:191], v[180:183], v[76:79]
  v_exp_f32 v167, v167
  v_mfma_f32_16x16x32_bf16 v[76:79], a[156:159], v[176:179], v[76:79]
  v_exp_f32 v168, v168
  v_mfma_f32_16x16x32_bf16 v[80:83], a[160:163], v[176:179], v[80:83]
  v_exp_f32 v172, v172
  v_mfma_f32_16x16x32_bf16 v[80:83], a[192:195], v[180:183], v[80:83]
  ds_read_b32 v251, v250
  s_add_u32 m0, s31, 4096
  v_mfma_f32_16x16x32_bf16 v[84:87], a[196:199], v[180:183], v[84:87]
  v_exp_f32 v174, v174
  v_mfma_f32_16x16x32_bf16 v[84:87], a[164:167], v[176:179], v[84:87]
  buffer_load_dwordx4 v233, s[12:15], s42 offen offset:1024 nt lds
  v_mfma_f32_16x16x32_bf16 v[88:91], a[168:171], v[176:179], v[88:91]
  v_exp_f32 v173, v173
  v_mfma_f32_16x16x32_bf16 v[88:91], a[200:203], v[180:183], v[88:91]
  v_exp_f32 v160, v160
  v_mfma_f32_16x16x32_bf16 v[92:95], a[204:207], v[180:183], v[92:95]
  v_exp_f32 v175, v175
  v_mfma_f32_16x16x32_bf16 v[92:95], a[172:175], v[176:179], v[92:95]
  s_waitcnt lgkmcnt(0)
  v_cmp_gt_u32 vcc, v252, v251
  v_smfmac_f32_16x16x64_bf16 a[216:219], a[228:231], v[176:183], v254
  v_cvt_pk_bf16_f32 v160, v160, v161
  v_mfma_f32_16x16x32_bf16 v[176:179], a[80:83], a[64:67], v[208:211]
  s_cbranch_vccnz L_SPIN8
  L_BACK8:
  v_mfma_f32_16x16x32_bf16 v[176:179], a[84:87], a[68:71], v[176:179]
  ds_read_b128 a[84:87], v221 offset:32768
  s_add_u32 m0, s30, 33024
  v_mfma_f32_16x16x32_bf16 v[176:179], a[88:91], a[72:75], v[176:179]
  buffer_load_dwordx4 v232, s[16:19], s59 offen offset:0 nt lds
  v_mfma_f32_16x16x32_bf16 v[176:179], a[92:95], a[76:79], v[176:179]
  ds_read_b128 a[80:83], v220 offset:32768
  v_mfma_f32_16x16x32_bf16 v[180:183], a[108:111], a[76:79], v[208:211]
  ds_read_b128 a[88:91], v222 offset:32768
  v_cvt_pk_bf16_f32 v161, v162, v163
  v_mfma_f32_16x16x32_bf16 v[180:183], a[104:107], a[72:75], v[180:183]
  ds_read_b128 a[104:107], v222 offset:36864
  v_cvt_pk_bf16_f32 v162, v164, v165
  v_mfma_f32_16x16x32_bf16 v[180:183], a[100:103], a[68:71], v[180:183]
  ds_read_b128 a[108:111], v223 offset:36864
  v_cvt_pk_bf16_f32 v163, v166, v167
  v_mfma_f32_16x16x32_bf16 v[180:183], a[96:99], a[64:67], v[180:183]
  ds_read_b128 a[92:95], v223 offset:32768
  v_cvt_pk_bf16_f32 v164, v168, v169
  v_mfma_f32_16x16x32_bf16 v[184:187], a[112:115], a[64:67], v[208:211]
  ds_read_b128 a[112:115], v220 offset:40960
  v_cvt_pk_bf16_f32 v165, v170, v171
  v_mfma_f32_16x16x32_bf16 v[184:187], a[116:119], a[68:71], v[184:187]
  ds_read_b128 a[100:103], v221 offset:36864
  v_cvt_pk_bf16_f32 v166, v172, v173
  v_mfma_f32_16x16x32_bf16 v[184:187], a[120:123], a[72:75], v[184:187]
  buffer_load_dwordx4 v233, s[16:19], s59 offen offset:1024 nt lds
  v_mfma_f32_16x16x32_bf16 v[184:187], a[124:127], a[76:79], v[184:187]
  ds_read_b128 a[96:99], v220 offset:36864
  ds_read_b128 a[116:119], v221 offset:40960
  v_mfma_f32_16x16x32_bf16 v[188:191], a[140:143], a[76:79], v[208:211]
  ds_read_b128 a[120:123], v222 offset:40960
  ds_read_b128 a[140:143], v223 offset:45056
  v_mfma_f32_16x16x32_bf16 v[188:191], a[136:139], a[72:75], v[188:191]
  ds_read_b128 a[136:139], v222 offset:45056
  v_add_u32 v252, 1, v252
  v_mfma_f32_16x16x32_bf16 v[188:191], a[132:135], a[68:71], v[188:191]
  ds_read_b128 a[124:127], v223 offset:40960
  v_cvt_pk_bf16_f32 v167, v174, v175
  v_mfma_f32_16x16x32_bf16 v[188:191], a[128:131], a[64:67], v[188:191]
  ds_read_b128 a[132:135], v221 offset:45056
  ds_read_b128 a[128:131], v220 offset:45056
  v_mfma_f32_16x16x32_bf16 v[96:99], a[144:147], v[160:163], v[96:99]
  v_exp_f32 v177, v177
  v_mfma_f32_16x16x32_bf16 v[96:99], a[176:179], v[164:167], v[96:99]
  v_exp_f32 v184, v184
  v_mfma_f32_16x16x32_bf16 v[100:103], a[180:183], v[164:167], v[100:103]
  v_exp_f32 v182, v182
  v_mfma_f32_16x16x32_bf16 v[100:103], a[148:151], v[160:163], v[100:103]
  buffer_load_dwordx4 v234, s[16:19], s59 offen offset:2048 nt lds
  v_mfma_f32_16x16x32_bf16 v[104:107], a[152:155], v[160:163], v[104:107]
  v_exp_f32 v179, v179
  v_mfma_f32_16x16x32_bf16 v[104:107], a[184:187], v[164:167], v[104:107]
  v_exp_f32 v190, v190
  v_mfma_f32_16x16x32_bf16 v[108:111], a[188:191], v[164:167], v[108:111]
  v_exp_f32 v176, v176
  v_mfma_f32_16x16x32_bf16 v[108:111], a[156:159], v[160:163], v[108:111]
  v_exp_f32 v191, v191
  v_mfma_f32_16x16x32_bf16 v[112:115], a[160:163], v[160:163], v[112:115]
  v_cvt_pk_bf16_f32 v176, v176, v177
  v_mfma_f32_16x16x32_bf16 v[112:115], a[192:195], v[164:167], v[112:115]
  v_exp_f32 v181, v181
  v_mfma_f32_16x16x32_bf16 v[116:119], a[196:199], v[164:167], v[116:119]
  s_waitcnt vmcnt(17) lgkmcnt(0)
  ds_write_b32 v253, v252
  v_mfma_f32_16x16x32_bf16 v[116:119], a[164:167], v[160:163], v[116:119]
  v_exp_f32 v188, v188
  v_mfma_f32_16x16x32_bf16 v[120:123], a[168:171], v[160:163], v[120:123]
  v_exp_f32 v187, v187
  v_mfma_f32_16x16x32_bf16 v[120:123], a[200:203], v[164:167], v[120:123]
  v_exp_f32 v185, v185
  v_mfma_f32_16x16x32_bf16 v[124:127], a[204:207], v[164:167], v[124:127]
  v_exp_f32 v183, v183
  v_mfma_f32_16x16x32_bf16 v[124:127], a[172:175], v[160:163], v[124:127]
  v_exp_f32 v189, v189
  v_smfmac_f32_16x16x64_bf16 a[220:223], a[228:231], v[160:167], v254
  v_mfma_f32_16x16x32_bf16 v[160:163], a[80:83], a[0:3], v[192:195]
  v_exp_f32 v178, v178
  v_mfma_f32_16x16x32_bf16 v[160:163], a[84:87], a[4:7], v[160:163]
  v_cvt_pk_bf16_f32 v177, v178, v179
  v_mfma_f32_16x16x32_bf16 v[160:163], a[88:91], a[8:11], v[160:163]
  buffer_load_dwordx4 v235, s[16:19], s59 offen offset:3072 nt lds
  v_mfma_f32_16x16x32_bf16 v[160:163], a[92:95], a[12:15], v[160:163]
  v_exp_f32 v180, v180
  v_mfma_f32_16x16x32_bf16 v[164:167], a[108:111], a[12:15], v[192:195]
  v_exp_f32 v186, v186
  v_mfma_f32_16x16x32_bf16 v[164:167], a[104:107], a[8:11], v[164:167]
  v_cvt_pk_bf16_f32 v178, v180, v181
  v_cvt_pk_bf16_f32 v179, v182, v183
  v_mfma_f32_16x16x32_bf16 v[164:167], a[100:103], a[4:7], v[164:167]
  v_cvt_pk_bf16_f32 v180, v184, v185
  v_cvt_pk_bf16_f32 v181, v186, v187
  v_mfma_f32_16x16x32_bf16 v[164:167], a[96:99], a[0:3], v[164:167]
  ds_read_b32 v251, v250
  v_cvt_pk_bf16_f32 v182, v188, v189
  v_mfma_f32_16x16x32_bf16 v[168:171], a[112:115], a[0:3], v[192:195]
  v_exp_f32 v161, v161
  v_mfma_f32_16x16x32_bf16 v[168:171], a[116:119], a[4:7], v[168:171]
  v_exp_f32 v163, v163
  v_mfma_f32_16x16x32_bf16 v[168:171], a[120:123], a[8:11], v[168:171]
  s_add_u32 m0, s31, 4096
  v_cvt_pk_bf16_f32 v183, v190, v191
  v_mfma_f32_16x16x32_bf16 v[168:171], a[124:127], a[12:15], v[168:171]
  v_exp_f32 v162, v162
  v_mfma_f32_16x16x32_bf16 v[172:175], a[140:143], a[12:15], v[192:195]
  v_exp_f32 v160, v160
  v_mfma_f32_16x16x32_bf16 v[172:175], a[136:139], a[8:11], v[172:175]
  s_waitcnt lgkmcnt(0)
  v_cmp_gt_u32 vcc, v252, v251
  v_mfma_f32_16x16x32_bf16 v[172:175], a[132:135], a[4:7], v[172:175]
  buffer_load_dwordx4 v235, s[12:15], s42 offen offset:3072 nt lds
  v_mfma_f32_16x16x32_bf16 v[172:175], a[128:131], a[0:3], v[172:175]
  v_add_u32 v226, 0x4000, v226
  v_mfma_f32_16x16x32_bf16 v[128:131], a[144:147], v[176:179], v[128:131]
  s_cbranch_vccnz L_SPIN9
  L_BACK9:
  v_mfma_f32_16x16x32_bf16 v[128:131], a[176:179], v[180:183], v[128:131]
  v_exp_f32 v169, v169
  v_mfma_f32_16x16x32_bf16 v[132:135], a[180:183], v[180:183], v[132:135]
  v_exp_f32 v168, v168
  v_mfma_f32_16x16x32_bf16 v[132:135], a[148:151], v[176:179], v[132:135]
  v_exp_f32 v171, v171
  v_mfma_f32_16x16x32_bf16 v[136:139], a[152:155], v[176:179], v[136:139]
  ds_read_b64_tr_b16 a[144:145], v224 offset:49152
  ds_read_b64_tr_b16 a[146:147], v224 offset:53248
  v_mfma_f32_16x16x32_bf16 v[136:139], a[184:187], v[180:183], v[136:139]
  ds_read_b64_tr_b16 a[176:177], v224 offset:57344
  ds_read_b64_tr_b16 a[182:183], v225 offset:61440
  v_mfma_f32_16x16x32_bf16 v[140:143], a[188:191], v[180:183], v[140:143]
  v_exp_f32 v170, v170
  v_mfma_f32_16x16x32_bf16 v[140:143], a[156:159], v[176:179], v[140:143]
  ds_read_b64_tr_b16 a[178:179], v224 offset:61440
  ds_read_b64_tr_b16 a[180:181], v225 offset:57344
  v_mfma_f32_16x16x32_bf16 v[144:147], a[160:163], v[176:179], v[144:147]
  v_exp_f32 v174, v174
  v_mfma_f32_16x16x32_bf16 v[144:147], a[192:195], v[180:183], v[144:147]
  v_exp_f32 v165, v165
  v_mfma_f32_16x16x32_bf16 v[148:151], a[196:199], v[180:183], v[148:151]
  ds_read_b64_tr_b16 a[150:151], v225 offset:53248
  ds_read_b64_tr_b16 a[184:185], v226 offset:57344
  v_mfma_f32_16x16x32_bf16 v[148:151], a[164:167], v[176:179], v[148:151]
  ds_read_b64_tr_b16 a[148:149], v225 offset:49152
  ds_read_b64_tr_b16 a[152:153], v226 offset:49152
  v_mfma_f32_16x16x32_bf16 v[152:155], a[168:171], v[176:179], v[152:155]
  ds_read_b64_tr_b16 a[156:157], v227 offset:49152
  v_cvt_pk_bf16_f32 v160, v160, v161
  v_mfma_f32_16x16x32_bf16 v[152:155], a[200:203], v[180:183], v[152:155]
  ds_read_b64_tr_b16 a[190:191], v227 offset:61440
  v_mfma_f32_16x16x32_bf16 v[156:159], a[204:207], v[180:183], v[156:159]
  ds_read_b64_tr_b16 a[154:155], v226 offset:53248
  v_add_u32 v222, 0xffffc000, v222
  v_mfma_f32_16x16x32_bf16 v[156:159], a[172:175], v[176:179], v[156:159]
  v_exp_f32 v175, v175
  v_smfmac_f32_16x16x64_bf16 a[224:227], a[228:231], v[176:183], v254
  ds_read_b64_tr_b16 a[186:187], v226 offset:61440
  v_mfma_f32_16x16x32_bf16 v[176:179], a[80:83], a[16:19], v[196:199]
  ds_read_b64_tr_b16 a[188:189], v227 offset:57344
  v_mfma_f32_16x16x32_bf16 v[176:179], a[84:87], a[20:23], v[176:179]
  ds_read_b64_tr_b16 a[158:159], v227 offset:53248
  ds_read_b64_tr_b16 a[194:195], v228 offset:61440
  v_mfma_f32_16x16x32_bf16 v[176:179], a[88:91], a[24:27], v[176:179]
  ds_read_b64_tr_b16 a[162:163], v228 offset:53248
  ds_read_b64_tr_b16 a[192:193], v228 offset:57344
  v_mfma_f32_16x16x32_bf16 v[176:179], a[92:95], a[28:31], v[176:179]
  v_exp_f32 v166, v166
  v_mfma_f32_16x16x32_bf16 v[180:183], a[108:111], a[28:31], v[196:199]
  ds_read_b64_tr_b16 a[196:197], v229 offset:57344
  v_cvt_pk_bf16_f32 v161, v162, v163
  v_mfma_f32_16x16x32_bf16 v[180:183], a[104:107], a[24:27], v[180:183]
  ds_read_b64_tr_b16 a[160:161], v228 offset:49152
  ds_read_b64_tr_b16 a[166:167], v229 offset:53248
  v_mfma_f32_16x16x32_bf16 v[180:183], a[100:103], a[20:23], v[180:183]
  v_exp_f32 v172, v172
  v_mfma_f32_16x16x32_bf16 v[180:183], a[96:99], a[16:19], v[180:183]
  v_exp_f32 v173, v173
  v_mfma_f32_16x16x32_bf16 v[184:187], a[112:115], a[16:19], v[196:199]
  v_exp_f32 v164, v164
  v_mfma_f32_16x16x32_bf16 v[184:187], a[116:119], a[20:23], v[184:187]
  ds_read_b64_tr_b16 a[200:201], v230 offset:57344
  v_cvt_pk_bf16_f32 v162, v164, v165
  v_mfma_f32_16x16x32_bf16 v[184:187], a[120:123], a[24:27], v[184:187]
  v_exp_f32 v167, v167
  v_mfma_f32_16x16x32_bf16 v[184:187], a[124:127], a[28:31], v[184:187]
  ds_read_b64_tr_b16 a[198:199], v229 offset:61440
  v_cvt_pk_bf16_f32 v163, v166, v167
  v_mfma_f32_16x16x32_bf16 v[188:191], a[140:143], a[28:31], v[196:199]
  ds_read_b64_tr_b16 a[164:165], v229 offset:49152
  v_cvt_pk_bf16_f32 v164, v168, v169
  v_mfma_f32_16x16x32_bf16 v[188:191], a[136:139], a[24:27], v[188:191]
  ds_read_b64_tr_b16 a[168:169], v230 offset:49152
  v_cvt_pk_bf16_f32 v165, v170, v171
  v_mfma_f32_16x16x32_bf16 v[188:191], a[132:135], a[20:23], v[188:191]
  v_cvt_pk_bf16_f32 v166, v172, v173
  v_cvt_pk_bf16_f32 v167, v174, v175
  v_mfma_f32_16x16x32_bf16 v[188:191], a[128:131], a[16:19], v[188:191]
  ds_read_b64_tr_b16 a[206:207], v231 offset:61440
  s_waitcnt lgkmcnt(4)
  v_mfma_f32_16x16x32_bf16 v[0:3], a[144:147], v[160:163], v[0:3]
  ds_read_b64_tr_b16 a[170:171], v230 offset:53248
  ds_read_b64_tr_b16 a[174:175], v231 offset:53248
  v_mfma_f32_16x16x32_bf16 v[0:3], a[176:179], v[164:167], v[0:3]
  ds_read_b64_tr_b16 a[202:203], v230 offset:61440
  v_mfma_f32_16x16x32_bf16 v[4:7], a[180:183], v[164:167], v[4:7]
  ds_read_b64_tr_b16 a[204:205], v231 offset:57344
  v_add_u32 v223, 0xffffc000, v223
  v_mfma_f32_16x16x32_bf16 v[4:7], a[148:151], v[160:163], v[4:7]
  ds_read_b64_tr_b16 a[172:173], v231 offset:49152
  v_add_u32 v221, 0xffffc000, v221
  v_mfma_f32_16x16x32_bf16 v[8:11], a[152:155], v[160:163], v[8:11]
  v_exp_f32 v180, v180
  v_mfma_f32_16x16x32_bf16 v[8:11], a[184:187], v[164:167], v[8:11]
  ds_read_b128 a[252:255], v239 offset:8192
  v_mfma_f32_16x16x32_bf16 v[12:15], a[188:191], v[164:167], v[12:15]
  v_add_u32 v252, 1, v252
  v_mfma_f32_16x16x32_bf16 v[12:15], a[156:159], v[160:163], v[12:15]
  v_exp_f32 v177, v177
  v_mfma_f32_16x16x32_bf16 v[16:19], a[160:163], v[160:163], v[16:19]
  s_add_u32 m0, s30, 49408
  v_mfma_f32_16x16x32_bf16 v[16:19], a[192:195], v[164:167], v[16:19]
  buffer_load_dwordx4 v236, s[20:23], s59 offen offset:0  lds
  s_waitcnt lgkmcnt(1)
  v_mfma_f32_16x16x32_bf16 v[20:23], a[196:199], v[164:167], v[20:23]
  v_exp_f32 v189, v189
  v_mfma_f32_16x16x32_bf16 v[20:23], a[164:167], v[160:163], v[20:23]
  v_mfma_f32_16x16x32_bf16 v[24:27], a[168:171], v[160:163], v[24:27]
  v_exp_f32 v188, v188
  v_mfma_f32_16x16x32_bf16 v[24:27], a[200:203], v[164:167], v[24:27]
  v_exp_f32 v179, v179
  v_mfma_f32_16x16x32_bf16 v[28:31], a[204:207], v[164:167], v[28:31]
  v_exp_f32 v183, v183
  v_mfma_f32_16x16x32_bf16 v[28:31], a[172:175], v[160:163], v[28:31]
  v_exp_f32 v190, v190
  v_smfmac_f32_16x16x64_bf16 a[208:211], a[228:231], v[160:167], v254
  v_mfma_f32_16x16x32_bf16 v[160:163], a[80:83], a[32:35], v[200:203]
  buffer_load_dwordx4 v237, s[20:23], s59 offen offset:1024  lds
  v_mfma_f32_16x16x32_bf16 v[160:163], a[84:87], a[36:39], v[160:163]
  v_exp_f32 v185, v185
  v_mfma_f32_16x16x32_bf16 v[160:163], a[88:91], a[40:43], v[160:163]
  v_exp_f32 v187, v187
  v_mfma_f32_16x16x32_bf16 v[160:163], a[92:95], a[44:47], v[160:163]
  v_exp_f32 v176, v176
  v_mfma_f32_16x16x32_bf16 v[164:167], a[108:111], a[44:47], v[200:203]
  v_exp_f32 v178, v178
  v_mfma_f32_16x16x32_bf16 v[164:167], a[104:107], a[40:43], v[164:167]
  v_exp_f32 v186, v186
  v_mfma_f32_16x16x32_bf16 v[164:167], a[100:103], a[36:39], v[164:167]
  v_cvt_pk_bf16_f32 v176, v176, v177
  v_cvt_pk_bf16_f32 v177, v178, v179
  v_mfma_f32_16x16x32_bf16 v[164:167], a[96:99], a[32:35], v[164:167]
  v_exp_f32 v184, v184
  v_mfma_f32_16x16x32_bf16 v[168:171], a[112:115], a[32:35], v[200:203]
  s_waitcnt lgkmcnt(0)
  buffer_store_dwordx4 a[252:255], v238, s[24:27], s43 offen offset:0
  v_mfma_f32_16x16x32_bf16 v[168:171], a[116:119], a[36:39], v[168:171]
  v_exp_f32 v181, v181
  v_mfma_f32_16x16x32_bf16 v[168:171], a[120:123], a[40:43], v[168:171]
  v_exp_f32 v182, v182
  v_mfma_f32_16x16x32_bf16 v[168:171], a[124:127], a[44:47], v[168:171]
  v_cvt_pk_bf16_f32 v178, v180, v181
  v_cvt_pk_bf16_f32 v179, v182, v183
  v_mfma_f32_16x16x32_bf16 v[172:175], a[140:143], a[44:47], v[200:203]
  v_cvt_pk_bf16_f32 v180, v184, v185
  v_cvt_pk_bf16_f32 v181, v186, v187
  v_mfma_f32_16x16x32_bf16 v[172:175], a[136:139], a[40:43], v[172:175]
  v_exp_f32 v191, v191
  v_mfma_f32_16x16x32_bf16 v[172:175], a[132:135], a[36:39], v[172:175]
  v_cvt_pk_bf16_f32 v182, v188, v189
  v_cvt_pk_bf16_f32 v183, v190, v191
  v_mfma_f32_16x16x32_bf16 v[172:175], a[128:131], a[32:35], v[172:175]
  buffer_load_dwordx4 v236, s[20:23], s59 offen offset:2048  lds
  v_mfma_f32_16x16x32_bf16 v[32:35], a[144:147], v[176:179], v[32:35]
  v_exp_f32 v163, v163
  v_mfma_f32_16x16x32_bf16 v[32:35], a[176:179], v[180:183], v[32:35]
  v_exp_f32 v161, v161
  v_mfma_f32_16x16x32_bf16 v[36:39], a[180:183], v[180:183], v[36:39]
  v_exp_f32 v167, v167
  v_mfma_f32_16x16x32_bf16 v[36:39], a[148:151], v[176:179], v[36:39]
  v_exp_f32 v162, v162
  v_mfma_f32_16x16x32_bf16 v[40:43], a[152:155], v[176:179], v[40:43]
  v_exp_f32 v174, v174
  v_mfma_f32_16x16x32_bf16 v[40:43], a[184:187], v[180:183], v[40:43]
  v_exp_f32 v171, v171
  v_mfma_f32_16x16x32_bf16 v[44:47], a[188:191], v[180:183], v[44:47]
  v_exp_f32 v164, v164
  v_mfma_f32_16x16x32_bf16 v[44:47], a[156:159], v[176:179], v[44:47]
  v_exp_f32 v169, v169
  v_mfma_f32_16x16x32_bf16 v[48:51], a[160:163], v[176:179], v[48:51]
  v_exp_f32 v170, v170
  v_mfma_f32_16x16x32_bf16 v[48:51], a[192:195], v[180:183], v[48:51]
  buffer_load_dwordx4 v237, s[20:23], s59 offen offset:3072  lds
  v_mfma_f32_16x16x32_bf16 v[52:55], a[196:199], v[180:183], v[52:55]
  v_exp_f32 v175, v175
  v_mfma_f32_16x16x32_bf16 v[52:55], a[164:167], v[176:179], v[52:55]
  v_exp_f32 v165, v165
  v_mfma_f32_16x16x32_bf16 v[56:59], a[168:171], v[176:179], v[56:59]
  v_exp_f32 v160, v160
  v_mfma_f32_16x16x32_bf16 v[56:59], a[200:203], v[180:183], v[56:59]
  v_add_u32 v220, 0xffffc000, v220
  v_mfma_f32_16x16x32_bf16 v[60:63], a[204:207], v[180:183], v[60:63]
  ds_read_b128 a[252:255], v255 offset:8704
  v_cvt_pk_bf16_f32 v160, v160, v161
  v_mfma_f32_16x16x32_bf16 v[60:63], a[172:175], v[176:179], v[60:63]
  v_cvt_pk_bf16_f32 v161, v162, v163
  v_smfmac_f32_16x16x64_bf16 a[212:215], a[228:231], v[176:183], v254
  v_mfma_f32_16x16x32_bf16 v[176:179], a[80:83], a[48:51], v[204:207]
  v_cvt_pk_bf16_f32 v162, v164, v165
  v_mfma_f32_16x16x32_bf16 v[176:179], a[84:87], a[52:55], v[176:179]
  v_exp_f32 v173, v173
  v_mfma_f32_16x16x32_bf16 v[176:179], a[88:91], a[56:59], v[176:179]
  v_mfma_f32_16x16x32_bf16 v[176:179], a[92:95], a[60:63], v[176:179]
  v_exp_f32 v166, v166
  v_mfma_f32_16x16x32_bf16 v[180:183], a[108:111], a[60:63], v[204:207]
  v_cvt_pk_bf16_f32 v163, v166, v167
  v_mfma_f32_16x16x32_bf16 v[180:183], a[104:107], a[56:59], v[180:183]
  v_exp_f32 v168, v168
  v_mfma_f32_16x16x32_bf16 v[180:183], a[100:103], a[52:55], v[180:183]
  v_exp_f32 v172, v172
  v_mfma_f32_16x16x32_bf16 v[180:183], a[96:99], a[48:51], v[180:183]
  v_cvt_pk_bf16_f32 v164, v168, v169
  v_cvt_pk_bf16_f32 v165, v170, v171
  v_mfma_f32_16x16x32_bf16 v[184:187], a[112:115], a[48:51], v[204:207]
  v_exp_f32 v177, v177
  v_mfma_f32_16x16x32_bf16 v[184:187], a[116:119], a[52:55], v[184:187]
  v_cvt_pk_bf16_f32 v166, v172, v173
  v_mfma_f32_16x16x32_bf16 v[184:187], a[120:123], a[56:59], v[184:187]
  s_waitcnt vmcnt(18)
  ds_write_b32 v253, v252
  v_mfma_f32_16x16x32_bf16 v[184:187], a[124:127], a[60:63], v[184:187]
  v_exp_f32 v176, v176
  v_mfma_f32_16x16x32_bf16 v[188:191], a[140:143], a[60:63], v[204:207]
  s_add_u32 m0, s31, 8192
  v_cvt_pk_bf16_f32 v176, v176, v177
  v_mfma_f32_16x16x32_bf16 v[188:191], a[136:139], a[56:59], v[188:191]
  v_cvt_pk_bf16_f32 v167, v174, v175
  v_mfma_f32_16x16x32_bf16 v[188:191], a[132:135], a[52:55], v[188:191]
  v_exp_f32 v179, v179
  v_mfma_f32_16x16x32_bf16 v[188:191], a[128:131], a[48:51], v[188:191]
  v_exp_f32 v181, v181
  v_mfma_f32_16x16x32_bf16 v[64:67], a[144:147], v[160:163], v[64:67]
  v_exp_f32 v183, v183
  v_mfma_f32_16x16x32_bf16 v[64:67], a[176:179], v[164:167], v[64:67]
  v_exp_f32 v178, v178
  v_mfma_f32_16x16x32_bf16 v[68:71], a[180:183], v[164:167], v[68:71]
  v_exp_f32 v184, v184
  v_mfma_f32_16x16x32_bf16 v[68:71], a[148:151], v[160:163], v[68:71]
  s_waitcnt lgkmcnt(0)
  buffer_load_dwordx4 v232, s[12:15], s43 offen offset:0 nt lds
  v_mfma_f32_16x16x32_bf16 v[72:75], a[152:155], v[160:163], v[72:75]
  v_exp_f32 v190, v190
  v_mfma_f32_16x16x32_bf16 v[72:75], a[184:187], v[164:167], v[72:75]
  v_exp_f32 v187, v187
  v_mfma_f32_16x16x32_bf16 v[76:79], a[188:191], v[164:167], v[76:79]
  v_exp_f32 v182, v182
  v_mfma_f32_16x16x32_bf16 v[76:79], a[156:159], v[160:163], v[76:79]
  v_exp_f32 v188, v188
  v_mfma_f32_16x16x32_bf16 v[80:83], a[160:163], v[160:163], v[80:83]
  v_exp_f32 v191, v191
  v_mfma_f32_16x16x32_bf16 v[80:83], a[192:195], v[164:167], v[80:83]
  ds_read_b32 v251, v250
  v_mfma_f32_16x16x32_bf16 v[84:87], a[196:199], v[164:167], v[84:87]
  v_exp_f32 v186, v186
  v_mfma_f32_16x16x32_bf16 v[84:87], a[164:167], v[160:163], v[84:87]
  buffer_store_dwordx4 a[252:255], v238, s[24:27], s43 offen offset:1024
  v_mfma_f32_16x16x32_bf16 v[88:91], a[168:171], v[160:163], v[88:91]
  v_exp_f32 v180, v180
  v_mfma_f32_16x16x32_bf16 v[88:91], a[200:203], v[164:167], v[88:91]
  v_exp_f32 v185, v185
  v_mfma_f32_16x16x32_bf16 v[92:95], a[204:207], v[164:167], v[92:95]
  v_exp_f32 v189, v189
  v_mfma_f32_16x16x32_bf16 v[92:95], a[172:175], v[160:163], v[92:95]
  s_waitcnt lgkmcnt(0)
  v_cmp_gt_u32 vcc, v252, v251
  v_smfmac_f32_16x16x64_bf16 a[216:219], a[228:231], v[160:167], v254
  v_cvt_pk_bf16_f32 v177, v178, v179
  v_mfma_f32_16x16x32_bf16 v[160:163], a[80:83], a[64:67], v[208:211]
  s_cbranch_vccnz L_SPIN10
  L_BACK10:
  v_mfma_f32_16x16x32_bf16 v[160:163], a[84:87], a[68:71], v[160:163]
  ds_read_b128 a[80:83], v220 offset:0
  s_add_u32 m0, s30, 65792
  v_mfma_f32_16x16x32_bf16 v[160:163], a[88:91], a[72:75], v[160:163]
  buffer_load_dwordx4 v232, s[16:19], s60 offen offset:0 nt lds
  v_mfma_f32_16x16x32_bf16 v[160:163], a[92:95], a[76:79], v[160:163]
  ds_read_b128 a[84:87], v221 offset:0
  v_add_u32 v252, 1, v252
  v_mfma_f32_16x16x32_bf16 v[164:167], a[108:111], a[76:79], v[208:211]
  ds_read_b128 a[88:91], v222 offset:0
  v_cvt_pk_bf16_f32 v178, v180, v181
  v_mfma_f32_16x16x32_bf16 v[164:167], a[104:107], a[72:75], v[164:167]
  ds_read_b128 a[104:107], v222 offset:4096
  v_cvt_pk_bf16_f32 v179, v182, v183
  v_mfma_f32_16x16x32_bf16 v[164:167], a[100:103], a[68:71], v[164:167]
  ds_read_b128 a[100:103], v221 offset:4096
  v_mfma_f32_16x16x32_bf16 v[164:167], a[96:99], a[64:67], v[164:167]
  ds_read_b128 a[92:95], v223 offset:0
  ds_read_b128 a[108:111], v223 offset:4096
  v_mfma_f32_16x16x32_bf16 v[168:171], a[112:115], a[64:67], v[208:211]
  ds_read_b128 a[96:99], v220 offset:4096
  v_cvt_pk_bf16_f32 v180, v184, v185
  v_mfma_f32_16x16x32_bf16 v[168:171], a[116:119], a[68:71], v[168:171]
  ds_read_b128 a[112:115], v220 offset:8192
  v_mfma_f32_16x16x32_bf16 v[168:171], a[120:123], a[72:75], v[168:171]
  ds_read_b128 a[116:119], v221 offset:8192
  ds_read_b128 a[120:123], v222 offset:8192
  v_mfma_f32_16x16x32_bf16 v[168:171], a[124:127], a[76:79], v[168:171]
  buffer_load_dwordx4 v233, s[16:19], s60 offen offset:1024 nt lds
  v_mfma_f32_16x16x32_bf16 v[172:175], a[140:143], a[76:79], v[208:211]
  ds_read_b128 a[124:127], v223 offset:8192
  v_cvt_pk_bf16_f32 v181, v186, v187
  v_mfma_f32_16x16x32_bf16 v[172:175], a[136:139], a[72:75], v[172:175]
  ds_read_b128 a[136:139], v222 offset:12288
  v_cvt_pk_bf16_f32 v182, v188, v189
  v_mfma_f32_16x16x32_bf16 v[172:175], a[132:135], a[68:71], v[172:175]
  ds_read_b128 a[140:143], v223 offset:12288
  v_cvt_pk_bf16_f32 v183, v190, v191
  v_mfma_f32_16x16x32_bf16 v[172:175], a[128:131], a[64:67], v[172:175]
  ds_read_b128 a[132:135], v221 offset:12288
  ds_read_b128 a[128:131], v220 offset:12288
  v_mfma_f32_16x16x32_bf16 v[96:99], a[144:147], v[176:179], v[96:99]
  v_exp_f32 v161, v161
  v_mfma_f32_16x16x32_bf16 v[96:99], a[176:179], v[180:183], v[96:99]
  v_exp_f32 v160, v160
  v_mfma_f32_16x16x32_bf16 v[100:103], a[180:183], v[180:183], v[100:103]
  v_exp_f32 v168, v168
  v_mfma_f32_16x16x32_bf16 v[100:103], a[148:151], v[176:179], v[100:103]
  buffer_load_dwordx4 v234, s[16:19], s60 offen offset:2048 nt lds
  v_mfma_f32_16x16x32_bf16 v[104:107], a[152:155], v[176:179], v[104:107]
  v_mfma_f32_16x16x32_bf16 v[104:107], a[184:187], v[180:183], v[104:107]
  v_exp_f32 v173, v173
  v_mfma_f32_16x16x32_bf16 v[108:111], a[188:191], v[180:183], v[108:111]
  v_exp_f32 v170, v170
  v_mfma_f32_16x16x32_bf16 v[108:111], a[156:159], v[176:179], v[108:111]
  v_exp_f32 v163, v163
  v_mfma_f32_16x16x32_bf16 v[112:115], a[160:163], v[176:179], v[112:115]
  v_exp_f32 v165, v165
  v_mfma_f32_16x16x32_bf16 v[112:115], a[192:195], v[180:183], v[112:115]
  v_exp_f32 v169, v169
  v_mfma_f32_16x16x32_bf16 v[116:119], a[196:199], v[180:183], v[116:119]
  v_exp_f32 v167, v167
  v_mfma_f32_16x16x32_bf16 v[116:119], a[164:167], v[176:179], v[116:119]
  s_waitcnt vmcnt(17) lgkmcnt(0)
  ds_write_b32 v253, v252
  v_mfma_f32_16x16x32_bf16 v[120:123], a[168:171], v[176:179], v[120:123]
  v_exp_f32 v162, v162
  v_mfma_f32_16x16x32_bf16 v[120:123], a[200:203], v[180:183], v[120:123]
  v_exp_f32 v166, v166
  v_mfma_f32_16x16x32_bf16 v[124:127], a[204:207], v[180:183], v[124:127]
  v_exp_f32 v175, v175
  v_mfma_f32_16x16x32_bf16 v[124:127], a[172:175], v[176:179], v[124:127]
  v_cvt_pk_bf16_f32 v160, v160, v161
  v_smfmac_f32_16x16x64_bf16 a[220:223], a[228:231], v[176:183], v254
  v_mfma_f32_16x16x32_bf16 v[176:179], a[80:83], a[0:3], v[192:195]
  v_exp_f32 v171, v171
  v_mfma_f32_16x16x32_bf16 v[176:179], a[84:87], a[4:7], v[176:179]
  v_exp_f32 v164, v164
  v_mfma_f32_16x16x32_bf16 v[176:179], a[88:91], a[8:11], v[176:179]
  buffer_load_dwordx4 v235, s[16:19], s60 offen offset:3072 nt lds
  v_mfma_f32_16x16x32_bf16 v[176:179], a[92:95], a[12:15], v[176:179]
  v_exp_f32 v174, v174
  v_mfma_f32_16x16x32_bf16 v[180:183], a[108:111], a[12:15], v[192:195]
  v_exp_f32 v172, v172
  v_mfma_f32_16x16x32_bf16 v[180:183], a[104:107], a[8:11], v[180:183]
  v_cvt_pk_bf16_f32 v161, v162, v163
  v_cvt_pk_bf16_f32 v162, v164, v165
  v_mfma_f32_16x16x32_bf16 v[180:183], a[100:103], a[4:7], v[180:183]
  s_add_u32 m0, s31, 8192
  v_mfma_f32_16x16x32_bf16 v[180:183], a[96:99], a[0:3], v[180:183]
  ds_read_b32 v251, v250
  v_cvt_pk_bf16_f32 v163, v166, v167
  v_mfma_f32_16x16x32_bf16 v[184:187], a[112:115], a[0:3], v[192:195]
  v_exp_f32 v177, v177
  v_mfma_f32_16x16x32_bf16 v[184:187], a[116:119], a[4:7], v[184:187]
  v_cvt_pk_bf16_f32 v164, v168, v169
  v_cvt_pk_bf16_f32 v165, v170, v171
  v_mfma_f32_16x16x32_bf16 v[184:187], a[120:123], a[8:11], v[184:187]
  buffer_load_dwordx4 v234, s[12:15], s43 offen offset:2048 nt lds
  v_mfma_f32_16x16x32_bf16 v[184:187], a[124:127], a[12:15], v[184:187]
  v_exp_f32 v178, v178
  v_mfma_f32_16x16x32_bf16 v[188:191], a[140:143], a[12:15], v[192:195]
  v_exp_f32 v183, v183
  v_mfma_f32_16x16x32_bf16 v[188:191], a[136:139], a[8:11], v[188:191]
  s_waitcnt lgkmcnt(0)
  v_cmp_gt_u32 vcc, v252, v251
  v_mfma_f32_16x16x32_bf16 v[188:191], a[132:135], a[4:7], v[188:191]
  v_cvt_pk_bf16_f32 v166, v172, v173
  v_cvt_pk_bf16_f32 v167, v174, v175
  v_mfma_f32_16x16x32_bf16 v[188:191], a[128:131], a[0:3], v[188:191]
  v_exp_f32 v180, v180
  v_mfma_f32_16x16x32_bf16 v[128:131], a[144:147], v[160:163], v[128:131]
  s_cbranch_vccnz L_SPIN11
  L_BACK11:
  v_mfma_f32_16x16x32_bf16 v[128:131], a[176:179], v[164:167], v[128:131]
  v_exp_f32 v186, v186
  v_mfma_f32_16x16x32_bf16 v[132:135], a[180:183], v[164:167], v[132:135]
  ds_read_b64_tr_b16 a[146:147], v224 offset:4096
  ds_read_b64_tr_b16 a[176:177], v224 offset:8192
  v_mfma_f32_16x16x32_bf16 v[132:135], a[148:151], v[160:163], v[132:135]
  v_exp_f32 v181, v181
  v_mfma_f32_16x16x32_bf16 v[136:139], a[152:155], v[160:163], v[136:139]
  v_exp_f32 v176, v176
  v_mfma_f32_16x16x32_bf16 v[136:139], a[184:187], v[164:167], v[136:139]
  ds_read_b64_tr_b16 a[144:145], v224 offset:0
  ds_read_b64_tr_b16 a[148:149], v225 offset:0
  v_mfma_f32_16x16x32_bf16 v[140:143], a[188:191], v[164:167], v[140:143]
  ds_read_b64_tr_b16 a[178:179], v224 offset:12288
  ds_read_b64_tr_b16 a[182:183], v225 offset:12288
  v_mfma_f32_16x16x32_bf16 v[140:143], a[156:159], v[160:163], v[140:143]
  ds_read_b64_tr_b16 a[180:181], v225 offset:8192
  ds_read_b64_tr_b16 a[150:151], v225 offset:4096
  v_mfma_f32_16x16x32_bf16 v[144:147], a[160:163], v[160:163], v[144:147]
  v_exp_f32 v188, v188
  v_mfma_f32_16x16x32_bf16 v[144:147], a[192:195], v[164:167], v[144:147]
  v_exp_f32 v185, v185
  v_mfma_f32_16x16x32_bf16 v[148:151], a[196:199], v[164:167], v[148:151]
  ds_read_b64_tr_b16 a[152:153], v226 offset:0
  ds_read_b64_tr_b16 a[154:155], v226 offset:4096
  v_mfma_f32_16x16x32_bf16 v[148:151], a[164:167], v[160:163], v[148:151]
  v_exp_f32 v191, v191
  v_mfma_f32_16x16x32_bf16 v[152:155], a[168:171], v[160:163], v[152:155]
  ds_read_b64_tr_b16 a[184:185], v226 offset:8192
  ds_read_b64_tr_b16 a[188:189], v227 offset:8192
  v_mfma_f32_16x16x32_bf16 v[152:155], a[200:203], v[164:167], v[152:155]
  ds_read_b64_tr_b16 a[158:159], v227 offset:4096
  v_cvt_pk_bf16_f32 v176, v176, v177
  v_mfma_f32_16x16x32_bf16 v[156:159], a[204:207], v[164:167], v[156:159]
  v_exp_f32 v179, v179
  v_mfma_f32_16x16x32_bf16 v[156:159], a[172:175], v[160:163], v[156:159]
  v_exp_f32 v187, v187
  v_smfmac_f32_16x16x64_bf16 a[224:227], a[228:231], v[160:167], v254
  ds_read_b64_tr_b16 a[186:187], v226 offset:12288
  v_mfma_f32_16x16x32_bf16 v[160:163], a[80:83], a[16:19], v[196:199]
  v_exp_f32 v182, v182
  v_mfma_f32_16x16x32_bf16 v[160:163], a[84:87], a[20:23], v[160:163]
  v_exp_f32 v184, v184
  v_mfma_f32_16x16x32_bf16 v[160:163], a[88:91], a[24:27], v[160:163]
  ds_read_b64_tr_b16 a[190:191], v227 offset:12288
  v_mfma_f32_16x16x32_bf16 v[160:163], a[92:95], a[28:31], v[160:163]
  ds_read_b64_tr_b16 a[156:157], v227 offset:0
  ds_read_b64_tr_b16 a[160:161], v228 offset:0
  v_mfma_f32_16x16x32_bf16 v[164:167], a[108:111], a[28:31], v[196:199]
  ds_read_b64_tr_b16 a[196:197], v229 offset:8192
  v_cvt_pk_bf16_f32 v177, v178, v179
  v_mfma_f32_16x16x32_bf16 v[164:167], a[104:107], a[24:27], v[164:167]
  ds_read_b64_tr_b16 a[194:195], v228 offset:12288
  v_cvt_pk_bf16_f32 v178, v180, v181
  v_mfma_f32_16x16x32_bf16 v[164:167], a[100:103], a[20:23], v[164:167]
  ds_read_b64_tr_b16 a[162:163], v228 offset:4096
  ds_read_b64_tr_b16 a[192:193], v228 offset:8192
  v_mfma_f32_16x16x32_bf16 v[164:167], a[96:99], a[16:19], v[164:167]
  ds_read_b64_tr_b16 a[164:165], v229 offset:0
  v_cvt_pk_bf16_f32 v179, v182, v183
  v_mfma_f32_16x16x32_bf16 v[168:171], a[112:115], a[16:19], v[196:199]
  ds_read_b128 a[252:255], v239 offset:9216
  v_cvt_pk_bf16_f32 v180, v184, v185
  v_mfma_f32_16x16x32_bf16 v[168:171], a[116:119], a[20:23], v[168:171]
  ds_read_b64_tr_b16 a[166:167], v229 offset:4096
  ds_read_b64_tr_b16 a[168:169], v230 offset:0
  v_mfma_f32_16x16x32_bf16 v[168:171], a[120:123], a[24:27], v[168:171]
  v_exp_f32 v189, v189
  v_mfma_f32_16x16x32_bf16 v[168:171], a[124:127], a[28:31], v[168:171]
  ds_read_b64_tr_b16 a[198:199], v229 offset:12288
  v_cvt_pk_bf16_f32 v181, v186, v187
  v_mfma_f32_16x16x32_bf16 v[172:175], a[140:143], a[28:31], v[196:199]
  ds_read_b64_tr_b16 a[206:207], v231 offset:12288
  v_cvt_pk_bf16_f32 v182, v188, v189
  v_mfma_f32_16x16x32_bf16 v[172:175], a[136:139], a[24:27], v[172:175]
  v_exp_f32 v190, v190
  v_mfma_f32_16x16x32_bf16 v[172:175], a[132:135], a[20:23], v[172:175]
  ds_read_b64_tr_b16 a[202:203], v230 offset:12288
  v_cvt_pk_bf16_f32 v183, v190, v191
  v_mfma_f32_16x16x32_bf16 v[172:175], a[128:131], a[16:19], v[172:175]
  ds_read_b64_tr_b16 a[200:201], v230 offset:8192
  s_waitcnt lgkmcnt(4)
  v_mfma_f32_16x16x32_bf16 v[0:3], a[144:147], v[176:179], v[0:3]
  ds_read_b64_tr_b16 a[170:171], v230 offset:4096
  v_mfma_f32_16x16x32_bf16 v[0:3], a[176:179], v[180:183], v[0:3]
  ds_read_b64_tr_b16 a[204:205], v231 offset:8192
  v_mfma_f32_16x16x32_bf16 v[4:7], a[180:183], v[180:183], v[4:7]
  ds_read_b64_tr_b16 a[172:173], v231 offset:0
  v_mfma_f32_16x16x32_bf16 v[4:7], a[148:151], v[176:179], v[4:7]
  ds_read_b64_tr_b16 a[174:175], v231 offset:4096
  v_mfma_f32_16x16x32_bf16 v[8:11], a[152:155], v[176:179], v[8:11]
  v_exp_f32 v162, v162
  v_mfma_f32_16x16x32_bf16 v[8:11], a[184:187], v[180:183], v[8:11]
  v_mfma_f32_16x16x32_bf16 v[12:15], a[188:191], v[180:183], v[12:15]
  buffer_store_dwordx4 a[252:255], v238, s[24:27], s43 offen offset:2048
  v_mfma_f32_16x16x32_bf16 v[12:15], a[156:159], v[176:179], v[12:15]
  v_exp_f32 v168, v168
  v_mfma_f32_16x16x32_bf16 v[16:19], a[160:163], v[176:179], v[16:19]
  v_exp_f32 v164, v164
  v_mfma_f32_16x16x32_bf16 v[16:19], a[192:195], v[180:183], v[16:19]
  v_exp_f32 v173, v173
  s_waitcnt lgkmcnt(0)
  v_mfma_f32_16x16x32_bf16 v[20:23], a[196:199], v[180:183], v[20:23]
  v_exp_f32 v161, v161
  v_mfma_f32_16x16x32_bf16 v[20:23], a[164:167], v[176:179], v[20:23]
  s_add_u32 m0, s30, 256
  v_mfma_f32_16x16x32_bf16 v[24:27], a[168:171], v[176:179], v[24:27]
  buffer_load_dwordx4 v236, s[20:23], s60 offen offset:0  lds
  v_mfma_f32_16x16x32_bf16 v[24:27], a[200:203], v[180:183], v[24:27]
  v_mfma_f32_16x16x32_bf16 v[28:31], a[204:207], v[180:183], v[28:31]
  v_exp_f32 v171, v171
  v_mfma_f32_16x16x32_bf16 v[28:31], a[172:175], v[176:179], v[28:31]
  v_exp_f32 v172, v172
  v_smfmac_f32_16x16x64_bf16 a[208:211], a[228:231], v[176:183], v254
  v_mfma_f32_16x16x32_bf16 v[176:179], a[80:83], a[32:35], v[200:203]
  v_exp_f32 v166, v166
  v_mfma_f32_16x16x32_bf16 v[176:179], a[84:87], a[36:39], v[176:179]
  v_exp_f32 v163, v163
  v_mfma_f32_16x16x32_bf16 v[176:179], a[88:91], a[40:43], v[176:179]
  v_exp_f32 v175, v175
  v_mfma_f32_16x16x32_bf16 v[176:179], a[92:95], a[44:47], v[176:179]
  v_exp_f32 v165, v165
  v_mfma_f32_16x16x32_bf16 v[180:183], a[108:111], a[44:47], v[200:203]
  v_exp_f32 v169, v169
  v_mfma_f32_16x16x32_bf16 v[180:183], a[104:107], a[40:43], v[180:183]
  buffer_load_dwordx4 v237, s[20:23], s60 offen offset:1024  lds
  v_mfma_f32_16x16x32_bf16 v[180:183], a[100:103], a[36:39], v[180:183]
  v_exp_f32 v160, v160
  v_mfma_f32_16x16x32_bf16 v[180:183], a[96:99], a[32:35], v[180:183]
  v_cvt_pk_bf16_f32 v160, v160, v161
  v_cvt_pk_bf16_f32 v161, v162, v163
  v_mfma_f32_16x16x32_bf16 v[184:187], a[112:115], a[32:35], v[200:203]
  v_exp_f32 v174, v174
  v_mfma_f32_16x16x32_bf16 v[184:187], a[116:119], a[36:39], v[184:187]
  v_exp_f32 v167, v167
  v_mfma_f32_16x16x32_bf16 v[184:187], a[120:123], a[40:43], v[184:187]
  v_exp_f32 v170, v170
  v_mfma_f32_16x16x32_bf16 v[184:187], a[124:127], a[44:47], v[184:187]
  v_exp_f32 v176, v176
  v_mfma_f32_16x16x32_bf16 v[188:191], a[140:143], a[44:47], v[200:203]
  v_cvt_pk_bf16_f32 v162, v164, v165
  v_cvt_pk_bf16_f32 v163, v166, v167
  v_mfma_f32_16x16x32_bf16 v[188:191], a[136:139], a[40:43], v[188:191]
  v_cvt_pk_bf16_f32 v164, v168, v169
  v_cvt_pk_bf16_f32 v165, v170, v171
  v_mfma_f32_16x16x32_bf16 v[188:191], a[132:135], a[36:39], v[188:191]
  buffer_load_dwordx4 v236, s[20:23], s60 offen offset:2048  lds
  v_mfma_f32_16x16x32_bf16 v[188:191], a[128:131], a[32:35], v[188:191]
  v_cvt_pk_bf16_f32 v166, v172, v173
  v_cvt_pk_bf16_f32 v167, v174, v175
  v_mfma_f32_16x16x32_bf16 v[32:35], a[144:147], v[160:163], v[32:35]
  v_exp_f32 v182, v182
  v_mfma_f32_16x16x32_bf16 v[32:35], a[176:179], v[164:167], v[32:35]
  v_mfma_f32_16x16x32_bf16 v[36:39], a[180:183], v[164:167], v[36:39]
  v_exp_f32 v186, v186
  v_mfma_f32_16x16x32_bf16 v[36:39], a[148:151], v[160:163], v[36:39]
  v_exp_f32 v180, v180
  v_mfma_f32_16x16x32_bf16 v[40:43], a[152:155], v[160:163], v[40:43]
  v_exp_f32 v179, v179
  v_mfma_f32_16x16x32_bf16 v[40:43], a[184:187], v[164:167], v[40:43]
  v_exp_f32 v185, v185
  v_mfma_f32_16x16x32_bf16 v[44:47], a[188:191], v[164:167], v[44:47]
  buffer_load_dwordx4 v237, s[20:23], s60 offen offset:3072  lds
  v_mfma_f32_16x16x32_bf16 v[44:47], a[156:159], v[160:163], v[44:47]
  v_exp_f32 v177, v177
  v_mfma_f32_16x16x32_bf16 v[48:51], a[160:163], v[160:163], v[48:51]
  v_mfma_f32_16x16x32_bf16 v[48:51], a[192:195], v[164:167], v[48:51]
  v_exp_f32 v178, v178
  v_mfma_f32_16x16x32_bf16 v[52:55], a[196:199], v[164:167], v[52:55]
  v_add_u32 v252, 1, v252
  v_mfma_f32_16x16x32_bf16 v[52:55], a[164:167], v[160:163], v[52:55]
  v_exp_f32 v183, v183
  v_mfma_f32_16x16x32_bf16 v[56:59], a[168:171], v[160:163], v[56:59]
  v_mfma_f32_16x16x32_bf16 v[56:59], a[200:203], v[164:167], v[56:59]
  v_exp_f32 v181, v181
  v_mfma_f32_16x16x32_bf16 v[60:63], a[204:207], v[164:167], v[60:63]
  v_exp_f32 v191, v191
  v_mfma_f32_16x16x32_bf16 v[60:63], a[172:175], v[160:163], v[60:63]
  v_exp_f32 v184, v184
  v_smfmac_f32_16x16x64_bf16 a[212:215], a[228:231], v[160:167], v254
  v_cvt_pk_bf16_f32 v176, v176, v177
  v_mfma_f32_16x16x32_bf16 v[160:163], a[80:83], a[48:51], v[204:207]
  ds_read_b128 a[252:255], v255 offset:9728
  v_cvt_pk_bf16_f32 v177, v178, v179
  v_mfma_f32_16x16x32_bf16 v[160:163], a[84:87], a[52:55], v[160:163]
  v_cvt_pk_bf16_f32 v178, v180, v181
  v_mfma_f32_16x16x32_bf16 v[160:163], a[88:91], a[56:59], v[160:163]
  v_cvt_pk_bf16_f32 v179, v182, v183
  v_cvt_pk_bf16_f32 v180, v184, v185
  v_mfma_f32_16x16x32_bf16 v[160:163], a[92:95], a[60:63], v[160:163]
  v_exp_f32 v189, v189
  v_mfma_f32_16x16x32_bf16 v[164:167], a[108:111], a[60:63], v[204:207]
  v_exp_f32 v187, v187
  v_mfma_f32_16x16x32_bf16 v[164:167], a[104:107], a[56:59], v[164:167]
  v_cvt_pk_bf16_f32 v181, v186, v187
  v_mfma_f32_16x16x32_bf16 v[164:167], a[100:103], a[52:55], v[164:167]
  v_mfma_f32_16x16x32_bf16 v[164:167], a[96:99], a[48:51], v[164:167]
  v_exp_f32 v188, v188
  v_mfma_f32_16x16x32_bf16 v[168:171], a[112:115], a[48:51], v[204:207]
  v_cvt_pk_bf16_f32 v182, v188, v189
  v_mfma_f32_16x16x32_bf16 v[168:171], a[116:119], a[52:55], v[168:171]
  v_exp_f32 v163, v163
  v_mfma_f32_16x16x32_bf16 v[168:171], a[120:123], a[56:59], v[168:171]
  s_waitcnt vmcnt(18)
  ds_write_b32 v253, v252
  v_mfma_f32_16x16x32_bf16 v[168:171], a[124:127], a[60:63], v[168:171]
  v_exp_f32 v190, v190
  v_mfma_f32_16x16x32_bf16 v[172:175], a[140:143], a[60:63], v[204:207]
  v_exp_f32 v165, v165
  v_mfma_f32_16x16x32_bf16 v[172:175], a[136:139], a[56:59], v[172:175]
  v_exp_f32 v164, v164
  v_mfma_f32_16x16x32_bf16 v[172:175], a[132:135], a[52:55], v[172:175]
  v_exp_f32 v160, v160
  v_mfma_f32_16x16x32_bf16 v[172:175], a[128:131], a[48:51], v[172:175]
  s_add_u32 m0, s31, 8192
  v_cvt_pk_bf16_f32 v183, v190, v191
  v_mfma_f32_16x16x32_bf16 v[64:67], a[144:147], v[176:179], v[64:67]
  v_exp_f32 v166, v166
  v_mfma_f32_16x16x32_bf16 v[64:67], a[176:179], v[180:183], v[64:67]
  v_exp_f32 v171, v171
  v_mfma_f32_16x16x32_bf16 v[68:71], a[180:183], v[180:183], v[68:71]
  v_exp_f32 v170, v170
  v_mfma_f32_16x16x32_bf16 v[68:71], a[148:151], v[176:179], v[68:71]
  v_exp_f32 v168, v168
  v_mfma_f32_16x16x32_bf16 v[72:75], a[152:155], v[176:179], v[72:75]
  s_waitcnt lgkmcnt(0)
  buffer_store_dwordx4 a[252:255], v238, s[24:27], s43 offen offset:3072
  v_mfma_f32_16x16x32_bf16 v[72:75], a[184:187], v[180:183], v[72:75]
  v_exp_f32 v169, v169
  v_mfma_f32_16x16x32_bf16 v[76:79], a[188:191], v[180:183], v[76:79]
  v_exp_f32 v173, v173
  v_mfma_f32_16x16x32_bf16 v[76:79], a[156:159], v[176:179], v[76:79]
  v_exp_f32 v175, v175
  v_mfma_f32_16x16x32_bf16 v[80:83], a[160:163], v[176:179], v[80:83]
  v_exp_f32 v174, v174
  v_mfma_f32_16x16x32_bf16 v[80:83], a[192:195], v[180:183], v[80:83]
  v_exp_f32 v161, v161
  v_mfma_f32_16x16x32_bf16 v[84:87], a[196:199], v[180:183], v[84:87]
  ds_read_b32 v251, v250
  v_mfma_f32_16x16x32_bf16 v[84:87], a[164:167], v[176:179], v[84:87]
  v_exp_f32 v162, v162
  v_mfma_f32_16x16x32_bf16 v[88:91], a[168:171], v[176:179], v[88:91]
  v_exp_f32 v167, v167
  v_mfma_f32_16x16x32_bf16 v[88:91], a[200:203], v[180:183], v[88:91]
  buffer_load_dwordx4 v233, s[12:15], s43 offen offset:1024 nt lds
  v_mfma_f32_16x16x32_bf16 v[92:95], a[204:207], v[180:183], v[92:95]
  v_exp_f32 v172, v172
  v_mfma_f32_16x16x32_bf16 v[92:95], a[172:175], v[176:179], v[92:95]
  s_waitcnt lgkmcnt(0)
  v_cmp_gt_u32 vcc, v252, v251
  v_smfmac_f32_16x16x64_bf16 a[216:219], a[228:231], v[176:183], v254
  v_mfma_f32_16x16x32_bf16 v[176:179], a[80:83], a[64:67], v[208:211]
  s_cbranch_vccnz L_SPIN12
  L_BACK12:
  v_mfma_f32_16x16x32_bf16 v[176:179], a[84:87], a[68:71], v[176:179]
  ds_read_b128 a[84:87], v221 offset:32768
  v_cvt_pk_bf16_f32 v160, v160, v161
  v_mfma_f32_16x16x32_bf16 v[176:179], a[88:91], a[72:75], v[176:179]
  ds_read_b128 a[88:91], v222 offset:32768
  s_add_u32 m0, s30, 16640
  v_mfma_f32_16x16x32_bf16 v[176:179], a[92:95], a[76:79], v[176:179]
  ds_read_b128 a[80:83], v220 offset:32768
  v_cvt_pk_bf16_f32 v161, v162, v163
  v_mfma_f32_16x16x32_bf16 v[180:183], a[108:111], a[76:79], v[208:211]
  buffer_load_dwordx4 v232, s[16:19], s61 offen offset:0 nt lds
  v_mfma_f32_16x16x32_bf16 v[180:183], a[104:107], a[72:75], v[180:183]
  ds_read_b128 a[92:95], v223 offset:32768
  ds_read_b128 a[104:107], v222 offset:36864
  v_mfma_f32_16x16x32_bf16 v[180:183], a[100:103], a[68:71], v[180:183]
  ds_read_b128 a[108:111], v223 offset:36864
  v_cvt_pk_bf16_f32 v162, v164, v165
  v_mfma_f32_16x16x32_bf16 v[180:183], a[96:99], a[64:67], v[180:183]
  ds_read_b128 a[100:103], v221 offset:36864
  v_cvt_pk_bf16_f32 v163, v166, v167
  v_mfma_f32_16x16x32_bf16 v[184:187], a[112:115], a[64:67], v[208:211]
  ds_read_b128 a[96:99], v220 offset:36864
  v_cvt_pk_bf16_f32 v164, v168, v169
  v_mfma_f32_16x16x32_bf16 v[184:187], a[116:119], a[68:71], v[184:187]
  ds_read_b128 a[116:119], v221 offset:40960
  v_mfma_f32_16x16x32_bf16 v[184:187], a[120:123], a[72:75], v[184:187]
  ds_read_b128 a[120:123], v222 offset:40960
  v_cvt_pk_bf16_f32 v165, v170, v171
  v_mfma_f32_16x16x32_bf16 v[184:187], a[124:127], a[76:79], v[184:187]
  buffer_load_dwordx4 v233, s[16:19], s61 offen offset:1024 nt lds
  v_mfma_f32_16x16x32_bf16 v[188:191], a[140:143], a[76:79], v[208:211]
  ds_read_b128 a[112:115], v220 offset:40960
  ds_read_b128 a[140:143], v223 offset:45056
  v_mfma_f32_16x16x32_bf16 v[188:191], a[136:139], a[72:75], v[188:191]
  ds_read_b128 a[124:127], v223 offset:40960
  ds_read_b128 a[136:139], v222 offset:45056
  v_mfma_f32_16x16x32_bf16 v[188:191], a[132:135], a[68:71], v[188:191]
  ds_read_b128 a[132:135], v221 offset:45056
  v_cvt_pk_bf16_f32 v166, v172, v173
  v_mfma_f32_16x16x32_bf16 v[188:191], a[128:131], a[64:67], v[188:191]
  ds_read_b128 a[128:131], v220 offset:45056
  v_cvt_pk_bf16_f32 v167, v174, v175
  v_mfma_f32_16x16x32_bf16 v[96:99], a[144:147], v[160:163], v[96:99]
  v_exp_f32 v181, v181
  v_mfma_f32_16x16x32_bf16 v[96:99], a[176:179], v[164:167], v[96:99]
  v_exp_f32 v176, v176
  v_mfma_f32_16x16x32_bf16 v[100:103], a[180:183], v[164:167], v[100:103]
  v_exp_f32 v184, v184
  v_mfma_f32_16x16x32_bf16 v[100:103], a[148:151], v[160:163], v[100:103]
  buffer_load_dwordx4 v234, s[16:19], s61 offen offset:2048 nt lds
  v_mfma_f32_16x16x32_bf16 v[104:107], a[152:155], v[160:163], v[104:107]
  v_exp_f32 v191, v191
  v_mfma_f32_16x16x32_bf16 v[104:107], a[184:187], v[164:167], v[104:107]
  v_exp_f32 v179, v179
  v_mfma_f32_16x16x32_bf16 v[108:111], a[188:191], v[164:167], v[108:111]
  v_add_u32 v252, 1, v252
  v_mfma_f32_16x16x32_bf16 v[108:111], a[156:159], v[160:163], v[108:111]
  v_exp_f32 v182, v182
  v_mfma_f32_16x16x32_bf16 v[112:115], a[160:163], v[160:163], v[112:115]
  v_exp_f32 v183, v183
  v_mfma_f32_16x16x32_bf16 v[112:115], a[192:195], v[164:167], v[112:115]
  v_exp_f32 v185, v185
  v_mfma_f32_16x16x32_bf16 v[116:119], a[196:199], v[164:167], v[116:119]
  v_exp_f32 v189, v189
  v_mfma_f32_16x16x32_bf16 v[116:119], a[164:167], v[160:163], v[116:119]
  s_waitcnt vmcnt(17) lgkmcnt(0)
  ds_write_b32 v253, v252
  v_mfma_f32_16x16x32_bf16 v[120:123], a[168:171], v[160:163], v[120:123]
  v_exp_f32 v190, v190
  v_mfma_f32_16x16x32_bf16 v[120:123], a[200:203], v[164:167], v[120:123]
  v_exp_f32 v178, v178
  v_mfma_f32_16x16x32_bf16 v[124:127], a[204:207], v[164:167], v[124:127]
  v_exp_f32 v188, v188
  v_mfma_f32_16x16x32_bf16 v[124:127], a[172:175], v[160:163], v[124:127]
  v_exp_f32 v177, v177
  v_smfmac_f32_16x16x64_bf16 a[220:223], a[228:231], v[160:167], v254
  v_mfma_f32_16x16x32_bf16 v[160:163], a[80:83], a[0:3], v[192:195]
  v_exp_f32 v187, v187
  v_mfma_f32_16x16x32_bf16 v[160:163], a[84:87], a[4:7], v[160:163]
  v_exp_f32 v186, v186
  v_mfma_f32_16x16x32_bf16 v[160:163], a[88:91], a[8:11], v[160:163]
  buffer_load_dwordx4 v235, s[16:19], s61 offen offset:3072 nt lds
  v_mfma_f32_16x16x32_bf16 v[160:163], a[92:95], a[12:15], v[160:163]
  v_exp_f32 v180, v180
  v_mfma_f32_16x16x32_bf16 v[164:167], a[108:111], a[12:15], v[192:195]
  v_cvt_pk_bf16_f32 v176, v176, v177
  v_cvt_pk_bf16_f32 v177, v178, v179
  v_mfma_f32_16x16x32_bf16 v[164:167], a[104:107], a[8:11], v[164:167]
  s_add_u32 m0, s31, 8192
  v_cvt_pk_bf16_f32 v178, v180, v181
  v_mfma_f32_16x16x32_bf16 v[164:167], a[100:103], a[4:7], v[164:167]
  v_cvt_pk_bf16_f32 v179, v182, v183
  v_cvt_pk_bf16_f32 v180, v184, v185
  v_mfma_f32_16x16x32_bf16 v[164:167], a[96:99], a[0:3], v[164:167]
  v_cvt_pk_bf16_f32 v181, v186, v187
  v_cvt_pk_bf16_f32 v182, v188, v189
  v_mfma_f32_16x16x32_bf16 v[168:171], a[112:115], a[0:3], v[192:195]
  ds_read_b32 v251, v250
  v_cvt_pk_bf16_f32 v183, v190, v191
  v_mfma_f32_16x16x32_bf16 v[168:171], a[116:119], a[4:7], v[168:171]
  v_exp_f32 v163, v163
  v_mfma_f32_16x16x32_bf16 v[168:171], a[120:123], a[8:11], v[168:171]
  v_exp_f32 v161, v161
  v_mfma_f32_16x16x32_bf16 v[168:171], a[124:127], a[12:15], v[168:171]
  v_exp_f32 v162, v162
  v_mfma_f32_16x16x32_bf16 v[172:175], a[140:143], a[12:15], v[192:195]
  v_exp_f32 v164, v164
  v_mfma_f32_16x16x32_bf16 v[172:175], a[136:139], a[8:11], v[172:175]
  s_waitcnt lgkmcnt(0)
  v_cmp_gt_u32 vcc, v252, v251
  v_mfma_f32_16x16x32_bf16 v[172:175], a[132:135], a[4:7], v[172:175]
  v_exp_f32 v166, v166
  v_mfma_f32_16x16x32_bf16 v[172:175], a[128:131], a[0:3], v[172:175]
  buffer_load_dwordx4 v235, s[12:15], s43 offen offset:3072 nt lds
  v_mfma_f32_16x16x32_bf16 v[128:131], a[144:147], v[176:179], v[128:131]
  s_cbranch_vccnz L_SPIN13
  L_BACK13:
  v_mfma_f32_16x16x32_bf16 v[128:131], a[176:179], v[180:183], v[128:131]
  ds_read_b64_tr_b16 a[144:145], v224 offset:32768
  v_add_u32 v221, 0x4000, v221
  v_mfma_f32_16x16x32_bf16 v[132:135], a[180:183], v[180:183], v[132:135]
  v_exp_f32 v167, v167
  v_mfma_f32_16x16x32_bf16 v[132:135], a[148:151], v[176:179], v[132:135]
  ds_read_b64_tr_b16 a[176:177], v224 offset:40960
  ds_read_b64_tr_b16 a[178:179], v224 offset:45056
  v_mfma_f32_16x16x32_bf16 v[136:139], a[152:155], v[176:179], v[136:139]
  v_exp_f32 v160, v160
  v_mfma_f32_16x16x32_bf16 v[136:139], a[184:187], v[180:183], v[136:139]
  ds_read_b64_tr_b16 a[146:147], v224 offset:36864
  ds_read_b64_tr_b16 a[182:183], v225 offset:45056
  v_mfma_f32_16x16x32_bf16 v[140:143], a[188:191], v[180:183], v[140:143]
  v_exp_f32 v169, v169
  v_mfma_f32_16x16x32_bf16 v[140:143], a[156:159], v[176:179], v[140:143]
  ds_read_b64_tr_b16 a[150:151], v225 offset:36864
  v_mfma_f32_16x16x32_bf16 v[144:147], a[160:163], v[176:179], v[144:147]
  ds_read_b64_tr_b16 a[180:181], v225 offset:40960
  ds_read_b64_tr_b16 a[154:155], v226 offset:36864
  v_mfma_f32_16x16x32_bf16 v[144:147], a[192:195], v[180:183], v[144:147]
  ds_read_b64_tr_b16 a[184:185], v226 offset:40960
  v_cvt_pk_bf16_f32 v160, v160, v161
  v_mfma_f32_16x16x32_bf16 v[148:151], a[196:199], v[180:183], v[148:151]
  v_exp_f32 v174, v174
  v_mfma_f32_16x16x32_bf16 v[148:151], a[164:167], v[176:179], v[148:151]
  ds_read_b64_tr_b16 a[148:149], v225 offset:32768
  ds_read_b64_tr_b16 a[152:153], v226 offset:32768
  v_mfma_f32_16x16x32_bf16 v[152:155], a[168:171], v[176:179], v[152:155]
  ds_read_b64_tr_b16 a[186:187], v226 offset:45056
  v_add_u32 v223, 0x4000, v223
  v_mfma_f32_16x16x32_bf16 v[152:155], a[200:203], v[180:183], v[152:155]
  v_exp_f32 v171, v171
  v_mfma_f32_16x16x32_bf16 v[156:159], a[204:207], v[180:183], v[156:159]
  ds_read_b64_tr_b16 a[188:189], v227 offset:40960
  v_cvt_pk_bf16_f32 v161, v162, v163
  v_mfma_f32_16x16x32_bf16 v[156:159], a[172:175], v[176:179], v[156:159]
  v_exp_f32 v165, v165
  v_smfmac_f32_16x16x64_bf16 a[224:227], a[228:231], v[176:183], v254
  ds_read_b64_tr_b16 a[162:163], v228 offset:36864
  v_mfma_f32_16x16x32_bf16 v[176:179], a[80:83], a[16:19], v[196:199]
  v_exp_f32 v172, v172
  v_mfma_f32_16x16x32_bf16 v[176:179], a[84:87], a[20:23], v[176:179]
  ds_read_b64_tr_b16 a[190:191], v227 offset:45056
  v_cvt_pk_bf16_f32 v162, v164, v165
  v_mfma_f32_16x16x32_bf16 v[176:179], a[88:91], a[24:27], v[176:179]
  ds_read_b64_tr_b16 a[196:197], v229 offset:40960
  v_cvt_pk_bf16_f32 v163, v166, v167
  v_mfma_f32_16x16x32_bf16 v[176:179], a[92:95], a[28:31], v[176:179]
  ds_read_b64_tr_b16 a[156:157], v227 offset:32768
  ds_read_b64_tr_b16 a[194:195], v228 offset:45056
  v_mfma_f32_16x16x32_bf16 v[180:183], a[108:111], a[28:31], v[196:199]
  ds_read_b64_tr_b16 a[158:159], v227 offset:36864
  ds_read_b64_tr_b16 a[160:161], v228 offset:32768
  v_mfma_f32_16x16x32_bf16 v[180:183], a[104:107], a[24:27], v[180:183]
  v_exp_f32 v170, v170
  v_mfma_f32_16x16x32_bf16 v[180:183], a[100:103], a[20:23], v[180:183]
  v_exp_f32 v173, v173
  v_mfma_f32_16x16x32_bf16 v[180:183], a[96:99], a[16:19], v[180:183]
  ds_read_b64_tr_b16 a[192:193], v228 offset:40960
  ds_read_b128 a[252:255], v239 offset:12288
  v_mfma_f32_16x16x32_bf16 v[184:187], a[112:115], a[16:19], v[196:199]
  v_exp_f32 v168, v168
  v_mfma_f32_16x16x32_bf16 v[184:187], a[116:119], a[20:23], v[184:187]
  ds_read_b64_tr_b16 a[164:165], v229 offset:32768
  v_cvt_pk_bf16_f32 v164, v168, v169
  v_mfma_f32_16x16x32_bf16 v[184:187], a[120:123], a[24:27], v[184:187]
  ds_read_b64_tr_b16 a[198:199], v229 offset:45056
  ds_read_b64_tr_b16 a[170:171], v230 offset:36864
  v_mfma_f32_16x16x32_bf16 v[184:187], a[124:127], a[28:31], v[184:187]
  ds_read_b64_tr_b16 a[166:167], v229 offset:36864
  v_cvt_pk_bf16_f32 v165, v170, v171
  v_mfma_f32_16x16x32_bf16 v[188:191], a[140:143], a[28:31], v[196:199]
  v_exp_f32 v175, v175
  v_mfma_f32_16x16x32_bf16 v[188:191], a[136:139], a[24:27], v[188:191]
  ds_read_b64_tr_b16 a[172:173], v231 offset:32768
  v_cvt_pk_bf16_f32 v166, v172, v173
  v_mfma_f32_16x16x32_bf16 v[188:191], a[132:135], a[20:23], v[188:191]
  ds_read_b64_tr_b16 a[168:169], v230 offset:32768
  v_cvt_pk_bf16_f32 v167, v174, v175
  v_mfma_f32_16x16x32_bf16 v[188:191], a[128:131], a[16:19], v[188:191]
  ds_read_b64_tr_b16 a[200:201], v230 offset:40960
  s_waitcnt lgkmcnt(6)
  v_mfma_f32_16x16x32_bf16 v[0:3], a[144:147], v[160:163], v[0:3]
  ds_read_b64_tr_b16 a[202:203], v230 offset:45056
  v_mfma_f32_16x16x32_bf16 v[0:3], a[176:179], v[164:167], v[0:3]
  ds_read_b64_tr_b16 a[204:205], v231 offset:40960
  v_mfma_f32_16x16x32_bf16 v[4:7], a[180:183], v[164:167], v[4:7]
  ds_read_b64_tr_b16 a[174:175], v231 offset:36864
  v_add_u32 v252, 1, v252
  v_mfma_f32_16x16x32_bf16 v[4:7], a[148:151], v[160:163], v[4:7]
  ds_read_b64_tr_b16 a[206:207], v231 offset:45056
  v_mfma_f32_16x16x32_bf16 v[8:11], a[152:155], v[160:163], v[8:11]
  v_exp_f32 v179, v179
  v_mfma_f32_16x16x32_bf16 v[8:11], a[184:187], v[164:167], v[8:11]
  v_mfma_f32_16x16x32_bf16 v[12:15], a[188:191], v[164:167], v[12:15]
  buffer_store_dwordx4 a[252:255], v238, s[24:27], s44 offen offset:0
  v_mfma_f32_16x16x32_bf16 v[12:15], a[156:159], v[160:163], v[12:15]
  v_exp_f32 v178, v178
  v_mfma_f32_16x16x32_bf16 v[16:19], a[160:163], v[160:163], v[16:19]
  v_exp_f32 v184, v184
  v_mfma_f32_16x16x32_bf16 v[16:19], a[192:195], v[164:167], v[16:19]
  v_exp_f32 v189, v189
  s_waitcnt lgkmcnt(0)
  v_mfma_f32_16x16x32_bf16 v[20:23], a[196:199], v[164:167], v[20:23]
  v_exp_f32 v182, v182
  v_mfma_f32_16x16x32_bf16 v[20:23], a[164:167], v[160:163], v[20:23]
  s_add_u32 m0, s30, 33024
  v_mfma_f32_16x16x32_bf16 v[24:27], a[168:171], v[160:163], v[24:27]
  buffer_load_dwordx4 v236, s[20:23], s61 offen offset:0  lds
  v_mfma_f32_16x16x32_bf16 v[24:27], a[200:203], v[164:167], v[24:27]
  v_exp_f32 v176, v176
  v_mfma_f32_16x16x32_bf16 v[28:31], a[204:207], v[164:167], v[28:31]
  v_exp_f32 v188, v188
  v_mfma_f32_16x16x32_bf16 v[28:31], a[172:175], v[160:163], v[28:31]
  v_exp_f32 v177, v177
  v_smfmac_f32_16x16x64_bf16 a[208:211], a[228:231], v[160:167], v254
  v_cvt_pk_bf16_f32 v176, v176, v177
  v_mfma_f32_16x16x32_bf16 v[160:163], a[80:83], a[32:35], v[200:203]
  v_exp_f32 v191, v191
  v_mfma_f32_16x16x32_bf16 v[160:163], a[84:87], a[36:39], v[160:163]
  v_exp_f32 v183, v183
  v_mfma_f32_16x16x32_bf16 v[160:163], a[88:91], a[40:43], v[160:163]
  v_exp_f32 v190, v190
  v_mfma_f32_16x16x32_bf16 v[160:163], a[92:95], a[44:47], v[160:163]
  v_exp_f32 v185, v185
  v_mfma_f32_16x16x32_bf16 v[164:167], a[108:111], a[44:47], v[200:203]
  buffer_load_dwordx4 v237, s[20:23], s61 offen offset:1024  lds
  v_mfma_f32_16x16x32_bf16 v[164:167], a[104:107], a[40:43], v[164:167]
  v_exp_f32 v180, v180
  v_mfma_f32_16x16x32_bf16 v[164:167], a[100:103], a[36:39], v[164:167]
  v_exp_f32 v181, v181
  v_mfma_f32_16x16x32_bf16 v[164:167], a[96:99], a[32:35], v[164:167]
  v_cvt_pk_bf16_f32 v177, v178, v179
  v_cvt_pk_bf16_f32 v178, v180, v181
  v_mfma_f32_16x16x32_bf16 v[168:171], a[112:115], a[32:35], v[200:203]
  v_exp_f32 v186, v186
  v_mfma_f32_16x16x32_bf16 v[168:171], a[116:119], a[36:39], v[168:171]
  v_cvt_pk_bf16_f32 v179, v182, v183
  v_mfma_f32_16x16x32_bf16 v[168:171], a[120:123], a[40:43], v[168:171]
  v_exp_f32 v187, v187
  v_mfma_f32_16x16x32_bf16 v[168:171], a[124:127], a[44:47], v[168:171]
  v_cvt_pk_bf16_f32 v180, v184, v185
  v_cvt_pk_bf16_f32 v181, v186, v187
  v_mfma_f32_16x16x32_bf16 v[172:175], a[140:143], a[44:47], v[200:203]
  v_exp_f32 v167, v167
  v_mfma_f32_16x16x32_bf16 v[172:175], a[136:139], a[40:43], v[172:175]
  v_cvt_pk_bf16_f32 v182, v188, v189
  v_cvt_pk_bf16_f32 v183, v190, v191
  v_mfma_f32_16x16x32_bf16 v[172:175], a[132:135], a[36:39], v[172:175]
  buffer_load_dwordx4 v236, s[20:23], s61 offen offset:2048  lds
  v_mfma_f32_16x16x32_bf16 v[172:175], a[128:131], a[32:35], v[172:175]
  v_add_u32 v227, 0xffffc000, v227
  v_mfma_f32_16x16x32_bf16 v[32:35], a[144:147], v[176:179], v[32:35]
  v_exp_f32 v165, v165
  v_mfma_f32_16x16x32_bf16 v[32:35], a[176:179], v[180:183], v[32:35]
  v_exp_f32 v168, v168
  v_mfma_f32_16x16x32_bf16 v[36:39], a[180:183], v[180:183], v[36:39]
  v_exp_f32 v169, v169
  v_mfma_f32_16x16x32_bf16 v[36:39], a[148:151], v[176:179], v[36:39]
  v_exp_f32 v163, v163
  v_mfma_f32_16x16x32_bf16 v[40:43], a[152:155], v[176:179], v[40:43]
  v_exp_f32 v170, v170
  v_mfma_f32_16x16x32_bf16 v[40:43], a[184:187], v[180:183], v[40:43]
  v_exp_f32 v166, v166
  v_mfma_f32_16x16x32_bf16 v[44:47], a[188:191], v[180:183], v[44:47]
  v_exp_f32 v174, v174
  v_mfma_f32_16x16x32_bf16 v[44:47], a[156:159], v[176:179], v[44:47]
  buffer_load_dwordx4 v237, s[20:23], s61 offen offset:3072  lds
  v_mfma_f32_16x16x32_bf16 v[48:51], a[160:163], v[176:179], v[48:51]
  v_mfma_f32_16x16x32_bf16 v[48:51], a[192:195], v[180:183], v[48:51]
  v_exp_f32 v160, v160
  v_mfma_f32_16x16x32_bf16 v[52:55], a[196:199], v[180:183], v[52:55]
  v_exp_f32 v161, v161
  v_mfma_f32_16x16x32_bf16 v[52:55], a[164:167], v[176:179], v[52:55]
  v_cvt_pk_bf16_f32 v160, v160, v161
  v_mfma_f32_16x16x32_bf16 v[56:59], a[168:171], v[176:179], v[56:59]
  v_exp_f32 v162, v162
  v_mfma_f32_16x16x32_bf16 v[56:59], a[200:203], v[180:183], v[56:59]
  v_exp_f32 v172, v172
  v_mfma_f32_16x16x32_bf16 v[60:63], a[204:207], v[180:183], v[60:63]
  v_exp_f32 v164, v164
  v_mfma_f32_16x16x32_bf16 v[60:63], a[172:175], v[176:179], v[60:63]
  v_exp_f32 v171, v171
  v_smfmac_f32_16x16x64_bf16 a[212:215], a[228:231], v[176:183], v254
  v_cvt_pk_bf16_f32 v161, v162, v163
  v_mfma_f32_16x16x32_bf16 v[176:179], a[80:83], a[48:51], v[204:207]
  v_cvt_pk_bf16_f32 v162, v164, v165
  v_cvt_pk_bf16_f32 v163, v166, v167
  v_mfma_f32_16x16x32_bf16 v[176:179], a[84:87], a[52:55], v[176:179]
  v_cvt_pk_bf16_f32 v164, v168, v169
  v_mfma_f32_16x16x32_bf16 v[176:179], a[88:91], a[56:59], v[176:179]
  ds_read_b128 a[252:255], v255 offset:12800
  v_cvt_pk_bf16_f32 v165, v170, v171
  v_mfma_f32_16x16x32_bf16 v[176:179], a[92:95], a[60:63], v[176:179]
  v_exp_f32 v173, v173
  v_mfma_f32_16x16x32_bf16 v[180:183], a[108:111], a[60:63], v[204:207]
  v_add_u32 v220, 0x4000, v220
  v_add_u32 v222, 0x4000, v222
  v_mfma_f32_16x16x32_bf16 v[180:183], a[104:107], a[56:59], v[180:183]
  v_exp_f32 v175, v175
  v_mfma_f32_16x16x32_bf16 v[180:183], a[100:103], a[52:55], v[180:183]
  v_add_u32 v226, 0xffffc000, v226
  v_cvt_pk_bf16_f32 v166, v172, v173
  v_mfma_f32_16x16x32_bf16 v[180:183], a[96:99], a[48:51], v[180:183]
  v_add_u32 v225, 0xffffc000, v225
  v_cvt_pk_bf16_f32 v167, v174, v175
  v_mfma_f32_16x16x32_bf16 v[184:187], a[112:115], a[48:51], v[204:207]
  s_waitcnt vmcnt(18)
  ds_write_b32 v253, v252
  v_mfma_f32_16x16x32_bf16 v[184:187], a[116:119], a[52:55], v[184:187]
  v_exp_f32 v179, v179
  v_mfma_f32_16x16x32_bf16 v[184:187], a[120:123], a[56:59], v[184:187]
  v_exp_f32 v178, v178
  v_mfma_f32_16x16x32_bf16 v[184:187], a[124:127], a[60:63], v[184:187]
  v_exp_f32 v176, v176
  v_mfma_f32_16x16x32_bf16 v[188:191], a[140:143], a[60:63], v[204:207]
  v_exp_f32 v180, v180
  v_mfma_f32_16x16x32_bf16 v[188:191], a[136:139], a[56:59], v[188:191]
  v_exp_f32 v182, v182
  v_mfma_f32_16x16x32_bf16 v[188:191], a[132:135], a[52:55], v[188:191]
  v_exp_f32 v183, v183
  v_mfma_f32_16x16x32_bf16 v[188:191], a[128:131], a[48:51], v[188:191]
  v_exp_f32 v177, v177
  v_mfma_f32_16x16x32_bf16 v[64:67], a[144:147], v[160:163], v[64:67]
  v_exp_f32 v187, v187
  v_mfma_f32_16x16x32_bf16 v[64:67], a[176:179], v[164:167], v[64:67]
  v_exp_f32 v186, v186
  v_mfma_f32_16x16x32_bf16 v[68:71], a[180:183], v[164:167], v[68:71]
  s_waitcnt lgkmcnt(0)
  buffer_store_dwordx4 a[252:255], v238, s[24:27], s44 offen offset:1024
  v_mfma_f32_16x16x32_bf16 v[68:71], a[148:151], v[160:163], v[68:71]
  v_add_u32 v228, 0xffffc000, v228
  v_cvt_pk_bf16_f32 v176, v176, v177
  v_mfma_f32_16x16x32_bf16 v[72:75], a[152:155], v[160:163], v[72:75]
  v_exp_f32 v185, v185
  v_mfma_f32_16x16x32_bf16 v[72:75], a[184:187], v[164:167], v[72:75]
  v_exp_f32 v191, v191
  v_mfma_f32_16x16x32_bf16 v[76:79], a[188:191], v[164:167], v[76:79]
  s_add_u32 m0, s31, 12288
  v_cvt_pk_bf16_f32 v177, v178, v179
  v_mfma_f32_16x16x32_bf16 v[76:79], a[156:159], v[160:163], v[76:79]
  v_exp_f32 v181, v181
  v_mfma_f32_16x16x32_bf16 v[80:83], a[160:163], v[160:163], v[80:83]
  v_cvt_pk_bf16_f32 v178, v180, v181
  v_mfma_f32_16x16x32_bf16 v[80:83], a[192:195], v[164:167], v[80:83]
  v_exp_f32 v190, v190
  v_mfma_f32_16x16x32_bf16 v[84:87], a[196:199], v[164:167], v[84:87]
  ds_read_b32 v251, v250
  v_mfma_f32_16x16x32_bf16 v[84:87], a[164:167], v[160:163], v[84:87]
  buffer_load_dwordx4 v232, s[12:15], s44 offen offset:0 nt lds
  v_mfma_f32_16x16x32_bf16 v[88:91], a[168:171], v[160:163], v[88:91]
  v_exp_f32 v184, v184
  v_mfma_f32_16x16x32_bf16 v[88:91], a[200:203], v[164:167], v[88:91]
  v_exp_f32 v189, v189
  v_mfma_f32_16x16x32_bf16 v[92:95], a[204:207], v[164:167], v[92:95]
  s_waitcnt lgkmcnt(0)
  v_cmp_gt_u32 vcc, v252, v251
  v_mfma_f32_16x16x32_bf16 v[92:95], a[172:175], v[160:163], v[92:95]
  v_exp_f32 v188, v188
  v_smfmac_f32_16x16x64_bf16 a[216:219], a[228:231], v[160:167], v254
  v_cvt_pk_bf16_f32 v179, v182, v183
  v_mfma_f32_16x16x32_bf16 v[160:163], a[80:83], a[64:67], v[208:211]
  s_cbranch_vccnz L_SPIN14
  L_BACK14:
  v_mfma_f32_16x16x32_bf16 v[160:163], a[84:87], a[68:71], v[160:163]
  ds_read_b128 a[80:83], v220 offset:49152
  s_add_u32 m0, s30, 49408
  v_mfma_f32_16x16x32_bf16 v[160:163], a[88:91], a[72:75], v[160:163]
  buffer_load_dwordx4 v232, s[16:19], s62 offen offset:0 nt lds
  v_mfma_f32_16x16x32_bf16 v[160:163], a[92:95], a[76:79], v[160:163]
  ds_read_b128 a[84:87], v221 offset:49152
  v_mfma_f32_16x16x32_bf16 v[164:167], a[108:111], a[76:79], v[208:211]
  ds_read_b128 a[108:111], v223 offset:53248
  v_cvt_pk_bf16_f32 v180, v184, v185
  v_mfma_f32_16x16x32_bf16 v[164:167], a[104:107], a[72:75], v[164:167]
  ds_read_b128 a[104:107], v222 offset:53248
  v_cvt_pk_bf16_f32 v181, v186, v187
  v_mfma_f32_16x16x32_bf16 v[164:167], a[100:103], a[68:71], v[164:167]
  ds_read_b128 a[88:91], v222 offset:49152
  ds_read_b128 a[92:95], v223 offset:49152
  v_mfma_f32_16x16x32_bf16 v[164:167], a[96:99], a[64:67], v[164:167]
  ds_read_b128 a[100:103], v221 offset:53248
  v_add_u32 v231, 0xffffc000, v231
  v_mfma_f32_16x16x32_bf16 v[168:171], a[112:115], a[64:67], v[208:211]
  ds_read_b128 a[96:99], v220 offset:53248
  v_mfma_f32_16x16x32_bf16 v[168:171], a[116:119], a[68:71], v[168:171]
  ds_read_b128 a[112:115], v220 offset:57344
  v_add_u32 v252, 1, v252
  v_mfma_f32_16x16x32_bf16 v[168:171], a[120:123], a[72:75], v[168:171]
  buffer_load_dwordx4 v233, s[16:19], s62 offen offset:1024 nt lds
  v_mfma_f32_16x16x32_bf16 v[168:171], a[124:127], a[76:79], v[168:171]
  ds_read_b128 a[124:127], v223 offset:57344
  v_add_u32 v229, 0xffffc000, v229
  v_mfma_f32_16x16x32_bf16 v[172:175], a[140:143], a[76:79], v[208:211]
  ds_read_b128 a[116:119], v221 offset:57344
  v_cvt_pk_bf16_f32 v182, v188, v189
  v_mfma_f32_16x16x32_bf16 v[172:175], a[136:139], a[72:75], v[172:175]
  ds_read_b128 a[140:143], v223 offset:61440
  v_cvt_pk_bf16_f32 v183, v190, v191
  v_mfma_f32_16x16x32_bf16 v[172:175], a[132:135], a[68:71], v[172:175]
  ds_read_b128 a[120:123], v222 offset:57344
  ds_read_b128 a[136:139], v222 offset:61440
  v_mfma_f32_16x16x32_bf16 v[172:175], a[128:131], a[64:67], v[172:175]
  ds_read_b128 a[132:135], v221 offset:61440
  ds_read_b128 a[128:131], v220 offset:61440
  v_mfma_f32_16x16x32_bf16 v[96:99], a[144:147], v[176:179], v[96:99]
  v_exp_f32 v164, v164
  v_mfma_f32_16x16x32_bf16 v[96:99], a[176:179], v[180:183], v[96:99]
  v_exp_f32 v165, v165
  v_mfma_f32_16x16x32_bf16 v[100:103], a[180:183], v[180:183], v[100:103]
  v_exp_f32 v160, v160
  v_mfma_f32_16x16x32_bf16 v[100:103], a[148:151], v[176:179], v[100:103]
  buffer_load_dwordx4 v234, s[16:19], s62 offen offset:2048 nt lds
  v_mfma_f32_16x16x32_bf16 v[104:107], a[152:155], v[176:179], v[104:107]
  v_exp_f32 v162, v162
  v_mfma_f32_16x16x32_bf16 v[104:107], a[184:187], v[180:183], v[104:107]
  v_exp_f32 v170, v170
  v_mfma_f32_16x16x32_bf16 v[108:111], a[188:191], v[180:183], v[108:111]
  v_exp_f32 v172, v172
  v_mfma_f32_16x16x32_bf16 v[108:111], a[156:159], v[176:179], v[108:111]
  v_exp_f32 v169, v169
  v_mfma_f32_16x16x32_bf16 v[112:115], a[160:163], v[176:179], v[112:115]
  v_exp_f32 v167, v167
  v_mfma_f32_16x16x32_bf16 v[112:115], a[192:195], v[180:183], v[112:115]
  v_exp_f32 v161, v161
  v_mfma_f32_16x16x32_bf16 v[116:119], a[196:199], v[180:183], v[116:119]
  v_exp_f32 v163, v163
  v_mfma_f32_16x16x32_bf16 v[116:119], a[164:167], v[176:179], v[116:119]
  s_waitcnt vmcnt(17) lgkmcnt(0)
  ds_write_b32 v253, v252
  v_mfma_f32_16x16x32_bf16 v[120:123], a[168:171], v[176:179], v[120:123]
  v_add_u32 v230, 0xffffc000, v230
  v_cvt_pk_bf16_f32 v160, v160, v161
  v_mfma_f32_16x16x32_bf16 v[120:123], a[200:203], v[180:183], v[120:123]
  v_exp_f32 v168, v168
  v_mfma_f32_16x16x32_bf16 v[124:127], a[204:207], v[180:183], v[124:127]
  v_exp_f32 v175, v175
  v_mfma_f32_16x16x32_bf16 v[124:127], a[172:175], v[176:179], v[124:127]
  v_exp_f32 v166, v166
  v_smfmac_f32_16x16x64_bf16 a[220:223], a[228:231], v[176:183], v254
  v_mfma_f32_16x16x32_bf16 v[176:179], a[80:83], a[0:3], v[192:195]
  v_exp_f32 v171, v171
  v_mfma_f32_16x16x32_bf16 v[176:179], a[84:87], a[4:7], v[176:179]
  v_exp_f32 v174, v174
  v_mfma_f32_16x16x32_bf16 v[176:179], a[88:91], a[8:11], v[176:179]
  buffer_load_dwordx4 v235, s[16:19], s62 offen offset:3072 nt lds
  v_mfma_f32_16x16x32_bf16 v[176:179], a[92:95], a[12:15], v[176:179]
  v_cvt_pk_bf16_f32 v161, v162, v163
  v_cvt_pk_bf16_f32 v162, v164, v165
  v_mfma_f32_16x16x32_bf16 v[180:183], a[108:111], a[12:15], v[192:195]
  v_cvt_pk_bf16_f32 v163, v166, v167
  v_cvt_pk_bf16_f32 v164, v168, v169
  v_mfma_f32_16x16x32_bf16 v[180:183], a[104:107], a[8:11], v[180:183]
  v_exp_f32 v173, v173
  v_mfma_f32_16x16x32_bf16 v[180:183], a[100:103], a[4:7], v[180:183]
  s_add_u32 m0, s31, 12288
  v_cvt_pk_bf16_f32 v165, v170, v171
  v_mfma_f32_16x16x32_bf16 v[180:183], a[96:99], a[0:3], v[180:183]
  v_add_u32 v224, 0xffffc000, v224
  v_cvt_pk_bf16_f32 v166, v172, v173
  v_mfma_f32_16x16x32_bf16 v[184:187], a[112:115], a[0:3], v[192:195]
  v_exp_f32 v179, v179
  v_mfma_f32_16x16x32_bf16 v[184:187], a[116:119], a[4:7], v[184:187]
  ds_read_b32 v251, v250
  v_cvt_pk_bf16_f32 v167, v174, v175
  v_mfma_f32_16x16x32_bf16 v[184:187], a[120:123], a[8:11], v[184:187]
  v_exp_f32 v177, v177
  v_mfma_f32_16x16x32_bf16 v[184:187], a[124:127], a[12:15], v[184:187]
  v_exp_f32 v176, v176
  v_mfma_f32_16x16x32_bf16 v[188:191], a[140:143], a[12:15], v[192:195]
  v_exp_f32 v182, v182
  v_mfma_f32_16x16x32_bf16 v[188:191], a[136:139], a[8:11], v[188:191]
  v_exp_f32 v180, v180
  v_mfma_f32_16x16x32_bf16 v[188:191], a[132:135], a[4:7], v[188:191]
  s_waitcnt lgkmcnt(0)
  v_cmp_gt_u32 vcc, v252, v251
  v_mfma_f32_16x16x32_bf16 v[188:191], a[128:131], a[0:3], v[188:191]
  buffer_load_dwordx4 v234, s[12:15], s44 offen offset:2048 nt lds
  v_mfma_f32_16x16x32_bf16 v[128:131], a[144:147], v[160:163], v[128:131]
  s_cbranch_vccnz L_SPIN15
  L_BACK15:
  v_mfma_f32_16x16x32_bf16 v[128:131], a[176:179], v[164:167], v[128:131]
  ds_read_b64_tr_b16 a[146:147], v224 offset:4096
  ds_read_b64_tr_b16 a[178:179], v224 offset:12288
  v_mfma_f32_16x16x32_bf16 v[132:135], a[180:183], v[164:167], v[132:135]
  ds_read_b64_tr_b16 a[144:145], v224 offset:0
  v_cvt_pk_bf16_f32 v176, v176, v177
  v_mfma_f32_16x16x32_bf16 v[132:135], a[148:151], v[160:163], v[132:135]
  v_exp_f32 v186, v186
  v_mfma_f32_16x16x32_bf16 v[136:139], a[152:155], v[160:163], v[136:139]
  ds_read_b64_tr_b16 a[148:149], v225 offset:0
  v_mfma_f32_16x16x32_bf16 v[136:139], a[184:187], v[164:167], v[136:139]
  ds_read_b64_tr_b16 a[176:177], v224 offset:8192
  v_mfma_f32_16x16x32_bf16 v[140:143], a[188:191], v[164:167], v[140:143]
  v_exp_f32 v187, v187
  v_mfma_f32_16x16x32_bf16 v[140:143], a[156:159], v[160:163], v[140:143]
  v_exp_f32 v191, v191
  v_mfma_f32_16x16x32_bf16 v[144:147], a[160:163], v[160:163], v[144:147]
  ds_read_b64_tr_b16 a[180:181], v225 offset:8192
  ds_read_b64_tr_b16 a[184:185], v226 offset:8192
  v_mfma_f32_16x16x32_bf16 v[144:147], a[192:195], v[164:167], v[144:147]
  ds_read_b64_tr_b16 a[150:151], v225 offset:4096
  ds_read_b64_tr_b16 a[152:153], v226 offset:0
  v_mfma_f32_16x16x32_bf16 v[148:151], a[196:199], v[164:167], v[148:151]
  ds_read_b64_tr_b16 a[182:183], v225 offset:12288
  ds_read_b64_tr_b16 a[188:189], v227 offset:8192
  v_mfma_f32_16x16x32_bf16 v[148:151], a[164:167], v[160:163], v[148:151]
  ds_read_b64_tr_b16 a[154:155], v226 offset:4096
  ds_read_b64_tr_b16 a[190:191], v227 offset:12288
  v_mfma_f32_16x16x32_bf16 v[152:155], a[168:171], v[160:163], v[152:155]
  v_exp_f32 v181, v181
  v_mfma_f32_16x16x32_bf16 v[152:155], a[200:203], v[164:167], v[152:155]
  ds_read_b64_tr_b16 a[186:187], v226 offset:12288
  v_mfma_f32_16x16x32_bf16 v[156:159], a[204:207], v[164:167], v[156:159]
  v_exp_f32 v188, v188
  v_mfma_f32_16x16x32_bf16 v[156:159], a[172:175], v[160:163], v[156:159]
  v_exp_f32 v178, v178
  v_smfmac_f32_16x16x64_bf16 a[224:227], a[228:231], v[160:167], v254
  ds_read_b64_tr_b16 a[156:157], v227 offset:0
  v_mfma_f32_16x16x32_bf16 v[160:163], a[80:83], a[16:19], v[196:199]
  v_exp_f32 v189, v189
  v_mfma_f32_16x16x32_bf16 v[160:163], a[84:87], a[20:23], v[160:163]
  ds_read_b64_tr_b16 a[160:161], v228 offset:0
  v_cvt_pk_bf16_f32 v177, v178, v179
  v_mfma_f32_16x16x32_bf16 v[160:163], a[88:91], a[24:27], v[160:163]
  v_exp_f32 v183, v183
  v_mfma_f32_16x16x32_bf16 v[160:163], a[92:95], a[28:31], v[160:163]
  ds_read_b64_tr_b16 a[158:159], v227 offset:4096
  ds_read_b64_tr_b16 a[196:197], v229 offset:8192
  v_mfma_f32_16x16x32_bf16 v[164:167], a[108:111], a[28:31], v[196:199]
  v_exp_f32 v190, v190
  v_mfma_f32_16x16x32_bf16 v[164:167], a[104:107], a[24:27], v[164:167]
  ds_read_b64_tr_b16 a[192:193], v228 offset:8192
  ds_read_b128 a[252:255], v239 offset:13312
  v_mfma_f32_16x16x32_bf16 v[164:167], a[100:103], a[20:23], v[164:167]
  ds_read_b64_tr_b16 a[194:195], v228 offset:12288
  ds_read_b64_tr_b16 a[198:199], v229 offset:12288
  v_mfma_f32_16x16x32_bf16 v[164:167], a[96:99], a[16:19], v[164:167]
  ds_read_b64_tr_b16 a[162:163], v228 offset:4096
  v_cvt_pk_bf16_f32 v178, v180, v181
  v_mfma_f32_16x16x32_bf16 v[168:171], a[112:115], a[16:19], v[196:199]
  v_exp_f32 v185, v185
  v_mfma_f32_16x16x32_bf16 v[168:171], a[116:119], a[20:23], v[168:171]
  v_exp_f32 v184, v184
  v_mfma_f32_16x16x32_bf16 v[168:171], a[120:123], a[24:27], v[168:171]
  ds_read_b64_tr_b16 a[164:165], v229 offset:0
  v_cvt_pk_bf16_f32 v179, v182, v183
  v_mfma_f32_16x16x32_bf16 v[168:171], a[124:127], a[28:31], v[168:171]
  ds_read_b64_tr_b16 a[166:167], v229 offset:4096
  v_cvt_pk_bf16_f32 v180, v184, v185
  v_mfma_f32_16x16x32_bf16 v[172:175], a[140:143], a[28:31], v[196:199]
  ds_read_b64_tr_b16 a[206:207], v231 offset:12288
  v_cvt_pk_bf16_f32 v181, v186, v187
  v_mfma_f32_16x16x32_bf16 v[172:175], a[136:139], a[24:27], v[172:175]
  ds_read_b64_tr_b16 a[168:169], v230 offset:0
  v_cvt_pk_bf16_f32 v182, v188, v189
  v_mfma_f32_16x16x32_bf16 v[172:175], a[132:135], a[20:23], v[172:175]
  ds_read_b64_tr_b16 a[170:171], v230 offset:4096
  v_cvt_pk_bf16_f32 v183, v190, v191
  v_mfma_f32_16x16x32_bf16 v[172:175], a[128:131], a[16:19], v[172:175]
  ds_read_b64_tr_b16 a[174:175], v231 offset:4096
  s_waitcnt lgkmcnt(6)
  v_mfma_f32_16x16x32_bf16 v[0:3], a[144:147], v[176:179], v[0:3]
  ds_read_b64_tr_b16 a[202:203], v230 offset:12288
  v_mfma_f32_16x16x32_bf16 v[0:3], a[176:179], v[180:183], v[0:3]
  ds_read_b64_tr_b16 a[200:201], v230 offset:8192
  v_mfma_f32_16x16x32_bf16 v[4:7], a[180:183], v[180:183], v[4:7]
  ds_read_b64_tr_b16 a[204:205], v231 offset:8192
  v_mfma_f32_16x16x32_bf16 v[4:7], a[148:151], v[176:179], v[4:7]
  ds_read_b64_tr_b16 a[172:173], v231 offset:0
  v_mfma_f32_16x16x32_bf16 v[8:11], a[152:155], v[176:179], v[8:11]
  v_add_u32 v252, 1, v252
  v_mfma_f32_16x16x32_bf16 v[8:11], a[184:187], v[180:183], v[8:11]
  v_mfma_f32_16x16x32_bf16 v[12:15], a[188:191], v[180:183], v[12:15]
  buffer_store_dwordx4 a[252:255], v238, s[24:27], s44 offen offset:2048
  v_mfma_f32_16x16x32_bf16 v[12:15], a[156:159], v[176:179], v[12:15]
  v_exp_f32 v172, v172
  v_mfma_f32_16x16x32_bf16 v[16:19], a[160:163], v[176:179], v[16:19]
  v_exp_f32 v166, v166
  v_mfma_f32_16x16x32_bf16 v[16:19], a[192:195], v[180:183], v[16:19]
  v_exp_f32 v173, v173
  v_mfma_f32_16x16x32_bf16 v[20:23], a[196:199], v[180:183], v[20:23]
  v_exp_f32 v161, v161
  s_waitcnt lgkmcnt(0)
  v_mfma_f32_16x16x32_bf16 v[20:23], a[164:167], v[176:179], v[20:23]
  s_add_u32 m0, s30, 65792
  v_mfma_f32_16x16x32_bf16 v[24:27], a[168:171], v[176:179], v[24:27]
  buffer_load_dwordx4 v236, s[20:23], s62 offen offset:0  lds
  v_mfma_f32_16x16x32_bf16 v[24:27], a[200:203], v[180:183], v[24:27]
  v_exp_f32 v168, v168
  v_mfma_f32_16x16x32_bf16 v[28:31], a[204:207], v[180:183], v[28:31]
  v_exp_f32 v167, v167
  v_mfma_f32_16x16x32_bf16 v[28:31], a[172:175], v[176:179], v[28:31]
  v_exp_f32 v169, v169
  v_smfmac_f32_16x16x64_bf16 a[208:211], a[228:231], v[176:183], v254
  v_mfma_f32_16x16x32_bf16 v[176:179], a[80:83], a[32:35], v[200:203]
  v_exp_f32 v165, v165
  v_mfma_f32_16x16x32_bf16 v[176:179], a[84:87], a[36:39], v[176:179]
  v_exp_f32 v175, v175
  v_mfma_f32_16x16x32_bf16 v[176:179], a[88:91], a[40:43], v[176:179]
  v_exp_f32 v160, v160
  v_mfma_f32_16x16x32_bf16 v[176:179], a[92:95], a[44:47], v[176:179]
  buffer_load_dwordx4 v237, s[20:23], s62 offen offset:1024  lds
  v_mfma_f32_16x16x32_bf16 v[180:183], a[108:111], a[44:47], v[200:203]
  v_exp_f32 v163, v163
  v_mfma_f32_16x16x32_bf16 v[180:183], a[104:107], a[40:43], v[180:183]
  v_exp_f32 v174, v174
  v_mfma_f32_16x16x32_bf16 v[180:183], a[100:103], a[36:39], v[180:183]
  v_exp_f32 v170, v170
  v_mfma_f32_16x16x32_bf16 v[180:183], a[96:99], a[32:35], v[180:183]
  v_cvt_pk_bf16_f32 v160, v160, v161
  v_mfma_f32_16x16x32_bf16 v[184:187], a[112:115], a[32:35], v[200:203]
  v_exp_f32 v171, v171
  v_mfma_f32_16x16x32_bf16 v[184:187], a[116:119], a[36:39], v[184:187]
  v_exp_f32 v162, v162
  v_mfma_f32_16x16x32_bf16 v[184:187], a[120:123], a[40:43], v[184:187]
  v_exp_f32 v164, v164
  v_mfma_f32_16x16x32_bf16 v[184:187], a[124:127], a[44:47], v[184:187]
  v_cvt_pk_bf16_f32 v161, v162, v163
  v_cvt_pk_bf16_f32 v162, v164, v165
  v_mfma_f32_16x16x32_bf16 v[188:191], a[140:143], a[44:47], v[200:203]
  v_cvt_pk_bf16_f32 v163, v166, v167
  v_cvt_pk_bf16_f32 v164, v168, v169
  v_mfma_f32_16x16x32_bf16 v[188:191], a[136:139], a[40:43], v[188:191]
  buffer_load_dwordx4 v236, s[20:23], s62 offen offset:2048  lds
  v_mfma_f32_16x16x32_bf16 v[188:191], a[132:135], a[36:39], v[188:191]
  v_cvt_pk_bf16_f32 v165, v170, v171
  v_cvt_pk_bf16_f32 v166, v172, v173
  v_mfma_f32_16x16x32_bf16 v[188:191], a[128:131], a[32:35], v[188:191]
  v_cvt_pk_bf16_f32 v167, v174, v175
  v_mfma_f32_16x16x32_bf16 v[32:35], a[144:147], v[160:163], v[32:35]
  v_exp_f32 v184, v184
  v_mfma_f32_16x16x32_bf16 v[32:35], a[176:179], v[164:167], v[32:35]
  v_mfma_f32_16x16x32_bf16 v[36:39], a[180:183], v[164:167], v[36:39]
  v_exp_f32 v177, v177
  v_mfma_f32_16x16x32_bf16 v[36:39], a[148:151], v[160:163], v[36:39]
  v_exp_f32 v183, v183
  v_mfma_f32_16x16x32_bf16 v[40:43], a[152:155], v[160:163], v[40:43]
  v_exp_f32 v180, v180
  v_mfma_f32_16x16x32_bf16 v[40:43], a[184:187], v[164:167], v[40:43]
  v_exp_f32 v190, v190
  v_mfma_f32_16x16x32_bf16 v[44:47], a[188:191], v[164:167], v[44:47]
  v_exp_f32 v176, v176
  v_mfma_f32_16x16x32_bf16 v[44:47], a[156:159], v[160:163], v[44:47]
  buffer_load_dwordx4 v237, s[20:23], s62 offen offset:3072  lds
  v_mfma_f32_16x16x32_bf16 v[48:51], a[160:163], v[160:163], v[48:51]
  v_cvt_pk_bf16_f32 v176, v176, v177
  v_mfma_f32_16x16x32_bf16 v[48:51], a[192:195], v[164:167], v[48:51]
  v_exp_f32 v181, v181
  v_mfma_f32_16x16x32_bf16 v[52:55], a[196:199], v[164:167], v[52:55]
  v_exp_f32 v185, v185
  v_mfma_f32_16x16x32_bf16 v[52:55], a[164:167], v[160:163], v[52:55]
  v_exp_f32 v179, v179
  v_mfma_f32_16x16x32_bf16 v[56:59], a[168:171], v[160:163], v[56:59]
  v_exp_f32 v187, v187
  v_mfma_f32_16x16x32_bf16 v[56:59], a[200:203], v[164:167], v[56:59]
  v_exp_f32 v178, v178
  v_mfma_f32_16x16x32_bf16 v[60:63], a[204:207], v[164:167], v[60:63]
  v_exp_f32 v186, v186
  v_mfma_f32_16x16x32_bf16 v[60:63], a[172:175], v[160:163], v[60:63]
  v_exp_f32 v191, v191
  v_smfmac_f32_16x16x64_bf16 a[212:215], a[228:231], v[160:167], v254
  v_mfma_f32_16x16x32_bf16 v[160:163], a[80:83], a[48:51], v[204:207]
  v_cvt_pk_bf16_f32 v177, v178, v179
  v_cvt_pk_bf16_f32 v178, v180, v181
  v_mfma_f32_16x16x32_bf16 v[160:163], a[84:87], a[52:55], v[160:163]
  v_exp_f32 v182, v182
  v_mfma_f32_16x16x32_bf16 v[160:163], a[88:91], a[56:59], v[160:163]
  v_exp_f32 v188, v188
  v_mfma_f32_16x16x32_bf16 v[160:163], a[92:95], a[60:63], v[160:163]
  v_exp_f32 v189, v189
  v_mfma_f32_16x16x32_bf16 v[164:167], a[108:111], a[60:63], v[204:207]
  v_cvt_pk_bf16_f32 v179, v182, v183
  v_mfma_f32_16x16x32_bf16 v[164:167], a[104:107], a[56:59], v[164:167]
  v_cvt_pk_bf16_f32 v180, v184, v185
  v_mfma_f32_16x16x32_bf16 v[164:167], a[100:103], a[52:55], v[164:167]
  ds_read_b128 a[252:255], v255 offset:13824
  v_mfma_f32_16x16x32_bf16 v[164:167], a[96:99], a[48:51], v[164:167]
  v_cvt_pk_bf16_f32 v181, v186, v187
  v_cvt_pk_bf16_f32 v182, v188, v189
  v_mfma_f32_16x16x32_bf16 v[168:171], a[112:115], a[48:51], v[204:207]
  v_exp_f32 v163, v163
  v_mfma_f32_16x16x32_bf16 v[168:171], a[116:119], a[52:55], v[168:171]
  s_waitcnt vmcnt(18)
  ds_write_b32 v253, v252
  v_mfma_f32_16x16x32_bf16 v[168:171], a[120:123], a[56:59], v[168:171]
  s_add_u32 m0, s31, 12288
  v_cvt_pk_bf16_f32 v183, v190, v191
  v_mfma_f32_16x16x32_bf16 v[168:171], a[124:127], a[60:63], v[168:171]
  v_exp_f32 v162, v162
  v_mfma_f32_16x16x32_bf16 v[172:175], a[140:143], a[60:63], v[204:207]
  v_exp_f32 v165, v165
  v_mfma_f32_16x16x32_bf16 v[172:175], a[136:139], a[56:59], v[172:175]
  v_exp_f32 v164, v164
  v_mfma_f32_16x16x32_bf16 v[172:175], a[132:135], a[52:55], v[172:175]
  v_exp_f32 v167, v167
  v_mfma_f32_16x16x32_bf16 v[172:175], a[128:131], a[48:51], v[172:175]
  v_exp_f32 v166, v166
  v_mfma_f32_16x16x32_bf16 v[64:67], a[144:147], v[176:179], v[64:67]
  v_exp_f32 v169, v169
  v_mfma_f32_16x16x32_bf16 v[64:67], a[176:179], v[180:183], v[64:67]
  v_exp_f32 v160, v160
  v_mfma_f32_16x16x32_bf16 v[68:71], a[180:183], v[180:183], v[68:71]
  v_exp_f32 v168, v168
  v_mfma_f32_16x16x32_bf16 v[68:71], a[148:151], v[176:179], v[68:71]
  v_exp_f32 v171, v171
  v_mfma_f32_16x16x32_bf16 v[72:75], a[152:155], v[176:179], v[72:75]
  v_exp_f32 v161, v161
  v_mfma_f32_16x16x32_bf16 v[72:75], a[184:187], v[180:183], v[72:75]
  s_waitcnt lgkmcnt(0)
  buffer_store_dwordx4 a[252:255], v238, s[24:27], s44 offen offset:3072
  v_mfma_f32_16x16x32_bf16 v[76:79], a[188:191], v[180:183], v[76:79]
  v_exp_f32 v174, v174
  v_mfma_f32_16x16x32_bf16 v[76:79], a[156:159], v[176:179], v[76:79]
  v_cvt_pk_bf16_f32 v160, v160, v161
  v_cvt_pk_bf16_f32 v161, v162, v163
  v_mfma_f32_16x16x32_bf16 v[80:83], a[160:163], v[176:179], v[80:83]
  v_cvt_pk_bf16_f32 v162, v164, v165
  v_mfma_f32_16x16x32_bf16 v[80:83], a[192:195], v[180:183], v[80:83]
  ds_read_b32 v251, v250
  v_cvt_pk_bf16_f32 v163, v166, v167
  v_mfma_f32_16x16x32_bf16 v[84:87], a[196:199], v[180:183], v[84:87]
  v_exp_f32 v170, v170
  v_mfma_f32_16x16x32_bf16 v[84:87], a[164:167], v[176:179], v[84:87]
  v_exp_f32 v172, v172
  v_mfma_f32_16x16x32_bf16 v[88:91], a[168:171], v[176:179], v[88:91]
  v_exp_f32 v175, v175
  v_mfma_f32_16x16x32_bf16 v[88:91], a[200:203], v[180:183], v[88:91]
  buffer_load_dwordx4 v233, s[12:15], s44 offen offset:1024 nt lds
  v_mfma_f32_16x16x32_bf16 v[92:95], a[204:207], v[180:183], v[92:95]
  s_waitcnt lgkmcnt(0)
  v_cmp_gt_u32 vcc, v252, v251
  v_mfma_f32_16x16x32_bf16 v[92:95], a[172:175], v[176:179], v[92:95]
  v_exp_f32 v173, v173
  v_smfmac_f32_16x16x64_bf16 a[216:219], a[228:231], v[176:183], v254
  v_cvt_pk_bf16_f32 v164, v168, v169
  v_mfma_f32_16x16x32_bf16 v[176:179], a[80:83], a[64:67], v[208:211]
  s_cbranch_vccnz L_SPIN16
  L_BACK16:
  v_mfma_f32_16x16x32_bf16 v[176:179], a[84:87], a[68:71], v[176:179]
  ds_read_b128 a[80:83], v220 offset:0
  v_cvt_pk_bf16_f32 v165, v170, v171
  v_mfma_f32_16x16x32_bf16 v[176:179], a[88:91], a[72:75], v[176:179]
  s_add_u32 s16, s6, s39
  s_addc_u32 s17, s7, 0
  v_mfma_f32_16x16x32_bf16 v[176:179], a[92:95], a[76:79], v[176:179]
  ds_read_b128 a[88:91], v222 offset:0
  s_and_b32 s18, s50, s40
  v_mfma_f32_16x16x32_bf16 v[180:183], a[108:111], a[76:79], v[208:211]
  ds_read_b128 a[84:87], v221 offset:0
  s_add_u32 m0, s30, 256
  v_mfma_f32_16x16x32_bf16 v[180:183], a[104:107], a[72:75], v[180:183]
  buffer_load_dwordx4 v232, s[16:19], 0 offen offset:0 nt lds
  v_mfma_f32_16x16x32_bf16 v[180:183], a[100:103], a[68:71], v[180:183]
  ds_read_b128 a[108:111], v223 offset:4096
  ds_read_b128 a[100:103], v221 offset:4096
  v_mfma_f32_16x16x32_bf16 v[180:183], a[96:99], a[64:67], v[180:183]
  ds_read_b128 a[92:95], v223 offset:0
  v_mfma_f32_16x16x32_bf16 v[184:187], a[112:115], a[64:67], v[208:211]
  ds_read_b128 a[96:99], v220 offset:4096
  v_cvt_pk_bf16_f32 v166, v172, v173
  v_mfma_f32_16x16x32_bf16 v[184:187], a[116:119], a[68:71], v[184:187]
  ds_read_b128 a[104:107], v222 offset:4096
  v_cvt_pk_bf16_f32 v167, v174, v175
  v_mfma_f32_16x16x32_bf16 v[184:187], a[120:123], a[72:75], v[184:187]
  ds_read_b128 a[112:115], v220 offset:8192
  v_add_u32 v252, 1, v252
  v_mfma_f32_16x16x32_bf16 v[184:187], a[124:127], a[76:79], v[184:187]
  buffer_load_dwordx4 v233, s[16:19], 0 offen offset:1024 nt lds
  v_mfma_f32_16x16x32_bf16 v[188:191], a[140:143], a[76:79], v[208:211]
  ds_read_b128 a[116:119], v221 offset:8192
  ds_read_b128 a[124:127], v223 offset:8192
  v_mfma_f32_16x16x32_bf16 v[188:191], a[136:139], a[72:75], v[188:191]
  ds_read_b128 a[120:123], v222 offset:8192
  ds_read_b128 a[140:143], v223 offset:12288
  v_mfma_f32_16x16x32_bf16 v[188:191], a[132:135], a[68:71], v[188:191]
  ds_read_b128 a[136:139], v222 offset:12288
  ds_read_b128 a[132:135], v221 offset:12288
  v_mfma_f32_16x16x32_bf16 v[188:191], a[128:131], a[64:67], v[188:191]
  ds_read_b128 a[128:131], v220 offset:12288
  v_mfma_f32_16x16x32_bf16 v[96:99], a[144:147], v[160:163], v[96:99]
  v_exp_f32 v182, v182
  v_mfma_f32_16x16x32_bf16 v[96:99], a[176:179], v[164:167], v[96:99]
  v_exp_f32 v186, v186
  v_mfma_f32_16x16x32_bf16 v[100:103], a[180:183], v[164:167], v[100:103]
  v_exp_f32 v181, v181
  v_mfma_f32_16x16x32_bf16 v[100:103], a[148:151], v[160:163], v[100:103]
  buffer_load_dwordx4 v234, s[16:19], 0 offen offset:2048 nt lds
  v_mfma_f32_16x16x32_bf16 v[104:107], a[152:155], v[160:163], v[104:107]
  v_exp_f32 v189, v189
  v_mfma_f32_16x16x32_bf16 v[104:107], a[184:187], v[164:167], v[104:107]
  v_exp_f32 v187, v187
  v_mfma_f32_16x16x32_bf16 v[108:111], a[188:191], v[164:167], v[108:111]
  v_exp_f32 v180, v180
  v_mfma_f32_16x16x32_bf16 v[108:111], a[156:159], v[160:163], v[108:111]
  v_exp_f32 v176, v176
  v_mfma_f32_16x16x32_bf16 v[112:115], a[160:163], v[160:163], v[112:115]
  v_exp_f32 v190, v190
  v_mfma_f32_16x16x32_bf16 v[112:115], a[192:195], v[164:167], v[112:115]
  v_exp_f32 v179, v179
  v_mfma_f32_16x16x32_bf16 v[116:119], a[196:199], v[164:167], v[116:119]
  v_exp_f32 v183, v183
  v_mfma_f32_16x16x32_bf16 v[116:119], a[164:167], v[160:163], v[116:119]
  s_waitcnt vmcnt(17) lgkmcnt(0)
  ds_write_b32 v253, v252
  v_mfma_f32_16x16x32_bf16 v[120:123], a[168:171], v[160:163], v[120:123]
  v_exp_f32 v177, v177
  v_mfma_f32_16x16x32_bf16 v[120:123], a[200:203], v[164:167], v[120:123]
  v_cvt_pk_bf16_f32 v176, v176, v177
  v_mfma_f32_16x16x32_bf16 v[124:127], a[204:207], v[164:167], v[124:127]
  v_exp_f32 v184, v184
  v_mfma_f32_16x16x32_bf16 v[124:127], a[172:175], v[160:163], v[124:127]
  v_exp_f32 v178, v178
  v_smfmac_f32_16x16x64_bf16 a[220:223], a[228:231], v[160:167], v254
  v_mfma_f32_16x16x32_bf16 v[160:163], a[80:83], a[0:3], v[192:195]
  v_exp_f32 v185, v185
  v_mfma_f32_16x16x32_bf16 v[160:163], a[84:87], a[4:7], v[160:163]
  v_exp_f32 v191, v191
  v_mfma_f32_16x16x32_bf16 v[160:163], a[88:91], a[8:11], v[160:163]
  buffer_load_dwordx4 v235, s[16:19], 0 offen offset:3072 nt lds
  v_mfma_f32_16x16x32_bf16 v[160:163], a[92:95], a[12:15], v[160:163]
  s_add_u32 m0, s31, 12288
  v_cvt_pk_bf16_f32 v177, v178, v179
  v_mfma_f32_16x16x32_bf16 v[164:167], a[108:111], a[12:15], v[192:195]
  v_cvt_pk_bf16_f32 v178, v180, v181
  v_mfma_f32_16x16x32_bf16 v[164:167], a[104:107], a[8:11], v[164:167]
  v_exp_f32 v188, v188
  v_mfma_f32_16x16x32_bf16 v[164:167], a[100:103], a[4:7], v[164:167]
  v_cvt_pk_bf16_f32 v179, v182, v183
  v_cvt_pk_bf16_f32 v180, v184, v185
  v_mfma_f32_16x16x32_bf16 v[164:167], a[96:99], a[0:3], v[164:167]
  ds_read_b32 v251, v250
  v_cvt_pk_bf16_f32 v181, v186, v187
  v_mfma_f32_16x16x32_bf16 v[168:171], a[112:115], a[0:3], v[192:195]
  v_exp_f32 v163, v163
  v_mfma_f32_16x16x32_bf16 v[168:171], a[116:119], a[4:7], v[168:171]
  v_cvt_pk_bf16_f32 v182, v188, v189
  v_cvt_pk_bf16_f32 v183, v190, v191
  v_mfma_f32_16x16x32_bf16 v[168:171], a[120:123], a[8:11], v[168:171]
  buffer_load_dwordx4 v235, s[12:15], s44 offen offset:3072 nt lds
  v_mfma_f32_16x16x32_bf16 v[168:171], a[124:127], a[12:15], v[168:171]
  v_exp_f32 v160, v160
  v_mfma_f32_16x16x32_bf16 v[172:175], a[140:143], a[12:15], v[192:195]
  v_exp_f32 v162, v162
  v_mfma_f32_16x16x32_bf16 v[172:175], a[136:139], a[8:11], v[172:175]
  s_waitcnt lgkmcnt(0)
  v_cmp_gt_u32 vcc, v252, v251
  v_mfma_f32_16x16x32_bf16 v[172:175], a[132:135], a[4:7], v[172:175]
  v_exp_f32 v166, v166
  v_mfma_f32_16x16x32_bf16 v[172:175], a[128:131], a[0:3], v[172:175]
  v_exp_f32 v164, v164
  v_mfma_f32_16x16x32_bf16 v[128:131], a[144:147], v[176:179], v[128:131]
  s_cbranch_vccnz L_SPIN17
  L_BACK17:
  v_mfma_f32_16x16x32_bf16 v[128:131], a[176:179], v[180:183], v[128:131]
  v_exp_f32 v171, v171
  v_mfma_f32_16x16x32_bf16 v[132:135], a[180:183], v[180:183], v[132:135]
  ds_read_b64_tr_b16 a[144:145], v224 offset:32768
  ds_read_b64_tr_b16 a[176:177], v224 offset:40960
  v_mfma_f32_16x16x32_bf16 v[132:135], a[148:151], v[176:179], v[132:135]
  ds_read_b64_tr_b16 a[178:179], v224 offset:45056
  ds_read_b64_tr_b16 a[180:181], v225 offset:40960
  v_mfma_f32_16x16x32_bf16 v[136:139], a[152:155], v[176:179], v[136:139]
  ds_read_b64_tr_b16 a[146:147], v224 offset:36864
  ds_read_b64_tr_b16 a[148:149], v225 offset:32768
  v_mfma_f32_16x16x32_bf16 v[136:139], a[184:187], v[180:183], v[136:139]
  v_exp_f32 v170, v170
  v_mfma_f32_16x16x32_bf16 v[140:143], a[188:191], v[180:183], v[140:143]
  ds_read_b64_tr_b16 a[182:183], v225 offset:45056
  ds_read_b64_tr_b16 a[150:151], v225 offset:36864
  v_mfma_f32_16x16x32_bf16 v[140:143], a[156:159], v[176:179], v[140:143]
  v_exp_f32 v161, v161
  v_mfma_f32_16x16x32_bf16 v[144:147], a[160:163], v[176:179], v[144:147]
  v_exp_f32 v173, v173
  v_mfma_f32_16x16x32_bf16 v[144:147], a[192:195], v[180:183], v[144:147]
  v_exp_f32 v167, v167
  v_mfma_f32_16x16x32_bf16 v[148:151], a[196:199], v[180:183], v[148:151]
  ds_read_b64_tr_b16 a[152:153], v226 offset:32768
  ds_read_b64_tr_b16 a[184:185], v226 offset:40960
  v_mfma_f32_16x16x32_bf16 v[148:151], a[164:167], v[176:179], v[148:151]
  ds_read_b64_tr_b16 a[154:155], v226 offset:36864
  v_cvt_pk_bf16_f32 v160, v160, v161
  v_mfma_f32_16x16x32_bf16 v[152:155], a[168:171], v[176:179], v[152:155]
  v_exp_f32 v172, v172
  v_mfma_f32_16x16x32_bf16 v[152:155], a[200:203], v[180:183], v[152:155]
  v_exp_f32 v169, v169
  v_mfma_f32_16x16x32_bf16 v[156:159], a[204:207], v[180:183], v[156:159]
  v_exp_f32 v165, v165
  v_mfma_f32_16x16x32_bf16 v[156:159], a[172:175], v[176:179], v[156:159]
  ds_read_b64_tr_b16 a[190:191], v227 offset:45056
  v_cvt_pk_bf16_f32 v161, v162, v163
  v_smfmac_f32_16x16x64_bf16 a[224:227], a[228:231], v[176:183], v254
  ds_read_b64_tr_b16 a[186:187], v226 offset:45056
  v_mfma_f32_16x16x32_bf16 v[176:179], a[80:83], a[16:19], v[196:199]
  ds_read_b64_tr_b16 a[158:159], v227 offset:36864
  ds_read_b64_tr_b16 a[160:161], v228 offset:32768
  v_mfma_f32_16x16x32_bf16 v[176:179], a[84:87], a[20:23], v[176:179]
  ds_read_b64_tr_b16 a[188:189], v227 offset:40960
  v_cvt_pk_bf16_f32 v162, v164, v165
  v_mfma_f32_16x16x32_bf16 v[176:179], a[88:91], a[24:27], v[176:179]
  ds_read_b64_tr_b16 a[156:157], v227 offset:32768
  ds_read_b64_tr_b16 a[162:163], v228 offset:36864
  v_mfma_f32_16x16x32_bf16 v[176:179], a[92:95], a[28:31], v[176:179]
  v_exp_f32 v174, v174
  v_mfma_f32_16x16x32_bf16 v[180:183], a[108:111], a[28:31], v[196:199]
  ds_read_b64_tr_b16 a[196:197], v229 offset:40960
  v_mfma_f32_16x16x32_bf16 v[180:183], a[104:107], a[24:27], v[180:183]
  ds_read_b64_tr_b16 a[192:193], v228 offset:40960
  ds_read_b128 a[252:255], v239 offset:16384
  v_mfma_f32_16x16x32_bf16 v[180:183], a[100:103], a[20:23], v[180:183]
  v_exp_f32 v168, v168
  v_mfma_f32_16x16x32_bf16 v[180:183], a[96:99], a[16:19], v[180:183]
  v_exp_f32 v175, v175
  v_mfma_f32_16x16x32_bf16 v[184:187], a[112:115], a[16:19], v[196:199]
  ds_read_b64_tr_b16 a[166:167], v229 offset:36864
  v_mfma_f32_16x16x32_bf16 v[184:187], a[116:119], a[20:23], v[184:187]
  ds_read_b64_tr_b16 a[194:195], v228 offset:45056
  ds_read_b64_tr_b16 a[198:199], v229 offset:45056
  v_mfma_f32_16x16x32_bf16 v[184:187], a[120:123], a[24:27], v[184:187]
  ds_read_b64_tr_b16 a[200:201], v230 offset:40960
  v_cvt_pk_bf16_f32 v163, v166, v167
  v_mfma_f32_16x16x32_bf16 v[184:187], a[124:127], a[28:31], v[184:187]
  ds_read_b64_tr_b16 a[164:165], v229 offset:32768
  v_cvt_pk_bf16_f32 v164, v168, v169
  v_mfma_f32_16x16x32_bf16 v[188:191], a[140:143], a[28:31], v[196:199]
  ds_read_b64_tr_b16 a[206:207], v231 offset:45056
  v_cvt_pk_bf16_f32 v165, v170, v171
  v_mfma_f32_16x16x32_bf16 v[188:191], a[136:139], a[24:27], v[188:191]
  ds_read_b64_tr_b16 a[204:205], v231 offset:40960
  v_cvt_pk_bf16_f32 v166, v172, v173
  v_mfma_f32_16x16x32_bf16 v[188:191], a[132:135], a[20:23], v[188:191]
  ds_read_b64_tr_b16 a[168:169], v230 offset:32768
  v_cvt_pk_bf16_f32 v167, v174, v175
  v_mfma_f32_16x16x32_bf16 v[188:191], a[128:131], a[16:19], v[188:191]
  ds_read_b64_tr_b16 a[202:203], v230 offset:45056
  s_waitcnt lgkmcnt(6)
  v_mfma_f32_16x16x32_bf16 v[0:3], a[144:147], v[160:163], v[0:3]
  ds_read_b64_tr_b16 a[170:171], v230 offset:36864
  ds_read_b64_tr_b16 a[174:175], v231 offset:36864
  v_mfma_f32_16x16x32_bf16 v[0:3], a[176:179], v[164:167], v[0:3]
  v_exp_f32 v183, v183
  v_mfma_f32_16x16x32_bf16 v[4:7], a[180:183], v[164:167], v[4:7]
  ds_read_b64_tr_b16 a[172:173], v231 offset:32768
  v_mfma_f32_16x16x32_bf16 v[4:7], a[148:151], v[160:163], v[4:7]
  v_exp_f32 v185, v185
  v_mfma_f32_16x16x32_bf16 v[8:11], a[152:155], v[160:163], v[8:11]
  v_exp_f32 v176, v176
  v_mfma_f32_16x16x32_bf16 v[8:11], a[184:187], v[164:167], v[8:11]
  buffer_store_dwordx4 a[252:255], v238, s[24:27], s45 offen offset:0
  v_mfma_f32_16x16x32_bf16 v[12:15], a[188:191], v[164:167], v[12:15]
  v_exp_f32 v179, v179
  v_mfma_f32_16x16x32_bf16 v[12:15], a[156:159], v[160:163], v[12:15]
  v_exp_f32 v186, v186
  v_mfma_f32_16x16x32_bf16 v[16:19], a[160:163], v[160:163], v[16:19]
  s_add_u32 s20, s8, s39
  s_addc_u32 s21, s9, 0
  v_mfma_f32_16x16x32_bf16 v[16:19], a[192:195], v[164:167], v[16:19]
  s_mov_b32 s22, s18
  s_add_u32 m0, s30, 16640
  v_mfma_f32_16x16x32_bf16 v[20:23], a[196:199], v[164:167], v[20:23]
  v_exp_f32 v177, v177
  s_waitcnt lgkmcnt(0)
  v_mfma_f32_16x16x32_bf16 v[20:23], a[164:167], v[160:163], v[20:23]
  v_cvt_pk_bf16_f32 v176, v176, v177
  v_mfma_f32_16x16x32_bf16 v[24:27], a[168:171], v[160:163], v[24:27]
  buffer_load_dwordx4 v236, s[20:23], 0 offen offset:0  lds
  v_mfma_f32_16x16x32_bf16 v[24:27], a[200:203], v[164:167], v[24:27]
  v_exp_f32 v178, v178
  v_mfma_f32_16x16x32_bf16 v[28:31], a[204:207], v[164:167], v[28:31]
  v_exp_f32 v182, v182
  v_mfma_f32_16x16x32_bf16 v[28:31], a[172:175], v[160:163], v[28:31]
  v_exp_f32 v180, v180
  v_smfmac_f32_16x16x64_bf16 a[208:211], a[228:231], v[160:167], v254
  v_cvt_pk_bf16_f32 v177, v178, v179
  v_mfma_f32_16x16x32_bf16 v[160:163], a[80:83], a[32:35], v[200:203]
  v_exp_f32 v187, v187
  v_mfma_f32_16x16x32_bf16 v[160:163], a[84:87], a[36:39], v[160:163]
  v_exp_f32 v189, v189
  v_mfma_f32_16x16x32_bf16 v[160:163], a[88:91], a[40:43], v[160:163]
  v_exp_f32 v181, v181
  v_mfma_f32_16x16x32_bf16 v[160:163], a[92:95], a[44:47], v[160:163]
  v_exp_f32 v190, v190
  v_mfma_f32_16x16x32_bf16 v[164:167], a[108:111], a[44:47], v[200:203]
  buffer_load_dwordx4 v237, s[20:23], 0 offen offset:1024  lds
  v_mfma_f32_16x16x32_bf16 v[164:167], a[104:107], a[40:43], v[164:167]
  v_cvt_pk_bf16_f32 v178, v180, v181
  v_mfma_f32_16x16x32_bf16 v[164:167], a[100:103], a[36:39], v[164:167]
  v_cvt_pk_bf16_f32 v179, v182, v183
  v_mfma_f32_16x16x32_bf16 v[164:167], a[96:99], a[32:35], v[164:167]
  v_exp_f32 v191, v191
  v_mfma_f32_16x16x32_bf16 v[168:171], a[112:115], a[32:35], v[200:203]
  v_exp_f32 v184, v184
  v_mfma_f32_16x16x32_bf16 v[168:171], a[116:119], a[36:39], v[168:171]
  v_add_u32 v252, 1, v252
  v_mfma_f32_16x16x32_bf16 v[168:171], a[120:123], a[40:43], v[168:171]
  v_exp_f32 v188, v188
  v_mfma_f32_16x16x32_bf16 v[168:171], a[124:127], a[44:47], v[168:171]
  v_cvt_pk_bf16_f32 v180, v184, v185
  v_cvt_pk_bf16_f32 v181, v186, v187
  v_mfma_f32_16x16x32_bf16 v[172:175], a[140:143], a[44:47], v[200:203]
  v_exp_f32 v164, v164
  v_mfma_f32_16x16x32_bf16 v[172:175], a[136:139], a[40:43], v[172:175]
  v_cvt_pk_bf16_f32 v182, v188, v189
  v_cvt_pk_bf16_f32 v183, v190, v191
  v_mfma_f32_16x16x32_bf16 v[172:175], a[132:135], a[36:39], v[172:175]
  v_exp_f32 v162, v162
  v_mfma_f32_16x16x32_bf16 v[172:175], a[128:131], a[32:35], v[172:175]
  buffer_load_dwordx4 v236, s[20:23], 0 offen offset:2048  lds
  v_mfma_f32_16x16x32_bf16 v[32:35], a[144:147], v[176:179], v[32:35]
  v_exp_f32 v170, v170
  v_mfma_f32_16x16x32_bf16 v[32:35], a[176:179], v[180:183], v[32:35]
  ds_read_b128 a[236:239], v255 offset:16896
  v_add_u32 v230, 0x4000, v230
  v_mfma_f32_16x16x32_bf16 v[36:39], a[180:183], v[180:183], v[36:39]
  v_exp_f32 v165, v165
  v_mfma_f32_16x16x32_bf16 v[36:39], a[148:151], v[176:179], v[36:39]
  v_exp_f32 v160, v160
  v_mfma_f32_16x16x32_bf16 v[40:43], a[152:155], v[176:179], v[40:43]
  v_exp_f32 v163, v163
  v_mfma_f32_16x16x32_bf16 v[40:43], a[184:187], v[180:183], v[40:43]
  v_exp_f32 v172, v172
  v_mfma_f32_16x16x32_bf16 v[44:47], a[188:191], v[180:183], v[44:47]
  v_exp_f32 v161, v161
  v_mfma_f32_16x16x32_bf16 v[44:47], a[156:159], v[176:179], v[44:47]
  buffer_load_dwordx4 v237, s[20:23], 0 offen offset:3072  lds
  v_mfma_f32_16x16x32_bf16 v[48:51], a[160:163], v[176:179], v[48:51]
  v_cvt_pk_bf16_f32 v160, v160, v161
  v_cvt_pk_bf16_f32 v161, v162, v163
  v_mfma_f32_16x16x32_bf16 v[48:51], a[192:195], v[180:183], v[48:51]
  ds_read_b128 a[244:247], v255 offset:17920
  v_add_u32 v225, 0x4000, v225
  v_mfma_f32_16x16x32_bf16 v[52:55], a[196:199], v[180:183], v[52:55]
  v_exp_f32 v173, v173
  v_mfma_f32_16x16x32_bf16 v[52:55], a[164:167], v[176:179], v[52:55]
  v_exp_f32 v169, v169
  v_mfma_f32_16x16x32_bf16 v[56:59], a[168:171], v[176:179], v[56:59]
  v_exp_f32 v168, v168
  v_mfma_f32_16x16x32_bf16 v[56:59], a[200:203], v[180:183], v[56:59]
  v_exp_f32 v175, v175
  v_mfma_f32_16x16x32_bf16 v[60:63], a[204:207], v[180:183], v[60:63]
  v_exp_f32 v167, v167
  v_mfma_f32_16x16x32_bf16 v[60:63], a[172:175], v[176:179], v[60:63]
  v_exp_f32 v171, v171
  v_smfmac_f32_16x16x64_bf16 a[212:215], a[228:231], v[176:183], v254
  s_add_u32 m0, s31, 16384
  v_mfma_f32_16x16x32_bf16 v[176:179], a[80:83], a[48:51], v[204:207]
  ds_read_b128 a[240:243], v239 offset:17408
  v_cvt_pk_bf16_f32 v162, v164, v165
  v_mfma_f32_16x16x32_bf16 v[176:179], a[84:87], a[52:55], v[176:179]
  s_waitcnt lgkmcnt(1)
  buffer_load_dwordx4 v232, s[12:15], s45 offen offset:0 nt lds
  v_mfma_f32_16x16x32_bf16 v[176:179], a[88:91], a[56:59], v[176:179]
  v_exp_f32 v166, v166
  v_mfma_f32_16x16x32_bf16 v[176:179], a[92:95], a[60:63], v[176:179]
  v_add_u32 v229, 0x4000, v229
  v_cvt_pk_bf16_f32 v163, v166, v167
  v_mfma_f32_16x16x32_bf16 v[180:183], a[108:111], a[60:63], v[204:207]
  v_exp_f32 v174, v174
  v_mfma_f32_16x16x32_bf16 v[180:183], a[104:107], a[56:59], v[180:183]
  v_mfma_f32_16x16x32_bf16 v[180:183], a[100:103], a[52:55], v[180:183]
  v_add_u32 v228, 0x4000, v228
  v_cvt_pk_bf16_f32 v164, v168, v169
  v_mfma_f32_16x16x32_bf16 v[180:183], a[96:99], a[48:51], v[180:183]
  v_add_u32 v224, 0x4000, v224
  v_cvt_pk_bf16_f32 v165, v170, v171
  v_mfma_f32_16x16x32_bf16 v[184:187], a[112:115], a[48:51], v[204:207]
  v_exp_f32 v179, v179
  v_mfma_f32_16x16x32_bf16 v[184:187], a[116:119], a[52:55], v[184:187]
  s_waitcnt vmcnt(19)
  ds_write_b32 v253, v252
  v_mfma_f32_16x16x32_bf16 v[184:187], a[120:123], a[56:59], v[184:187]
  v_exp_f32 v177, v177
  v_mfma_f32_16x16x32_bf16 v[184:187], a[124:127], a[60:63], v[184:187]
  v_exp_f32 v178, v178
  v_mfma_f32_16x16x32_bf16 v[188:191], a[140:143], a[60:63], v[204:207]
  v_exp_f32 v180, v180
  v_mfma_f32_16x16x32_bf16 v[188:191], a[136:139], a[56:59], v[188:191]
  v_exp_f32 v182, v182
  v_mfma_f32_16x16x32_bf16 v[188:191], a[132:135], a[52:55], v[188:191]
  v_exp_f32 v176, v176
  v_mfma_f32_16x16x32_bf16 v[188:191], a[128:131], a[48:51], v[188:191]
  v_cvt_pk_bf16_f32 v166, v172, v173
  v_cvt_pk_bf16_f32 v167, v174, v175
  v_mfma_f32_16x16x32_bf16 v[64:67], a[144:147], v[160:163], v[64:67]
  buffer_store_dwordx4 a[236:239], v238, s[24:27], s45 offen offset:1024
  v_mfma_f32_16x16x32_bf16 v[64:67], a[176:179], v[164:167], v[64:67]
  v_exp_f32 v187, v187
  v_mfma_f32_16x16x32_bf16 v[68:71], a[180:183], v[164:167], v[68:71]
  v_exp_f32 v185, v185
  v_mfma_f32_16x16x32_bf16 v[68:71], a[148:151], v[160:163], v[68:71]
  v_exp_f32 v184, v184
  v_mfma_f32_16x16x32_bf16 v[72:75], a[152:155], v[160:163], v[72:75]
  v_cvt_pk_bf16_f32 v176, v176, v177
  v_mfma_f32_16x16x32_bf16 v[72:75], a[184:187], v[164:167], v[72:75]
  v_exp_f32 v190, v190
  v_mfma_f32_16x16x32_bf16 v[76:79], a[188:191], v[164:167], v[76:79]
  buffer_load_dwordx4 v234, s[12:15], s45 offen offset:2048 nt lds
  v_mfma_f32_16x16x32_bf16 v[76:79], a[156:159], v[160:163], v[76:79]
  v_exp_f32 v191, v191
  v_mfma_f32_16x16x32_bf16 v[80:83], a[160:163], v[160:163], v[80:83]
  ds_read_b32 v251, v250
  v_cvt_pk_bf16_f32 v177, v178, v179
  v_mfma_f32_16x16x32_bf16 v[80:83], a[192:195], v[164:167], v[80:83]
  v_exp_f32 v183, v183
  v_mfma_f32_16x16x32_bf16 v[84:87], a[196:199], v[164:167], v[84:87]
  v_exp_f32 v181, v181
  v_mfma_f32_16x16x32_bf16 v[84:87], a[164:167], v[160:163], v[84:87]
  v_exp_f32 v188, v188
  v_mfma_f32_16x16x32_bf16 v[88:91], a[168:171], v[160:163], v[88:91]
  v_exp_f32 v189, v189
  v_mfma_f32_16x16x32_bf16 v[88:91], a[200:203], v[164:167], v[88:91]
  s_waitcnt lgkmcnt(1)
  buffer_load_dwordx4 v233, s[12:15], s45 offen offset:1024 nt lds
  v_mfma_f32_16x16x32_bf16 v[92:95], a[204:207], v[164:167], v[92:95]
  s_waitcnt lgkmcnt(0)
  v_cmp_gt_u32 vcc, v252, v251
  v_mfma_f32_16x16x32_bf16 v[92:95], a[172:175], v[160:163], v[92:95]
  buffer_load_dwordx4 v235, s[12:15], s45 offen offset:3072 nt lds
  v_smfmac_f32_16x16x64_bf16 a[216:219], a[228:231], v[160:167], v254
  v_add_u32 v226, 0x4000, v226
  v_mfma_f32_16x16x32_bf16 v[160:163], a[80:83], a[64:67], v[208:211]
  s_cbranch_vccnz L_SPIN18
  L_BACK18:
  v_mfma_f32_16x16x32_bf16 v[160:163], a[84:87], a[68:71], v[160:163]
  ds_read_b128 a[84:87], v221 offset:32768
  v_mfma_f32_16x16x32_bf16 v[160:163], a[88:91], a[72:75], v[160:163]
  ds_read_b128 a[80:83], v220 offset:32768
  v_cvt_pk_bf16_f32 v178, v180, v181
  v_mfma_f32_16x16x32_bf16 v[160:163], a[92:95], a[76:79], v[160:163]
  ds_read_b128 a[92:95], v223 offset:32768
  v_mfma_f32_16x16x32_bf16 v[164:167], a[108:111], a[76:79], v[208:211]
  ds_read_b128 a[88:91], v222 offset:32768
  s_add_u32 m0, s30, 33024
  v_mfma_f32_16x16x32_bf16 v[164:167], a[104:107], a[72:75], v[164:167]
  buffer_load_dwordx4 v232, s[16:19], s54 offen offset:0 nt lds
  v_mfma_f32_16x16x32_bf16 v[164:167], a[100:103], a[68:71], v[164:167]
  ds_read_b128 a[104:107], v222 offset:36864
  v_mfma_f32_16x16x32_bf16 v[164:167], a[96:99], a[64:67], v[164:167]
  ds_read_b128 a[96:99], v220 offset:36864
  v_cvt_pk_bf16_f32 v179, v182, v183
  v_mfma_f32_16x16x32_bf16 v[168:171], a[112:115], a[64:67], v[208:211]
  ds_read_b128 a[108:111], v223 offset:36864
  ds_read_b128 a[100:103], v221 offset:36864
  v_mfma_f32_16x16x32_bf16 v[168:171], a[116:119], a[68:71], v[168:171]
  ds_read_b128 a[116:119], v221 offset:40960
  v_add_u32 v252, 1, v252
  v_mfma_f32_16x16x32_bf16 v[168:171], a[120:123], a[72:75], v[168:171]
  ds_read_b128 a[112:115], v220 offset:40960
  v_cvt_pk_bf16_f32 v180, v184, v185
  v_mfma_f32_16x16x32_bf16 v[168:171], a[124:127], a[76:79], v[168:171]
  ds_read_b128 a[120:123], v222 offset:40960
  ds_read_b128 a[124:127], v223 offset:40960
  v_mfma_f32_16x16x32_bf16 v[172:175], a[140:143], a[76:79], v[208:211]
  v_exp_f32 v186, v186
  v_mfma_f32_16x16x32_bf16 v[172:175], a[136:139], a[72:75], v[172:175]
  buffer_load_dwordx4 v233, s[16:19], s54 offen offset:1024 nt lds
  v_mfma_f32_16x16x32_bf16 v[172:175], a[132:135], a[68:71], v[172:175]
  v_cvt_pk_bf16_f32 v181, v186, v187
  v_cvt_pk_bf16_f32 v182, v188, v189
  v_mfma_f32_16x16x32_bf16 v[172:175], a[128:131], a[64:67], v[172:175]
  v_add_u32 v231, 0x4000, v231
  v_cvt_pk_bf16_f32 v183, v190, v191
  v_mfma_f32_16x16x32_bf16 v[96:99], a[144:147], v[176:179], v[96:99]
  v_exp_f32 v165, v165
  v_mfma_f32_16x16x32_bf16 v[96:99], a[176:179], v[180:183], v[96:99]
  v_exp_f32 v167, v167
  v_mfma_f32_16x16x32_bf16 v[100:103], a[180:183], v[180:183], v[100:103]
  v_exp_f32 v162, v162
  v_mfma_f32_16x16x32_bf16 v[100:103], a[148:151], v[176:179], v[100:103]
  v_exp_f32 v171, v171
  v_mfma_f32_16x16x32_bf16 v[104:107], a[152:155], v[176:179], v[104:107]
  s_waitcnt vmcnt(19) lgkmcnt(0)
  ds_write_b32 v253, v252
  v_mfma_f32_16x16x32_bf16 v[104:107], a[184:187], v[180:183], v[104:107]
  v_mfma_f32_16x16x32_bf16 v[108:111], a[188:191], v[180:183], v[108:111]
  v_exp_f32 v172, v172
  v_mfma_f32_16x16x32_bf16 v[108:111], a[156:159], v[176:179], v[108:111]
  v_exp_f32 v168, v168
  v_mfma_f32_16x16x32_bf16 v[112:115], a[160:163], v[176:179], v[112:115]
  v_exp_f32 v166, v166
  v_mfma_f32_16x16x32_bf16 v[112:115], a[192:195], v[180:183], v[112:115]
  buffer_load_dwordx4 v234, s[16:19], s54 offen offset:2048 nt lds
  v_mfma_f32_16x16x32_bf16 v[116:119], a[196:199], v[180:183], v[116:119]
  v_exp_f32 v163, v163
  v_mfma_f32_16x16x32_bf16 v[116:119], a[164:167], v[176:179], v[116:119]
  v_exp_f32 v164, v164
  v_mfma_f32_16x16x32_bf16 v[120:123], a[168:171], v[176:179], v[120:123]
  v_exp_f32 v160, v160
  v_mfma_f32_16x16x32_bf16 v[120:123], a[200:203], v[180:183], v[120:123]
  v_exp_f32 v161, v161
  v_mfma_f32_16x16x32_bf16 v[124:127], a[204:207], v[180:183], v[124:127]
  v_cvt_pk_bf16_f32 v160, v160, v161
  v_cvt_pk_bf16_f32 v161, v162, v163
  v_mfma_f32_16x16x32_bf16 v[124:127], a[172:175], v[176:179], v[124:127]
  v_exp_f32 v174, v174
  v_smfmac_f32_16x16x64_bf16 a[220:223], a[228:231], v[176:183], v254
  s_cmp_eq_u32 s32, 3
  s_cbranch_scc1 L_TAIL
  v_mfma_f32_16x16x32_bf16 v[176:179], a[80:83], a[0:3], v[192:195]
  v_exp_f32 v169, v169
  v_mfma_f32_16x16x32_bf16 v[176:179], a[84:87], a[4:7], v[176:179]
  v_cvt_pk_bf16_f32 v162, v164, v165
  v_cvt_pk_bf16_f32 v163, v166, v167
  v_mfma_f32_16x16x32_bf16 v[176:179], a[88:91], a[8:11], v[176:179]
  buffer_load_dwordx4 v235, s[16:19], s54 offen offset:3072 nt lds
  v_mfma_f32_16x16x32_bf16 v[176:179], a[92:95], a[12:15], v[176:179]
  v_exp_f32 v175, v175
  v_mfma_f32_16x16x32_bf16 v[180:183], a[108:111], a[12:15], v[192:195]
  v_exp_f32 v173, v173
  v_mfma_f32_16x16x32_bf16 v[180:183], a[104:107], a[8:11], v[180:183]
  ds_read_b32 v251, v250
  v_cvt_pk_bf16_f32 v164, v168, v169
  v_mfma_f32_16x16x32_bf16 v[180:183], a[100:103], a[4:7], v[180:183]
  v_exp_f32 v170, v170
  v_mfma_f32_16x16x32_bf16 v[180:183], a[96:99], a[0:3], v[180:183]
  v_cvt_pk_bf16_f32 v165, v170, v171
  v_cvt_pk_bf16_f32 v166, v172, v173
  v_mfma_f32_16x16x32_bf16 v[184:187], a[112:115], a[0:3], v[192:195]
  v_exp_f32 v178, v178
  v_mfma_f32_16x16x32_bf16 v[184:187], a[116:119], a[4:7], v[184:187]
  s_waitcnt lgkmcnt(0)
  v_cmp_gt_u32 vcc, v252, v251
  v_mfma_f32_16x16x32_bf16 v[184:187], a[120:123], a[8:11], v[184:187]
  v_add_u32 v227, 0x4000, v227
  v_cvt_pk_bf16_f32 v167, v174, v175
  v_mfma_f32_16x16x32_bf16 v[184:187], a[124:127], a[12:15], v[184:187]
  s_cbranch_vccnz L_SPIN19
  L_BACK19:
  v_mfma_f32_16x16x32_bf16 v[128:131], a[144:147], v[160:163], v[128:131]
  v_exp_f32 v179, v179
  v_mfma_f32_16x16x32_bf16 v[128:131], a[176:179], v[164:167], v[128:131]
  ds_read_b64_tr_b16 a[146:147], v224 offset:53248
  ds_read_b128 a[0:3], v240 offset:0
  v_mfma_f32_16x16x32_bf16 v[132:135], a[180:183], v[164:167], v[132:135]
  v_exp_f32 v176, v176
  v_mfma_f32_16x16x32_bf16 v[132:135], a[148:151], v[160:163], v[132:135]
  ds_read_b64_tr_b16 a[148:149], v225 offset:49152
  v_mfma_f32_16x16x32_bf16 v[136:139], a[152:155], v[160:163], v[136:139]
  v_exp_f32 v181, v181
  v_mfma_f32_16x16x32_bf16 v[136:139], a[184:187], v[164:167], v[136:139]
  ds_read_b64_tr_b16 a[144:145], v224 offset:49152
  v_mfma_f32_16x16x32_bf16 v[140:143], a[188:191], v[164:167], v[140:143]
  ds_read_b64_tr_b16 a[154:155], v226 offset:53248
  v_add_u32 v221, 0xffffc000, v221
  v_mfma_f32_16x16x32_bf16 v[140:143], a[156:159], v[160:163], v[140:143]
  v_exp_f32 v177, v177
  v_mfma_f32_16x16x32_bf16 v[144:147], a[160:163], v[160:163], v[144:147]
  ds_read_b64_tr_b16 a[152:153], v226 offset:49152
  v_add_u32 v222, 0xffffc000, v222
  v_mfma_f32_16x16x32_bf16 v[144:147], a[192:195], v[164:167], v[144:147]
  ds_read_b64_tr_b16 a[158:159], v227 offset:53248
  v_add_u32 v223, 0xffffc000, v223
  v_mfma_f32_16x16x32_bf16 v[148:151], a[196:199], v[164:167], v[148:151]
  ds_read_b64_tr_b16 a[150:151], v225 offset:53248
  v_cvt_pk_bf16_f32 v176, v176, v177
  v_mfma_f32_16x16x32_bf16 v[148:151], a[164:167], v[160:163], v[148:151]
  v_exp_f32 v182, v182
  v_mfma_f32_16x16x32_bf16 v[152:155], a[168:171], v[160:163], v[152:155]
  ds_read_b64_tr_b16 a[156:157], v227 offset:49152
  v_mfma_f32_16x16x32_bf16 v[152:155], a[200:203], v[164:167], v[152:155]
  ds_read_b64_tr_b16 a[162:163], v228 offset:53248
  v_mfma_f32_16x16x32_bf16 v[156:159], a[204:207], v[164:167], v[156:159]
  v_exp_f32 v180, v180
  v_mfma_f32_16x16x32_bf16 v[156:159], a[172:175], v[160:163], v[156:159]
  ds_read_b64_tr_b16 a[160:161], v228 offset:49152
  v_cvt_pk_bf16_f32 v177, v178, v179
  v_smfmac_f32_16x16x64_bf16 a[224:227], a[228:231], v[160:167], v254
  s_waitcnt lgkmcnt(3)
  v_mfma_f32_16x16x16_bf16 v[212:215], a[248:249], a[0:1], 0
  v_exp_f32 v184, v184
  v_mfma_f32_16x16x16_bf16 v[212:215], a[250:251], a[0:1], v[212:215]
  v_exp_f32 v186, v186
  v_mfma_f32_16x16x16_bf16 v[192:195], a[250:251], a[2:3], 0
  ds_read_b64_tr_b16 a[164:165], v229 offset:49152
  v_cvt_pk_bf16_f32 v178, v180, v181
  v_mfma_f32_16x16x16_bf16 v[192:195], a[248:249], a[2:3], v[192:195]
  ds_read_b64_tr_b16 a[170:171], v230 offset:53248
  v_add_u32 v220, 0xffffc000, v220
  v_exp_f32 v183, v183
  v_mfma_f32_16x16x32_bf16 v[160:163], a[80:83], a[16:19], v[196:199]
  ds_read_b64_tr_b16 a[166:167], v229 offset:53248
  v_add_u32 v252, 1, v252
  v_mfma_f32_16x16x32_bf16 v[160:163], a[84:87], a[20:23], v[160:163]
  v_exp_f32 v185, v185
  v_mfma_f32_16x16x32_bf16 v[160:163], a[88:91], a[24:27], v[160:163]
  ds_read_b64_tr_b16 a[168:169], v230 offset:49152
  v_cvt_pk_bf16_f32 v212, v212, v213
  v_mfma_f32_16x16x32_bf16 v[160:163], a[92:95], a[28:31], v[160:163]
  ds_read_b128 a[4:7], v241 offset:0
  v_accvgpr_write_b32 a0, v212
  v_mfma_f32_16x16x32_bf16 v[164:167], a[108:111], a[28:31], v[196:199]
  ds_read_b64_tr_b16 a[174:175], v231 offset:53248
  v_mfma_f32_16x16x32_bf16 v[164:167], a[104:107], a[24:27], v[164:167]
  ds_read_b64_tr_b16 a[180:181], v225 offset:57344
  v_cvt_pk_bf16_f32 v192, v192, v193
  v_mfma_f32_16x16x32_bf16 v[164:167], a[100:103], a[20:23], v[164:167]
  ds_read_b64_tr_b16 a[172:173], v231 offset:49152
  v_cvt_pk_bf16_f32 v194, v194, v195
  v_mfma_f32_16x16x32_bf16 v[164:167], a[96:99], a[16:19], v[164:167]
  ds_read_b128 a[8:11], v242 offset:0
  v_cvt_pk_bf16_f32 v179, v182, v183
  v_mfma_f32_16x16x32_bf16 v[168:171], a[112:115], a[16:19], v[196:199]
  ds_read_b64_tr_b16 a[188:189], v227 offset:57344
  v_cvt_pk_bf16_f32 v214, v214, v215
  v_mfma_f32_16x16x32_bf16 v[168:171], a[116:119], a[20:23], v[168:171]
  ds_read_b64_tr_b16 a[184:185], v226 offset:57344
  v_accvgpr_write_b32 a3, v194
  v_mfma_f32_16x16x32_bf16 v[168:171], a[120:123], a[24:27], v[168:171]
  ds_read_b64_tr_b16 a[176:177], v224 offset:57344
  v_accvgpr_write_b32 a1, v214
  v_mfma_f32_16x16x32_bf16 v[168:171], a[124:127], a[28:31], v[168:171]
  ds_read_b64_tr_b16 a[196:197], v229 offset:57344
  v_accvgpr_write_b32 a2, v192
  s_waitcnt lgkmcnt(6)
  v_mfma_f32_16x16x16_bf16 v[212:215], a[248:249], a[4:5], 0
  ds_read_b64_tr_b16 a[192:193], v228 offset:57344
  v_mov_b32 v182, 0
  v_mfma_f32_16x16x16_bf16 v[212:215], a[250:251], a[4:5], v[212:215]
  v_exp_f32 v162, v162
  v_mfma_f32_16x16x16_bf16 v[192:195], a[250:251], a[6:7], 0
  ds_read_b64_tr_b16 a[200:201], v230 offset:57344
  v_mov_b32 v183, 0
  v_mfma_f32_16x16x16_bf16 v[192:195], a[248:249], a[6:7], v[192:195]
  ds_read_b128 a[12:15], v243 offset:0
  v_exp_f32 v187, v187
  v_mfma_f32_16x16x32_bf16 v[0:3], a[144:147], v[176:179], v[0:3]
  ds_read_b128 a[16:19], v240 offset:4096
  v_cvt_pk_bf16_f32 v180, v184, v185
  v_mfma_f32_16x16x32_bf16 v[4:7], a[148:151], v[176:179], v[4:7]
  v_exp_f32 v163, v163
  v_mfma_f32_16x16x32_bf16 v[8:11], a[152:155], v[176:179], v[8:11]
  v_exp_f32 v160, v160
  v_mfma_f32_16x16x32_bf16 v[12:15], a[156:159], v[176:179], v[12:15]
  ds_read_b64_tr_b16 a[204:205], v231 offset:57344
  v_cvt_pk_bf16_f32 v181, v186, v187
  v_mfma_f32_16x16x32_bf16 v[16:19], a[160:163], v[176:179], v[16:19]
  ds_read_b128 a[20:23], v241 offset:4096
  v_cvt_pk_bf16_f32 v214, v214, v215
  v_mfma_f32_16x16x32_bf16 v[20:23], a[164:167], v[176:179], v[20:23]
  v_accvgpr_write_b32 a5, v214
  v_mfma_f32_16x16x32_bf16 v[24:27], a[168:171], v[176:179], v[24:27]
  ds_read_b128 a[28:31], v243 offset:4096
  v_cvt_pk_bf16_f32 v194, v194, v195
  s_waitcnt lgkmcnt(3)
  v_mfma_f32_16x16x32_bf16 v[28:31], a[172:175], v[176:179], v[28:31]
  ds_read_b128 a[24:27], v242 offset:4096
  v_cvt_pk_bf16_f32 v192, v192, v193
  v_smfmac_f32_16x16x64_bf16 a[208:211], a[228:231], v[176:183], v254
  s_add_u32 m0, s30, 49408
  v_mfma_f32_16x16x16_bf16 v[0:3], a[176:177], v[180:181], v[0:3]
  buffer_load_dwordx4 v236, s[20:23], s54 offen offset:0  lds
  v_mfma_f32_16x16x16_bf16 v[4:7], a[180:181], v[180:181], v[4:7]
  v_exp_f32 v164, v164
  v_mfma_f32_16x16x16_bf16 v[8:11], a[184:185], v[180:181], v[8:11]
  v_accvgpr_write_b32 a6, v192
  v_mfma_f32_16x16x16_bf16 v[12:15], a[188:189], v[180:181], v[12:15]
  v_cvt_pk_bf16_f32 v212, v212, v213
  v_mfma_f32_16x16x16_bf16 v[16:19], a[192:193], v[180:181], v[16:19]
  v_exp_f32 v165, v165
  v_mfma_f32_16x16x16_bf16 v[20:23], a[196:197], v[180:181], v[20:23]
  v_accvgpr_write_b32 a4, v212
  v_accvgpr_write_b32 a7, v194
  v_mfma_f32_16x16x16_bf16 v[24:27], a[200:201], v[180:181], v[24:27]
  v_exp_f32 v169, v169
  s_waitcnt lgkmcnt(0)
  v_mfma_f32_16x16x16_bf16 v[28:31], a[204:205], v[180:181], v[28:31]
  buffer_load_dwordx4 v237, s[20:23], s54 offen offset:1024  lds
  v_mfma_f32_16x16x16_bf16 v[212:215], a[248:249], a[8:9], 0
  v_exp_f32 v166, v166
  v_mfma_f32_16x16x16_bf16 v[212:215], a[250:251], a[8:9], v[212:215]
  v_exp_f32 v171, v171
  v_mfma_f32_16x16x16_bf16 v[192:195], a[250:251], a[10:11], 0
  v_exp_f32 v161, v161
  v_mfma_f32_16x16x16_bf16 v[192:195], a[248:249], a[10:11], v[192:195]
  v_cvt_pk_bf16_f32 v160, v160, v161
  v_mfma_f32_16x16x16_bf16 v[216:219], a[248:249], a[16:17], 0
  v_accvgpr_read_b32 v249, a208
  v_accvgpr_read_b32 v248, a209
  v_add_f32 v249, v249, v248
  v_rcp_f32 v248, v249
  v_subrev_u32 v249, 0x1c800000, v249
  v_cmp_lt_u32 s[66:67], s69, v249
  v_pk_mul_f32 v[0:1], v[0:1], v[248:249] op_sel_hi:[1,0]
  v_pk_mul_f32 v[2:3], v[2:3], v[248:249] op_sel_hi:[1,0]
  v_pk_mul_f32 v[16:17], v[16:17], v[248:249] op_sel_hi:[1,0]
  v_pk_mul_f32 v[18:19], v[18:19], v[248:249] op_sel_hi:[1,0]
  v_pk_mul_f32 v[4:5], v[4:5], v[248:249] op_sel_hi:[1,0]
  v_pk_mul_f32 v[6:7], v[6:7], v[248:249] op_sel_hi:[1,0]
  v_pk_mul_f32 v[20:21], v[20:21], v[248:249] op_sel_hi:[1,0]
  v_pk_mul_f32 v[22:23], v[22:23], v[248:249] op_sel_hi:[1,0]
  v_pk_mul_f32 v[8:9], v[8:9], v[248:249] op_sel_hi:[1,0]
  v_pk_mul_f32 v[10:11], v[10:11], v[248:249] op_sel_hi:[1,0]
  v_pk_mul_f32 v[24:25], v[24:25], v[248:249] op_sel_hi:[1,0]
  v_pk_mul_f32 v[26:27], v[26:27], v[248:249] op_sel_hi:[1,0]
  v_pk_mul_f32 v[12:13], v[12:13], v[248:249] op_sel_hi:[1,0]
  v_pk_mul_f32 v[14:15], v[14:15], v[248:249] op_sel_hi:[1,0]
  v_pk_mul_f32 v[28:29], v[28:29], v[248:249] op_sel_hi:[1,0]
  v_pk_mul_f32 v[30:31], v[30:31], v[248:249] op_sel_hi:[1,0]
  v_mfma_f32_16x16x16_bf16 v[216:219], a[250:251], a[16:17], v[216:219]
  v_exp_f32 v167, v167
  v_mfma_f32_16x16x16_bf16 v[196:199], a[250:251], a[18:19], 0
  v_cvt_pk_bf16_f32 v214, v214, v215
  v_accvgpr_write_b32 a9, v214
  v_mfma_f32_16x16x16_bf16 v[196:199], a[248:249], a[18:19], v[196:199]
  buffer_store_dwordx4 a[240:243], v238, s[24:27], s45 offen offset:2048
  v_mfma_f32_16x16x32_bf16 v[176:179], a[80:83], a[32:35], v[200:203]
  v_cvt_pk_bf16_f32 v192, v192, v193
  v_cvt_pk_bf16_f32 v161, v162, v163
  v_mfma_f32_16x16x32_bf16 v[176:179], a[84:87], a[36:39], v[176:179]
  v_accvgpr_write_b32 a10, v192
  v_cvt_pk_bf16_f32 v162, v164, v165
  v_mfma_f32_16x16x32_bf16 v[176:179], a[88:91], a[40:43], v[176:179]
  v_cvt_pk_bf16_f32 v194, v194, v195
  v_accvgpr_write_b32 a11, v194
  v_mfma_f32_16x16x32_bf16 v[176:179], a[92:95], a[44:47], v[176:179]
  v_cvt_pk_bf16_f32 v218, v218, v219
  v_cvt_pk_bf16_f32 v0, v0, v1
  v_mfma_f32_16x16x32_bf16 v[180:183], a[108:111], a[44:47], v[200:203]
  v_cvt_pk_bf16_f32 v212, v212, v213
  v_cvt_pk_bf16_f32 v198, v198, v199
  v_mfma_f32_16x16x32_bf16 v[180:183], a[104:107], a[40:43], v[180:183]
  v_cvt_pk_bf16_f32 v196, v196, v197
  v_cvt_pk_bf16_f32 v163, v166, v167
  v_mfma_f32_16x16x32_bf16 v[180:183], a[100:103], a[36:39], v[180:183]
  v_accvgpr_write_b32 a8, v212
  v_accvgpr_write_b32 a17, v218
  v_mfma_f32_16x16x32_bf16 v[180:183], a[96:99], a[32:35], v[180:183]
  buffer_load_dwordx4 v236, s[20:23], s54 offen offset:2048  lds
  v_mfma_f32_16x16x32_bf16 v[184:187], a[112:115], a[32:35], v[200:203]
  v_cvt_pk_bf16_f32 v216, v216, v217
  v_cvt_pk_bf16_f32 v20, v20, v21
  v_mfma_f32_16x16x32_bf16 v[184:187], a[116:119], a[36:39], v[184:187]
  v_accvgpr_write_b32 a18, v196
  v_cvt_pk_bf16_f32 v1, v2, v3
  v_mfma_f32_16x16x32_bf16 v[184:187], a[120:123], a[40:43], v[184:187]
  v_exp_f32 v170, v170
  v_mfma_f32_16x16x32_bf16 v[184:187], a[124:127], a[44:47], v[184:187]
  v_accvgpr_write_b32 a19, v198
  v_mov_b32 v166, 0
  v_mfma_f32_16x16x16_bf16 v[212:215], a[248:249], a[12:13], 0
  v_accvgpr_write_b32 a16, v216
  v_cvt_pk_bf16_f32 v16, v16, v17
  v_mfma_f32_16x16x16_bf16 v[212:215], a[250:251], a[12:13], v[212:215]
  v_exp_f32 v176, v176
  v_mfma_f32_16x16x16_bf16 v[192:195], a[250:251], a[14:15], 0
  v_exp_f32 v168, v168
  v_mfma_f32_16x16x16_bf16 v[192:195], a[248:249], a[14:15], v[192:195]
  buffer_load_dwordx4 v237, s[20:23], s54 offen offset:3072  lds
  v_mfma_f32_16x16x16_bf16 v[216:219], a[248:249], a[20:21], 0
  ds_read_b128 a[36:39], v241 offset:8192
  v_cvt_pk_bf16_f32 v4, v4, v5
  v_mfma_f32_16x16x16_bf16 v[216:219], a[250:251], a[20:21], v[216:219]
  v_cvt_pk_bf16_f32 v164, v168, v169
  v_exp_f32 v180, v180
  v_mfma_f32_16x16x16_bf16 v[196:199], a[250:251], a[22:23], 0
  ds_read_b128 a[40:43], v242 offset:8192
  v_cvt_pk_bf16_f32 v165, v170, v171
  v_mfma_f32_16x16x16_bf16 v[196:199], a[248:249], a[22:23], v[196:199]
  v_mov_b32 v167, 0
  v_exp_f32 v186, v186
  v_cvt_pk_bf16_f32 v21, v22, v23
  v_mfma_f32_16x16x32_bf16 v[32:35], a[144:147], v[160:163], v[32:35]
  ds_read_b128 a[32:35], v240 offset:8192
  v_cvt_pk_bf16_f32 v28, v28, v29
  v_mfma_f32_16x16x32_bf16 v[36:39], a[148:151], v[160:163], v[36:39]
  ds_read_b128 a[44:47], v243 offset:8192
  v_cvt_pk_bf16_f32 v214, v214, v215
  v_mfma_f32_16x16x32_bf16 v[40:43], a[152:155], v[160:163], v[40:43]
  v_exp_f32 v183, v183
  v_mfma_f32_16x16x32_bf16 v[44:47], a[156:159], v[160:163], v[44:47]
  v_cvt_pk_bf16_f32 v216, v216, v217
  v_cvt_pk_bf16_f32 v24, v24, v25
  v_mfma_f32_16x16x32_bf16 v[48:51], a[160:163], v[160:163], v[48:51]
  v_exp_f32 v187, v187
  v_mfma_f32_16x16x32_bf16 v[52:55], a[164:167], v[160:163], v[52:55]
  v_exp_f32 v185, v185
  v_mfma_f32_16x16x32_bf16 v[56:59], a[168:171], v[160:163], v[56:59]
  v_cvt_pk_bf16_f32 v192, v192, v193
  v_accvgpr_write_b32 a20, v216
  v_cvt_pk_bf16_f32 v17, v18, v19
  v_mfma_f32_16x16x32_bf16 v[60:63], a[172:175], v[160:163], v[60:63]
  v_accvgpr_write_b32 a14, v192
  v_cvt_pk_bf16_f32 v218, v218, v219
  v_smfmac_f32_16x16x64_bf16 a[212:215], a[228:231], v[160:167], v254
  v_cvt_pk_bf16_f32 v198, v198, v199
  v_mfma_f32_16x16x16_bf16 v[32:35], a[176:177], v[164:165], v[32:35]
  ds_write2st64_b64 v244, v[0:1], v[16:17] offset0:0 offset1:4
  v_mfma_f32_16x16x16_bf16 v[36:39], a[180:181], v[164:165], v[36:39]
  v_exp_f32 v181, v181
  v_mfma_f32_16x16x16_bf16 v[40:43], a[184:185], v[164:165], v[40:43]
  v_cvt_pk_bf16_f32 v212, v212, v213
  v_accvgpr_write_b32 a23, v198
  v_mfma_f32_16x16x16_bf16 v[44:47], a[188:189], v[164:165], v[44:47]
  v_exp_f32 v178, v178
  v_mfma_f32_16x16x16_bf16 v[48:51], a[192:193], v[164:165], v[48:51]
  v_accvgpr_write_b32 a21, v218
  v_exp_f32 v182, v182
  v_mfma_f32_16x16x16_bf16 v[52:55], a[196:197], v[164:165], v[52:55]
  v_cvt_pk_bf16_f32 v196, v196, v197
  v_accvgpr_write_b32 a22, v196
  v_mfma_f32_16x16x16_bf16 v[56:59], a[200:201], v[164:165], v[56:59]
  v_accvgpr_write_b32 a12, v212
  v_accvgpr_write_b32 a13, v214
  s_or_b64 s[36:37], s[36:37], s[66:67]
  v_mfma_f32_16x16x16_bf16 v[60:63], a[204:205], v[164:165], v[60:63]
  v_exp_f32 v184, v184
  v_mfma_f32_16x16x16_bf16 v[216:219], a[248:249], a[24:25], 0
  v_exp_f32 v177, v177
  v_mfma_f32_16x16x16_bf16 v[216:219], a[250:251], a[24:25], v[216:219]
  v_cvt_pk_bf16_f32 v194, v194, v195
  v_accvgpr_write_b32 a15, v194
  v_mfma_f32_16x16x16_bf16 v[196:199], a[250:251], a[26:27], 0
  v_exp_f32 v179, v179
  v_mfma_f32_16x16x16_bf16 v[196:199], a[248:249], a[26:27], v[196:199]
  v_cvt_pk_bf16_f32 v176, v176, v177
  s_waitcnt lgkmcnt(0)
  v_mfma_f32_16x16x16_bf16 v[212:215], a[248:249], a[32:33], 0
  v_cvt_pk_bf16_f32 v177, v178, v179
  v_cvt_pk_bf16_f32 v178, v180, v181
  v_mfma_f32_16x16x16_bf16 v[212:215], a[250:251], a[32:33], v[212:215]
  v_cvt_pk_bf16_f32 v8, v8, v9
  v_cvt_pk_bf16_f32 v9, v10, v11
  v_mfma_f32_16x16x16_bf16 v[200:203], a[250:251], a[34:35], 0
  v_cvt_pk_bf16_f32 v216, v216, v217
  v_cvt_pk_bf16_f32 v25, v26, v27
  v_mfma_f32_16x16x16_bf16 v[200:203], a[248:249], a[34:35], v[200:203]
  ds_write2st64_b64 v246, v[8:9], v[24:25] offset0:0 offset1:4
  v_mfma_f32_16x16x32_bf16 v[160:163], a[80:83], a[48:51], v[204:207]
  v_cvt_pk_bf16_f32 v179, v182, v183
  v_accvgpr_read_b32 v249, a212
  v_mfma_f32_16x16x32_bf16 v[160:163], a[84:87], a[52:55], v[160:163]
  v_cvt_pk_bf16_f32 v198, v198, v199
  v_accvgpr_read_b32 v248, a213
  v_mfma_f32_16x16x32_bf16 v[160:163], a[88:91], a[56:59], v[160:163]
  v_cvt_pk_bf16_f32 v218, v218, v219
  v_accvgpr_write_b32 a25, v218
  v_mfma_f32_16x16x32_bf16 v[160:163], a[92:95], a[60:63], v[160:163]
  v_cvt_pk_bf16_f32 v212, v212, v213
  v_cvt_pk_bf16_f32 v214, v214, v215
  v_mfma_f32_16x16x32_bf16 v[164:167], a[108:111], a[60:63], v[204:207]
  v_cvt_pk_bf16_f32 v29, v30, v31
  v_add_f32 v249, v249, v248
  v_mfma_f32_16x16x32_bf16 v[164:167], a[104:107], a[56:59], v[164:167]
  v_cvt_pk_bf16_f32 v196, v196, v197
  v_accvgpr_write_b32 a26, v196
  v_mfma_f32_16x16x32_bf16 v[164:167], a[100:103], a[52:55], v[164:167]
  v_cvt_pk_bf16_f32 v202, v202, v203
  v_mov_b32 v182, 0
  v_mfma_f32_16x16x32_bf16 v[164:167], a[96:99], a[48:51], v[164:167]
  v_accvgpr_write_b32 a32, v212
  v_accvgpr_write_b32 a35, v202
  v_mfma_f32_16x16x32_bf16 v[168:171], a[112:115], a[48:51], v[204:207]
  v_cvt_pk_bf16_f32 v200, v200, v201
  v_accvgpr_write_b32 a34, v200
  v_mfma_f32_16x16x32_bf16 v[168:171], a[116:119], a[52:55], v[168:171]
  v_exp_f32 v162, v162
  v_mfma_f32_16x16x32_bf16 v[168:171], a[120:123], a[56:59], v[168:171]
  v_accvgpr_write_b32 a24, v216
  v_accvgpr_write_b32 a27, v198
  v_mfma_f32_16x16x32_bf16 v[168:171], a[124:127], a[60:63], v[168:171]
  v_cvt_pk_bf16_f32 v180, v184, v185
  v_cvt_pk_bf16_f32 v181, v186, v187
  v_mfma_f32_16x16x16_bf16 v[216:219], a[248:249], a[28:29], 0
  v_rcp_f32 v248, v249
  v_mfma_f32_16x16x16_bf16 v[216:219], a[250:251], a[28:29], v[216:219]
  v_exp_f32 v167, v167
  v_mfma_f32_16x16x16_bf16 v[196:199], a[250:251], a[30:31], 0
  v_exp_f32 v165, v165
  v_mfma_f32_16x16x16_bf16 v[196:199], a[248:249], a[30:31], v[196:199]
  v_accvgpr_write_b32 a33, v214
  v_cvt_pk_bf16_f32 v5, v6, v7
  v_mfma_f32_16x16x16_bf16 v[212:215], a[248:249], a[36:37], 0
  v_exp_f32 v168, v168
  v_mfma_f32_16x16x16_bf16 v[212:215], a[250:251], a[36:37], v[212:215]
  v_exp_f32 v164, v164
  v_mfma_f32_16x16x16_bf16 v[200:203], a[250:251], a[38:39], 0
  v_exp_f32 v160, v160
  v_mfma_f32_16x16x16_bf16 v[200:203], a[248:249], a[38:39], v[200:203]
  v_cvt_pk_bf16_f32 v216, v216, v217
  v_accvgpr_write_b32 a28, v216
  v_exp_f32 v163, v163
  v_mfma_f32_16x16x32_bf16 v[64:67], a[144:147], v[176:179], v[64:67]
  v_cvt_pk_bf16_f32 v196, v196, v197
  v_mov_b32 v183, 0
  v_mfma_f32_16x16x32_bf16 v[68:71], a[148:151], v[176:179], v[68:71]
  s_waitcnt vmcnt(20)
  ds_write_b32 v253, v252
  v_mfma_f32_16x16x32_bf16 v[72:75], a[152:155], v[176:179], v[72:75]
  v_cvt_pk_bf16_f32 v218, v218, v219
  v_cvt_pk_bf16_f32 v212, v212, v213
  v_mfma_f32_16x16x32_bf16 v[76:79], a[156:159], v[176:179], v[76:79]
  v_cvt_pk_bf16_f32 v198, v198, v199
  v_cvt_pk_bf16_f32 v214, v214, v215
  v_mfma_f32_16x16x32_bf16 v[80:83], a[160:163], v[176:179], v[80:83]
  v_cvt_pk_bf16_f32 v202, v202, v203
  v_subrev_u32 v249, 0x1c800000, v249
  v_mfma_f32_16x16x32_bf16 v[84:87], a[164:167], v[176:179], v[84:87]
  v_cvt_pk_bf16_f32 v200, v200, v201
  v_accvgpr_write_b32 a39, v202
  v_exp_f32 v171, v171
  v_cmp_lt_u32 s[66:67], s69, v249
  v_pk_mul_f32 v[40:41], v[40:41], v[248:249] op_sel_hi:[1,0]
  v_pk_mul_f32 v[42:43], v[42:43], v[248:249] op_sel_hi:[1,0]
  v_pk_mul_f32 v[56:57], v[56:57], v[248:249] op_sel_hi:[1,0]
  v_pk_mul_f32 v[58:59], v[58:59], v[248:249] op_sel_hi:[1,0]
  v_pk_mul_f32 v[44:45], v[44:45], v[248:249] op_sel_hi:[1,0]
  v_pk_mul_f32 v[46:47], v[46:47], v[248:249] op_sel_hi:[1,0]
  v_pk_mul_f32 v[60:61], v[60:61], v[248:249] op_sel_hi:[1,0]
  v_pk_mul_f32 v[62:63], v[62:63], v[248:249] op_sel_hi:[1,0]
  v_mfma_f32_16x16x32_bf16 v[88:91], a[168:171], v[176:179], v[88:91]
  v_exp_f32 v161, v161
  v_mfma_f32_16x16x32_bf16 v[92:95], a[172:175], v[176:179], v[92:95]
  v_accvgpr_write_b32 a30, v196
  v_cvt_pk_bf16_f32 v40, v40, v41
  v_smfmac_f32_16x16x64_bf16 a[216:219], a[228:231], v[176:183], v254
  s_waitcnt vmcnt(19)
  ds_read_b128 a[48:51], v240 offset:12288
  v_accvgpr_write_b32 a38, v200
  v_mfma_f32_16x16x16_bf16 v[64:67], a[176:177], v[180:181], v[64:67]
  ds_write2st64_b64 v245, v[4:5], v[20:21] offset0:0 offset1:4
  v_pk_mul_f32 v[32:33], v[32:33], v[248:249] op_sel_hi:[1,0]
  v_pk_mul_f32 v[34:35], v[34:35], v[248:249] op_sel_hi:[1,0]
  v_pk_mul_f32 v[48:49], v[48:49], v[248:249] op_sel_hi:[1,0]
  v_pk_mul_f32 v[50:51], v[50:51], v[248:249] op_sel_hi:[1,0]
  v_pk_mul_f32 v[36:37], v[36:37], v[248:249] op_sel_hi:[1,0]
  v_pk_mul_f32 v[38:39], v[38:39], v[248:249] op_sel_hi:[1,0]
  v_pk_mul_f32 v[52:53], v[52:53], v[248:249] op_sel_hi:[1,0]
  v_pk_mul_f32 v[54:55], v[54:55], v[248:249] op_sel_hi:[1,0]
  v_mfma_f32_16x16x16_bf16 v[68:71], a[180:181], v[180:181], v[68:71]
  ds_read_b128 a[52:55], v241 offset:12288
  s_or_b64 s[36:37], s[36:37], s[66:67]
  v_mfma_f32_16x16x16_bf16 v[72:75], a[184:185], v[180:181], v[72:75]
  v_cvt_pk_bf16_f32 v160, v160, v161
  v_exp_f32 v169, v169
  v_mfma_f32_16x16x16_bf16 v[76:79], a[188:189], v[180:181], v[76:79]
  v_exp_f32 v170, v170
  v_mfma_f32_16x16x16_bf16 v[80:83], a[192:193], v[180:181], v[80:83]
  v_accvgpr_write_b32 a37, v214
  v_cvt_pk_bf16_f32 v161, v162, v163
  v_mfma_f32_16x16x16_bf16 v[84:87], a[196:197], v[180:181], v[84:87]
  ds_read_b128 a[56:59], v242 offset:12288
  v_accvgpr_write_b32 a31, v198
  v_mfma_f32_16x16x16_bf16 v[88:91], a[200:201], v[180:181], v[88:91]
  ds_read_b128 a[60:63], v243 offset:12288
  v_accvgpr_write_b32 a36, v212
  v_mfma_f32_16x16x16_bf16 v[92:95], a[204:205], v[180:181], v[92:95]
  ds_read_b32 v251, v250
  v_cvt_pk_bf16_f32 v44, v44, v45
  v_mfma_f32_16x16x16_bf16 v[212:215], a[248:249], a[40:41], 0
  buffer_store_dwordx4 a[244:247], v238, s[24:27], s45 offen offset:3072
  v_mfma_f32_16x16x16_bf16 v[212:215], a[250:251], a[40:41], v[212:215]
  v_cvt_pk_bf16_f32 v162, v164, v165
  v_cvt_pk_bf16_f32 v60, v60, v61
  v_mfma_f32_16x16x16_bf16 v[200:203], a[250:251], a[42:43], 0
  v_accvgpr_write_b32 a212, 0
  v_cvt_pk_bf16_f32 v56, v56, v57
  v_mfma_f32_16x16x16_bf16 v[200:203], a[248:249], a[42:43], v[200:203]
  v_accvgpr_write_b32 a29, v218
  s_waitcnt lgkmcnt(2)
  v_mfma_f32_16x16x16_bf16 v[216:219], a[248:249], a[48:49], 0
  v_accvgpr_read_b32 v249, a216
  v_accvgpr_read_b32 v248, a217
  v_mfma_f32_16x16x16_bf16 v[216:219], a[250:251], a[48:49], v[216:219]
  s_waitcnt lgkmcnt(0)
  v_cmp_gt_u32 vcc, v252, v251
  v_mfma_f32_16x16x16_bf16 v[204:207], a[250:251], a[50:51], 0
  v_cvt_pk_bf16_f32 v48, v48, v49
  v_cvt_pk_bf16_f32 v52, v52, v53
  v_mfma_f32_16x16x16_bf16 v[204:207], a[248:249], a[50:51], v[204:207]
  s_cbranch_vccnz L_SPIN0
  L_BACK0:
  v_cvt_pk_bf16_f32 v212, v212, v213
  v_accvgpr_write_b32 a40, v212
  v_mfma_f32_16x16x32_bf16 v[176:179], a[80:83], a[64:67], v[208:211]
  v_exp_f32 v166, v166
  v_mfma_f32_16x16x32_bf16 v[176:179], a[84:87], a[68:71], v[176:179]
  ds_read_b128 a[232:235], v250 offset:256
  s_add_u32 m0, s30, 65792
  v_mfma_f32_16x16x32_bf16 v[176:179], a[88:91], a[72:75], v[176:179]
  ds_read_b128 a[236:239], v250 offset:320
  v_cvt_pk_bf16_f32 v216, v216, v217
  v_mfma_f32_16x16x32_bf16 v[176:179], a[92:95], a[76:79], v[176:179]
  ds_read_b128 a[80:83], v220 offset:0
  v_cvt_pk_bf16_f32 v214, v214, v215
  v_mfma_f32_16x16x32_bf16 v[180:183], a[108:111], a[76:79], v[208:211]
  buffer_load_dwordx4 v232, s[16:19], s55 offen offset:0 nt lds
  v_mfma_f32_16x16x32_bf16 v[180:183], a[104:107], a[72:75], v[180:183]
  ds_read_b128 a[240:243], v250 offset:384
  v_accvgpr_write_b32 a41, v214
  v_mfma_f32_16x16x32_bf16 v[180:183], a[100:103], a[68:71], v[180:183]
  ds_read_b128 a[244:247], v250 offset:448
  v_cvt_pk_bf16_f32 v218, v218, v219
  v_cvt_pk_bf16_f32 v163, v166, v167
  v_mfma_f32_16x16x32_bf16 v[180:183], a[96:99], a[64:67], v[180:183]
  ds_read_b128 a[84:87], v221 offset:0
  v_cvt_pk_bf16_f32 v164, v168, v169
  v_mfma_f32_16x16x32_bf16 v[184:187], a[112:115], a[64:67], v[208:211]
  ds_read_b128 a[92:95], v223 offset:0
  v_cvt_pk_bf16_f32 v49, v50, v51
  v_mfma_f32_16x16x32_bf16 v[184:187], a[116:119], a[68:71], v[184:187]
  ds_read_b128 a[88:91], v222 offset:0
  v_accvgpr_write_b32 a217, 0
  v_mfma_f32_16x16x32_bf16 v[184:187], a[120:123], a[72:75], v[184:187]
  v_cvt_pk_bf16_f32 v200, v200, v201
  v_cvt_pk_bf16_f32 v202, v202, v203
  v_mfma_f32_16x16x32_bf16 v[184:187], a[124:127], a[76:79], v[184:187]
  v_accvgpr_write_b32 a42, v200
  v_accvgpr_write_b32 a48, v216
  s_waitcnt lgkmcnt(4)
  v_mfma_f32_16x16x32_bf16 v[192:195], a[232:235], a[0:3], 0
  buffer_load_dwordx4 v233, s[16:19], s55 offen offset:1024 nt lds
  v_mfma_f32_16x16x32_bf16 v[192:195], a[236:239], a[4:7], v[192:195]
  ds_read_b128 a[108:111], v223 offset:4096
  v_accvgpr_write_b32 a43, v202
  v_cvt_pk_bf16_f32 v204, v204, v205
  v_accvgpr_write_b32 a50, v204
  v_mfma_f32_16x16x32_bf16 v[192:195], a[240:243], a[8:11], v[192:195]
  ds_read_b128 a[104:107], v222 offset:4096
  v_add_f32 v249, v249, v248
  v_rcp_f32 v248, v249
  s_waitcnt lgkmcnt(3)
  v_mfma_f32_16x16x32_bf16 v[192:195], a[244:247], a[12:15], v[192:195]
  ds_read_b128 a[100:103], v221 offset:4096
  v_exp_f32 v178, v178
  v_mfma_f32_16x16x16_bf16 v[212:215], a[248:249], a[44:45], 0
  v_cvt_pk_bf16_f32 v206, v206, v207
  v_accvgpr_write_b32 a51, v206
  v_mov_b32 v166, 0
  v_mfma_f32_16x16x16_bf16 v[212:215], a[250:251], a[44:45], v[212:215]
  s_add_u32 s24, s10, s38
  s_addc_u32 s25, s11, 0
  v_mfma_f32_16x16x16_bf16 v[200:203], a[250:251], a[46:47], 0
  ds_read_b128 a[112:115], v220 offset:8192
  v_cvt_pk_bf16_f32 v45, v46, v47
  v_mfma_f32_16x16x16_bf16 v[200:203], a[248:249], a[46:47], v[200:203]
  ds_read_b128 a[96:99], v220 offset:4096
  v_accvgpr_write_b32 a49, v218
  v_mfma_f32_16x16x16_bf16 v[216:219], a[248:249], a[52:53], 0
  v_cvt_pk_bf16_f32 v61, v62, v63
  v_subrev_u32 v249, 0x1c800000, v249
  v_mfma_f32_16x16x16_bf16 v[216:219], a[250:251], a[52:53], v[216:219]
  v_exp_f32 v177, v177
  v_mfma_f32_16x16x16_bf16 v[204:207], a[250:251], a[54:55], 0
  v_mov_b32 v167, 0
  v_cvt_pk_bf16_f32 v12, v12, v13
  v_mfma_f32_16x16x16_bf16 v[204:207], a[248:249], a[54:55], v[204:207]
  ds_read_b128 a[116:119], v221 offset:8192
  v_sub_f32 v192, 0xc2800000, v192
  v_exp_f32 v187, v187
  v_mfma_f32_16x16x32_bf16 v[96:99], a[144:147], v[160:163], v[96:99]
  buffer_load_dwordx4 v234, s[16:19], s55 offen offset:2048 nt lds
  v_exp_f32 v180, v180
  v_mfma_f32_16x16x32_bf16 v[100:103], a[148:151], v[160:163], v[100:103]
  ds_read_b128 a[124:127], v223 offset:8192
  v_sub_f32 v194, 0xc2800000, v194
  v_mfma_f32_16x16x32_bf16 v[104:107], a[152:155], v[160:163], v[104:107]
  ds_read_b128 a[120:123], v222 offset:8192
  v_cvt_pk_bf16_f32 v202, v202, v203
  v_mfma_f32_16x16x32_bf16 v[108:111], a[156:159], v[160:163], v[108:111]
  v_sub_f32 v193, 0xc2800000, v193
  v_cmp_lt_u32 s[66:67], s69, v249
  v_mfma_f32_16x16x32_bf16 v[112:115], a[160:163], v[160:163], v[112:115]
  v_cvt_pk_bf16_f32 v204, v204, v205
  v_cvt_pk_bf16_f32 v165, v170, v171
  v_cvt_pk_bf16_f32 v32, v32, v33
  v_mfma_f32_16x16x32_bf16 v[116:119], a[164:167], v[160:163], v[116:119]
  v_add_u32 v252, 1, v252
  v_sub_f32 v195, 0xc2800000, v195
  v_cvt_pk_bf16_f32 v212, v212, v213
  v_mfma_f32_16x16x32_bf16 v[120:123], a[168:171], v[160:163], v[120:123]
  s_waitcnt vmcnt(13)
  ds_read_b128 a[76:79], v243 offset:16384
  v_cvt_pk_bf16_f32 v206, v206, v207
  v_cvt_pk_bf16_f32 v36, v36, v37
  v_mfma_f32_16x16x32_bf16 v[124:127], a[172:175], v[160:163], v[124:127]
  ds_read_b128 a[140:143], v223 offset:12288
  v_accvgpr_write_b32 a208, 0
  v_smfmac_f32_16x16x64_bf16 a[220:223], a[228:231], v[160:167], v254
  v_accvgpr_write_b32 a44, v212
  v_accvgpr_write_b32 a54, v204
  v_mfma_f32_16x16x16_bf16 v[96:99], a[176:177], v[164:165], v[96:99]
  buffer_load_dwordx4 v235, s[16:19], s55 offen offset:3072 nt lds
  s_mov_b32 s26, s49
  v_cvt_pk_bf16_f32 v200, v200, v201
  v_cvt_pk_bf16_f32 v13, v14, v15
  v_pk_mul_f32 v[72:73], v[72:73], v[248:249] op_sel_hi:[1,0]
  v_pk_mul_f32 v[74:75], v[74:75], v[248:249] op_sel_hi:[1,0]
  v_pk_mul_f32 v[88:89], v[88:89], v[248:249] op_sel_hi:[1,0]
  v_pk_mul_f32 v[90:91], v[90:91], v[248:249] op_sel_hi:[1,0]
  v_pk_mul_f32 v[76:77], v[76:77], v[248:249] op_sel_hi:[1,0]
  v_pk_mul_f32 v[78:79], v[78:79], v[248:249] op_sel_hi:[1,0]
  v_pk_mul_f32 v[92:93], v[92:93], v[248:249] op_sel_hi:[1,0]
  v_pk_mul_f32 v[94:95], v[94:95], v[248:249] op_sel_hi:[1,0]
  v_mfma_f32_16x16x16_bf16 v[100:103], a[180:181], v[164:165], v[100:103]
  v_cvt_pk_bf16_f32 v218, v218, v219
  v_accvgpr_write_b32 a55, v206
  v_mfma_f32_16x16x16_bf16 v[104:107], a[184:185], v[164:165], v[104:107]
  ds_read_b128 a[64:67], v240 offset:16384
  v_cvt_pk_bf16_f32 v214, v214, v215
  v_mfma_f32_16x16x16_bf16 v[108:111], a[188:189], v[164:165], v[108:111]
  ds_read_b128 a[132:135], v221 offset:12288
  v_cvt_pk_bf16_f32 v216, v216, v217
  v_mfma_f32_16x16x16_bf16 v[112:115], a[192:193], v[164:165], v[112:115]
  ds_read_b128 a[136:139], v222 offset:12288
  v_cvt_pk_bf16_f32 v53, v54, v55
  v_mfma_f32_16x16x16_bf16 v[116:119], a[196:197], v[164:165], v[116:119]
  v_accvgpr_write_b32 a52, v216
  v_cvt_pk_bf16_f32 v41, v42, v43
  v_mfma_f32_16x16x16_bf16 v[120:123], a[200:201], v[164:165], v[120:123]
  v_exp_f32 v176, v176
  v_mfma_f32_16x16x16_bf16 v[124:127], a[204:205], v[164:165], v[124:127]
  ds_read_b128 a[128:131], v220 offset:12288
  v_accvgpr_write_b32 a53, v218
  v_mfma_f32_16x16x16_bf16 v[216:219], a[248:249], a[56:57], 0
  v_accvgpr_write_b32 a45, v214
  s_or_b64 s[36:37], s[36:37], s[66:67]
  v_mfma_f32_16x16x16_bf16 v[216:219], a[250:251], a[56:57], v[216:219]
  v_exp_f32 v181, v181
  v_mfma_f32_16x16x16_bf16 v[204:207], a[250:251], a[58:59], 0
  ds_write2st64_b64 v247, v[12:13], v[28:29] offset0:0 offset1:4
  v_accvgpr_write_b32 a46, v200
  v_pk_mul_f32 v[64:65], v[64:65], v[248:249] op_sel_hi:[1,0]
  v_pk_mul_f32 v[66:67], v[66:67], v[248:249] op_sel_hi:[1,0]
  v_pk_mul_f32 v[80:81], v[80:81], v[248:249] op_sel_hi:[1,0]
  v_pk_mul_f32 v[82:83], v[82:83], v[248:249] op_sel_hi:[1,0]
  v_pk_mul_f32 v[68:69], v[68:69], v[248:249] op_sel_hi:[1,0]
  v_pk_mul_f32 v[70:71], v[70:71], v[248:249] op_sel_hi:[1,0]
  v_pk_mul_f32 v[84:85], v[84:85], v[248:249] op_sel_hi:[1,0]
  v_pk_mul_f32 v[86:87], v[86:87], v[248:249] op_sel_hi:[1,0]
  v_mfma_f32_16x16x16_bf16 v[204:207], a[248:249], a[58:59], v[204:207]
  v_accvgpr_write_b32 a47, v202
  v_exp_f32 v186, v186
  v_accvgpr_write_b32 a216, 0
  s_waitcnt lgkmcnt(2)
  v_mfma_f32_16x16x16_bf16 v[212:215], a[248:249], a[64:65], 0
  v_cvt_pk_bf16_f32 v80, v80, v81
  v_cvt_pk_bf16_f32 v68, v68, v69
  v_mfma_f32_16x16x16_bf16 v[212:215], a[250:251], a[64:65], v[212:215]
  v_exp_f32 v183, v183
  v_mfma_f32_16x16x16_bf16 v[208:211], a[250:251], a[66:67], 0
  v_exp_f32 v182, v182
  v_mfma_f32_16x16x16_bf16 v[208:211], a[248:249], a[66:67], v[208:211]
  v_cvt_pk_bf16_f32 v218, v218, v219
  v_cvt_pk_bf16_f32 v176, v176, v177
  s_mov_b32 s38, s39
  s_add_u32 s32, s32, 1
  s_branch L_PASS
  L_TAIL:
  v_mfma_f32_16x16x32_bf16 v[176:179], a[80:83], a[0:3], v[192:195]
  v_exp_f32 v169, v169
  v_mfma_f32_16x16x32_bf16 v[176:179], a[84:87], a[4:7], v[176:179]
  v_add_u32 v227, 0x4000, v227
  v_cvt_pk_bf16_f32 v162, v164, v165
  v_mfma_f32_16x16x32_bf16 v[176:179], a[88:91], a[8:11], v[176:179]
  v_exp_f32 v173, v173
  v_mfma_f32_16x16x32_bf16 v[176:179], a[92:95], a[12:15], v[176:179]
  ds_read_b32 v251, v250
  v_mfma_f32_16x16x32_bf16 v[180:183], a[108:111], a[12:15], v[192:195]
  v_exp_f32 v170, v170
  v_mfma_f32_16x16x32_bf16 v[180:183], a[104:107], a[8:11], v[180:183]
  buffer_store_dwordx4 a[240:243], v238, s[24:27], s45 offen offset:2048
  v_mfma_f32_16x16x32_bf16 v[180:183], a[100:103], a[4:7], v[180:183]
  v_cvt_pk_bf16_f32 v163, v166, v167
  v_cvt_pk_bf16_f32 v164, v168, v169
  v_mfma_f32_16x16x32_bf16 v[180:183], a[96:99], a[0:3], v[180:183]
  v_cvt_pk_bf16_f32 v165, v170, v171
  v_cvt_pk_bf16_f32 v166, v172, v173
  v_mfma_f32_16x16x32_bf16 v[184:187], a[112:115], a[0:3], v[192:195]
  v_exp_f32 v175, v175
  v_mfma_f32_16x16x32_bf16 v[184:187], a[116:119], a[4:7], v[184:187]
  s_waitcnt lgkmcnt(0)
  v_cmp_gt_u32 vcc, v252, v251
  v_mfma_f32_16x16x32_bf16 v[184:187], a[120:123], a[8:11], v[184:187]
  v_exp_f32 v176, v176
  v_mfma_f32_16x16x32_bf16 v[184:187], a[124:127], a[12:15], v[184:187]
  v_cvt_pk_bf16_f32 v167, v174, v175
  v_mfma_f32_16x16x32_bf16 v[128:131], a[144:147], v[160:163], v[128:131]
  s_cbranch_vccnz L_SPIN999
  L_BACK999:
  v_mfma_f32_16x16x32_bf16 v[128:131], a[176:179], v[164:167], v[128:131]
  v_exp_f32 v182, v182
  v_mfma_f32_16x16x32_bf16 v[132:135], a[180:183], v[164:167], v[132:135]
  v_exp_f32 v177, v177
  v_mfma_f32_16x16x32_bf16 v[132:135], a[148:151], v[160:163], v[132:135]
  ds_read_b64_tr_b16 a[146:147], v224 offset:53248
  v_cvt_pk_bf16_f32 v176, v176, v177
  v_mfma_f32_16x16x32_bf16 v[136:139], a[152:155], v[160:163], v[136:139]
  v_exp_f32 v179, v179
  v_mfma_f32_16x16x32_bf16 v[136:139], a[184:187], v[164:167], v[136:139]
  buffer_store_dwordx4 a[244:247], v238, s[24:27], s45 offen offset:3072
  v_mfma_f32_16x16x32_bf16 v[140:143], a[188:191], v[164:167], v[140:143]
  v_exp_f32 v183, v183
  v_mfma_f32_16x16x32_bf16 v[140:143], a[156:159], v[160:163], v[140:143]
  v_exp_f32 v178, v178
  s_waitcnt vmcnt(5)
  v_mfma_f32_16x16x32_bf16 v[144:147], a[160:163], v[160:163], v[144:147]
  ds_read_b64_tr_b16 a[152:153], v226 offset:49152
  v_cvt_pk_bf16_f32 v177, v178, v179
  v_mfma_f32_16x16x32_bf16 v[144:147], a[192:195], v[164:167], v[144:147]
  v_exp_f32 v181, v181
  v_mfma_f32_16x16x32_bf16 v[148:151], a[196:199], v[164:167], v[148:151]
  v_exp_f32 v180, v180
  v_mfma_f32_16x16x32_bf16 v[148:151], a[164:167], v[160:163], v[148:151]
  ds_read_b64_tr_b16 a[148:149], v225 offset:49152
  ds_read_b64_tr_b16 a[150:151], v225 offset:53248
  v_mfma_f32_16x16x32_bf16 v[152:155], a[168:171], v[160:163], v[152:155]
  ds_read_b64_tr_b16 a[162:163], v228 offset:53248
  ds_read_b64_tr_b16 a[168:169], v230 offset:49152
  v_mfma_f32_16x16x32_bf16 v[152:155], a[200:203], v[164:167], v[152:155]
  ds_read_b64_tr_b16 a[156:157], v227 offset:49152
  ds_read_b64_tr_b16 a[166:167], v229 offset:53248
  v_mfma_f32_16x16x32_bf16 v[156:159], a[204:207], v[164:167], v[156:159]
  ds_read_b64_tr_b16 a[154:155], v226 offset:53248
  ds_read_b64_tr_b16 a[164:165], v229 offset:49152
  v_mfma_f32_16x16x32_bf16 v[156:159], a[172:175], v[160:163], v[156:159]
  ds_read_b64_tr_b16 a[160:161], v228 offset:49152
  ds_read_b64_tr_b16 a[172:173], v231 offset:49152
  v_smfmac_f32_16x16x64_bf16 a[224:227], a[228:231], v[160:167], v254
  ds_read_b64_tr_b16 a[144:145], v224 offset:49152
  v_mfma_f32_16x16x32_bf16 v[160:163], a[80:83], a[16:19], v[196:199]
  v_exp_f32 v185, v185
  v_mfma_f32_16x16x32_bf16 v[160:163], a[84:87], a[20:23], v[160:163]
  ds_read_b64_tr_b16 a[180:181], v225 offset:57344
  ds_read_b64_tr_b16 a[158:159], v227 offset:53248
  v_mfma_f32_16x16x32_bf16 v[160:163], a[88:91], a[24:27], v[160:163]
  ds_read_b64_tr_b16 a[200:201], v230 offset:57344
  ds_read_b64_tr_b16 a[174:175], v231 offset:53248
  v_mfma_f32_16x16x32_bf16 v[160:163], a[92:95], a[28:31], v[160:163]
  ds_read_b64_tr_b16 a[170:171], v230 offset:53248
  v_cvt_pk_bf16_f32 v178, v180, v181
  v_mfma_f32_16x16x32_bf16 v[164:167], a[108:111], a[28:31], v[196:199]
  v_exp_f32 v184, v184
  v_mfma_f32_16x16x32_bf16 v[164:167], a[104:107], a[24:27], v[164:167]
  s_add_u32 s24, s10, s38
  s_addc_u32 s25, s11, 0
  v_mfma_f32_16x16x32_bf16 v[164:167], a[100:103], a[20:23], v[164:167]
  v_exp_f32 v187, v187
  v_mfma_f32_16x16x32_bf16 v[164:167], a[96:99], a[16:19], v[164:167]
  ds_read_b64_tr_b16 a[184:185], v226 offset:57344
  v_cvt_pk_bf16_f32 v179, v182, v183
  v_mfma_f32_16x16x32_bf16 v[168:171], a[112:115], a[16:19], v[196:199]
  ds_read_b64_tr_b16 a[188:189], v227 offset:57344
  v_mov_b32 v183, 0
  v_mfma_f32_16x16x32_bf16 v[168:171], a[116:119], a[20:23], v[168:171]
  ds_read_b64_tr_b16 a[192:193], v228 offset:57344
  v_mov_b32 v182, 0
  v_mfma_f32_16x16x32_bf16 v[168:171], a[120:123], a[24:27], v[168:171]
  ds_read_b64_tr_b16 a[176:177], v224 offset:57344
  v_mfma_f32_16x16x32_bf16 v[168:171], a[124:127], a[28:31], v[168:171]
  ds_read_b64_tr_b16 a[196:197], v229 offset:57344
  s_waitcnt lgkmcnt(5)
  v_mfma_f32_16x16x32_bf16 v[0:3], a[144:147], v[176:179], v[0:3]
  v_exp_f32 v186, v186
  v_mfma_f32_16x16x32_bf16 v[4:7], a[148:151], v[176:179], v[4:7]
  v_exp_f32 v161, v161
  v_mfma_f32_16x16x32_bf16 v[8:11], a[152:155], v[176:179], v[8:11]
  v_cvt_pk_bf16_f32 v180, v184, v185
  v_cvt_pk_bf16_f32 v181, v186, v187
  v_mfma_f32_16x16x32_bf16 v[12:15], a[156:159], v[176:179], v[12:15]
  v_exp_f32 v162, v162
  v_mfma_f32_16x16x32_bf16 v[16:19], a[160:163], v[176:179], v[16:19]
  v_exp_f32 v164, v164
  v_mfma_f32_16x16x32_bf16 v[20:23], a[164:167], v[176:179], v[20:23]
  v_exp_f32 v160, v160
  v_mfma_f32_16x16x32_bf16 v[24:27], a[168:171], v[176:179], v[24:27]
  v_cvt_pk_bf16_f32 v160, v160, v161
  v_mfma_f32_16x16x32_bf16 v[28:31], a[172:175], v[176:179], v[28:31]
  ds_read_b64_tr_b16 a[204:205], v231 offset:57344
  s_mov_b32 s26, s49
  v_smfmac_f32_16x16x64_bf16 a[208:211], a[228:231], v[176:183], v254
  s_waitcnt lgkmcnt(1)
  v_mfma_f32_16x16x16_bf16 v[0:3], a[176:177], v[180:181], v[0:3]
  v_exp_f32 v170, v170
  v_mfma_f32_16x16x16_bf16 v[4:7], a[180:181], v[180:181], v[4:7]
  v_exp_f32 v165, v165
  v_mfma_f32_16x16x16_bf16 v[8:11], a[184:185], v[180:181], v[8:11]
  v_exp_f32 v169, v169
  v_mfma_f32_16x16x16_bf16 v[12:15], a[188:189], v[180:181], v[12:15]
  v_exp_f32 v168, v168
  v_mfma_f32_16x16x16_bf16 v[16:19], a[192:193], v[180:181], v[16:19]
  v_exp_f32 v163, v163
  v_mfma_f32_16x16x16_bf16 v[20:23], a[196:197], v[180:181], v[20:23]
  v_exp_f32 v166, v166
  v_mfma_f32_16x16x16_bf16 v[24:27], a[200:201], v[180:181], v[24:27]
  v_cvt_pk_bf16_f32 v161, v162, v163
  v_cvt_pk_bf16_f32 v162, v164, v165
  s_waitcnt lgkmcnt(0)
  v_mfma_f32_16x16x16_bf16 v[28:31], a[204:205], v[180:181], v[28:31]
  v_exp_f32 v167, v167
  v_accvgpr_read_b32 v193, a208
  v_accvgpr_read_b32 v194, a209
  v_mfma_f32_16x16x32_bf16 v[176:179], a[80:83], a[32:35], v[200:203]
  v_cvt_pk_bf16_f32 v163, v166, v167
  v_mfma_f32_16x16x32_bf16 v[176:179], a[84:87], a[36:39], v[176:179]
  v_mov_b32 v166, 0
  v_cvt_pk_bf16_f32 v164, v168, v169
  v_mfma_f32_16x16x32_bf16 v[176:179], a[88:91], a[40:43], v[176:179]
  v_exp_f32 v171, v171
  v_mfma_f32_16x16x32_bf16 v[176:179], a[92:95], a[44:47], v[176:179]
  v_mov_b32 v167, 0
  v_add_f32 v193, v193, v194
  v_mfma_f32_16x16x32_bf16 v[180:183], a[108:111], a[44:47], v[200:203]
  v_cvt_pk_bf16_f32 v165, v170, v171
  v_rcp_f32 v192, v193
  v_subrev_u32 v193, 0x1c800000, v193
  v_cmp_lt_u32 s[66:67], s69, v193
  v_pk_mul_f32 v[8:9], v[8:9], v[192:193] op_sel_hi:[1,0]
  v_pk_mul_f32 v[10:11], v[10:11], v[192:193] op_sel_hi:[1,0]
  v_pk_mul_f32 v[24:25], v[24:25], v[192:193] op_sel_hi:[1,0]
  v_pk_mul_f32 v[26:27], v[26:27], v[192:193] op_sel_hi:[1,0]
  v_pk_mul_f32 v[12:13], v[12:13], v[192:193] op_sel_hi:[1,0]
  v_pk_mul_f32 v[14:15], v[14:15], v[192:193] op_sel_hi:[1,0]
  v_pk_mul_f32 v[28:29], v[28:29], v[192:193] op_sel_hi:[1,0]
  v_pk_mul_f32 v[30:31], v[30:31], v[192:193] op_sel_hi:[1,0]
  v_mfma_f32_16x16x32_bf16 v[180:183], a[104:107], a[40:43], v[180:183]
  v_cvt_pk_bf16_f32 v8, v8, v9
  v_cvt_pk_bf16_f32 v24, v24, v25
  v_cvt_pk_bf16_f32 v25, v26, v27
  v_cvt_pk_bf16_f32 v12, v12, v13
  v_mfma_f32_16x16x32_bf16 v[180:183], a[100:103], a[36:39], v[180:183]
  v_cvt_pk_bf16_f32 v9, v10, v11
  v_cvt_pk_bf16_f32 v13, v14, v15
  v_cvt_pk_bf16_f32 v28, v28, v29
  v_cvt_pk_bf16_f32 v29, v30, v31
  v_mfma_f32_16x16x32_bf16 v[180:183], a[96:99], a[32:35], v[180:183]
  ds_write2st64_b64 v246, v[8:9], v[24:25] offset0:0 offset1:4
  v_pk_mul_f32 v[0:1], v[0:1], v[192:193] op_sel_hi:[1,0]
  v_pk_mul_f32 v[2:3], v[2:3], v[192:193] op_sel_hi:[1,0]
  v_pk_mul_f32 v[16:17], v[16:17], v[192:193] op_sel_hi:[1,0]
  v_pk_mul_f32 v[18:19], v[18:19], v[192:193] op_sel_hi:[1,0]
  v_pk_mul_f32 v[4:5], v[4:5], v[192:193] op_sel_hi:[1,0]
  v_pk_mul_f32 v[6:7], v[6:7], v[192:193] op_sel_hi:[1,0]
  v_pk_mul_f32 v[20:21], v[20:21], v[192:193] op_sel_hi:[1,0]
  v_pk_mul_f32 v[22:23], v[22:23], v[192:193] op_sel_hi:[1,0]
  v_mfma_f32_16x16x32_bf16 v[184:187], a[112:115], a[32:35], v[200:203]
  v_cvt_pk_bf16_f32 v0, v0, v1
  v_cvt_pk_bf16_f32 v16, v16, v17
  v_mfma_f32_16x16x32_bf16 v[184:187], a[116:119], a[36:39], v[184:187]
  ds_write2st64_b64 v247, v[12:13], v[28:29] offset0:0 offset1:4
  v_exp_f32 v176, v176
  v_mfma_f32_16x16x32_bf16 v[184:187], a[120:123], a[40:43], v[184:187]
  v_cvt_pk_bf16_f32 v4, v4, v5
  v_cvt_pk_bf16_f32 v20, v20, v21
  v_mfma_f32_16x16x32_bf16 v[184:187], a[124:127], a[44:47], v[184:187]
  v_cvt_pk_bf16_f32 v1, v2, v3
  v_cvt_pk_bf16_f32 v17, v18, v19
  v_mfma_f32_16x16x32_bf16 v[32:35], a[144:147], v[160:163], v[32:35]
  v_cvt_pk_bf16_f32 v5, v6, v7
  v_cvt_pk_bf16_f32 v21, v22, v23
  v_mfma_f32_16x16x32_bf16 v[36:39], a[148:151], v[160:163], v[36:39]
  v_exp_f32 v180, v180
  s_or_b64 s[36:37], s[36:37], s[66:67]
  v_mfma_f32_16x16x32_bf16 v[40:43], a[152:155], v[160:163], v[40:43]
  v_exp_f32 v182, v182
  v_mfma_f32_16x16x32_bf16 v[44:47], a[156:159], v[160:163], v[44:47]
  ds_write2st64_b64 v245, v[4:5], v[20:21] offset0:0 offset1:4
  v_mfma_f32_16x16x32_bf16 v[48:51], a[160:163], v[160:163], v[48:51]
  v_exp_f32 v179, v179
  v_mfma_f32_16x16x32_bf16 v[52:55], a[164:167], v[160:163], v[52:55]
  ds_write2st64_b64 v244, v[0:1], v[16:17] offset0:0 offset1:4
  v_mfma_f32_16x16x32_bf16 v[56:59], a[168:171], v[160:163], v[56:59]
  ds_read_b128 a[0:3], v239 offset:0
  v_exp_f32 v187, v187
  v_mfma_f32_16x16x32_bf16 v[60:63], a[172:175], v[160:163], v[60:63]
  ds_read_b128 a[4:7], v255 offset:512
  v_exp_f32 v184, v184
  v_smfmac_f32_16x16x64_bf16 a[212:215], a[228:231], v[160:167], v254
  ds_read_b128 a[8:11], v239 offset:1024
  v_mfma_f32_16x16x16_bf16 v[32:35], a[176:177], v[164:165], v[32:35]
  v_exp_f32 v185, v185
  v_mfma_f32_16x16x16_bf16 v[36:39], a[180:181], v[164:165], v[36:39]
  v_exp_f32 v183, v183
  v_mfma_f32_16x16x16_bf16 v[40:43], a[184:185], v[164:165], v[40:43]
  v_exp_f32 v178, v178
  v_mfma_f32_16x16x16_bf16 v[44:47], a[188:189], v[164:165], v[44:47]
  s_waitcnt lgkmcnt(2)
  buffer_store_dwordx4 a[0:3], v238, s[24:27], 0 offen offset:0 nt
  v_mfma_f32_16x16x16_bf16 v[48:51], a[192:193], v[164:165], v[48:51]
  s_waitcnt lgkmcnt(1)
  buffer_store_dwordx4 a[4:7], v238, s[24:27], 0 offen offset:1024 nt
  v_mfma_f32_16x16x16_bf16 v[52:55], a[196:197], v[164:165], v[52:55]
  v_exp_f32 v181, v181
  v_mfma_f32_16x16x16_bf16 v[56:59], a[200:201], v[164:165], v[56:59]
  ds_read_b128 a[12:15], v255 offset:1536
  v_accvgpr_read_b32 v197, a212
  v_mfma_f32_16x16x16_bf16 v[60:63], a[204:205], v[164:165], v[60:63]
  s_waitcnt lgkmcnt(1)
  buffer_store_dwordx4 a[8:11], v238, s[24:27], 0 offen offset:2048 nt
  v_mfma_f32_16x16x32_bf16 v[160:163], a[80:83], a[48:51], v[204:207]
  v_exp_f32 v177, v177
  v_accvgpr_read_b32 v198, a213
  v_add_f32 v197, v197, v198
  v_mfma_f32_16x16x32_bf16 v[160:163], a[84:87], a[52:55], v[160:163]
  v_rcp_f32 v196, v197
  v_mfma_f32_16x16x32_bf16 v[160:163], a[88:91], a[56:59], v[160:163]
  v_exp_f32 v186, v186
  v_subrev_u32 v197, 0x1c800000, v197
  v_mfma_f32_16x16x32_bf16 v[160:163], a[92:95], a[60:63], v[160:163]
  v_cvt_pk_bf16_f32 v176, v176, v177
  v_cmp_lt_u32 s[66:67], s69, v197
  v_mfma_f32_16x16x32_bf16 v[164:167], a[108:111], a[60:63], v[204:207]
  s_waitcnt lgkmcnt(0)
  buffer_store_dwordx4 a[12:15], v238, s[24:27], 0 offen offset:3072 nt
  v_cvt_pk_bf16_f32 v177, v178, v179
  v_pk_mul_f32 v[32:33], v[32:33], v[196:197] op_sel_hi:[1,0]
  v_pk_mul_f32 v[34:35], v[34:35], v[196:197] op_sel_hi:[1,0]
  v_pk_mul_f32 v[48:49], v[48:49], v[196:197] op_sel_hi:[1,0]
  v_pk_mul_f32 v[50:51], v[50:51], v[196:197] op_sel_hi:[1,0]
  v_pk_mul_f32 v[36:37], v[36:37], v[196:197] op_sel_hi:[1,0]
  v_pk_mul_f32 v[38:39], v[38:39], v[196:197] op_sel_hi:[1,0]
  v_pk_mul_f32 v[52:53], v[52:53], v[196:197] op_sel_hi:[1,0]
  v_pk_mul_f32 v[54:55], v[54:55], v[196:197] op_sel_hi:[1,0]
  v_mfma_f32_16x16x32_bf16 v[164:167], a[104:107], a[56:59], v[164:167]
  v_cvt_pk_bf16_f32 v178, v180, v181
  v_cvt_pk_bf16_f32 v48, v48, v49
  v_cvt_pk_bf16_f32 v49, v50, v51
  v_mfma_f32_16x16x32_bf16 v[164:167], a[100:103], a[52:55], v[164:167]
  v_cvt_pk_bf16_f32 v32, v32, v33
  v_cvt_pk_bf16_f32 v33, v34, v35
  v_mfma_f32_16x16x32_bf16 v[164:167], a[96:99], a[48:51], v[164:167]
  ds_write2st64_b64 v244, v[32:33], v[48:49] offset0:8 offset1:12
  v_cvt_pk_bf16_f32 v179, v182, v183
  v_pk_mul_f32 v[40:41], v[40:41], v[196:197] op_sel_hi:[1,0]
  v_pk_mul_f32 v[42:43], v[42:43], v[196:197] op_sel_hi:[1,0]
  v_pk_mul_f32 v[56:57], v[56:57], v[196:197] op_sel_hi:[1,0]
  v_pk_mul_f32 v[58:59], v[58:59], v[196:197] op_sel_hi:[1,0]
  v_pk_mul_f32 v[44:45], v[44:45], v[196:197] op_sel_hi:[1,0]
  v_pk_mul_f32 v[46:47], v[46:47], v[196:197] op_sel_hi:[1,0]
  v_pk_mul_f32 v[60:61], v[60:61], v[196:197] op_sel_hi:[1,0]
  v_pk_mul_f32 v[62:63], v[62:63], v[196:197] op_sel_hi:[1,0]
  v_mfma_f32_16x16x32_bf16 v[168:171], a[112:115], a[48:51], v[204:207]
  v_mov_b32 v182, 0
  v_cvt_pk_bf16_f32 v60, v60, v61
  v_mfma_f32_16x16x32_bf16 v[168:171], a[116:119], a[52:55], v[168:171]
  v_cvt_pk_bf16_f32 v36, v36, v37
  v_cvt_pk_bf16_f32 v52, v52, v53
  v_mfma_f32_16x16x32_bf16 v[168:171], a[120:123], a[56:59], v[168:171]
  v_cvt_pk_bf16_f32 v180, v184, v185
  v_cvt_pk_bf16_f32 v40, v40, v41
  v_cvt_pk_bf16_f32 v41, v42, v43
  v_cvt_pk_bf16_f32 v56, v56, v57
  v_mfma_f32_16x16x32_bf16 v[168:171], a[124:127], a[60:63], v[168:171]
  v_cvt_pk_bf16_f32 v57, v58, v59
  v_cvt_pk_bf16_f32 v44, v44, v45
  v_mfma_f32_16x16x32_bf16 v[64:67], a[144:147], v[176:179], v[64:67]
  ds_write2st64_b64 v246, v[40:41], v[56:57] offset0:8 offset1:12
  v_cvt_pk_bf16_f32 v45, v46, v47
  v_mfma_f32_16x16x32_bf16 v[68:71], a[148:151], v[176:179], v[68:71]
  v_exp_f32 v166, v166
  v_mfma_f32_16x16x32_bf16 v[72:75], a[152:155], v[176:179], v[72:75]
  v_cvt_pk_bf16_f32 v181, v186, v187
  v_cvt_pk_bf16_f32 v37, v38, v39
  v_cvt_pk_bf16_f32 v53, v54, v55
  v_cvt_pk_bf16_f32 v61, v62, v63
  v_mfma_f32_16x16x32_bf16 v[76:79], a[156:159], v[176:179], v[76:79]
  ds_write2st64_b64 v245, v[36:37], v[52:53] offset0:8 offset1:12
  v_exp_f32 v164, v164
  v_mfma_f32_16x16x32_bf16 v[80:83], a[160:163], v[176:179], v[80:83]
  ds_write2st64_b64 v247, v[44:45], v[60:61] offset0:8 offset1:12
  v_mfma_f32_16x16x32_bf16 v[84:87], a[164:167], v[176:179], v[84:87]
  ds_read_b128 a[16:19], v239 offset:4096
  v_mov_b32 v183, 0
  v_mfma_f32_16x16x32_bf16 v[88:91], a[168:171], v[176:179], v[88:91]
  ds_read_b128 a[20:23], v255 offset:4608
  s_or_b64 s[36:37], s[36:37], s[66:67]
  v_mfma_f32_16x16x32_bf16 v[92:95], a[172:175], v[176:179], v[92:95]
  v_exp_f32 v168, v168
  v_smfmac_f32_16x16x64_bf16 a[216:219], a[228:231], v[176:183], v254
  ds_read_b128 a[24:27], v239 offset:5120
  v_mfma_f32_16x16x16_bf16 v[64:67], a[176:177], v[180:181], v[64:67]
  v_exp_f32 v160, v160
  v_mfma_f32_16x16x16_bf16 v[68:71], a[180:181], v[180:181], v[68:71]
  ds_read_b128 a[28:31], v255 offset:5632
  v_exp_f32 v161, v161
  v_mfma_f32_16x16x16_bf16 v[72:75], a[184:185], v[180:181], v[72:75]
  s_waitcnt lgkmcnt(3)
  buffer_store_dwordx4 a[16:19], v238, s[24:27], s42 offen offset:0 nt
  v_exp_f32 v162, v162
  v_mfma_f32_16x16x16_bf16 v[76:79], a[188:189], v[180:181], v[76:79]
  s_waitcnt lgkmcnt(2)
  buffer_store_dwordx4 a[20:23], v238, s[24:27], s42 offen offset:1024 nt
  v_exp_f32 v165, v165
  v_mfma_f32_16x16x16_bf16 v[80:83], a[192:193], v[180:181], v[80:83]
  v_cvt_pk_bf16_f32 v160, v160, v161
  v_exp_f32 v163, v163
  v_mfma_f32_16x16x16_bf16 v[84:87], a[196:197], v[180:181], v[84:87]
  v_exp_f32 v171, v171
  v_mfma_f32_16x16x16_bf16 v[88:91], a[200:201], v[180:181], v[88:91]
  v_accvgpr_read_b32 v201, a216
  v_accvgpr_read_b32 v202, a217
  v_add_f32 v201, v201, v202
  v_mfma_f32_16x16x16_bf16 v[92:95], a[204:205], v[180:181], v[92:95]
  v_exp_f32 v167, v167
  v_rcp_f32 v200, v201
  v_mfma_f32_16x16x32_bf16 v[176:179], a[80:83], a[64:67], v[208:211]
  v_cvt_pk_bf16_f32 v161, v162, v163
  v_cvt_pk_bf16_f32 v162, v164, v165
  v_mfma_f32_16x16x32_bf16 v[176:179], a[84:87], a[68:71], v[176:179]
  v_subrev_u32 v201, 0x1c800000, v201
  v_cmp_lt_u32 s[66:67], s69, v201
  v_mfma_f32_16x16x32_bf16 v[176:179], a[88:91], a[72:75], v[176:179]
  s_waitcnt lgkmcnt(0)
  buffer_store_dwordx4 a[24:27], v238, s[24:27], s42 offen offset:2048 nt
  v_mfma_f32_16x16x32_bf16 v[176:179], a[92:95], a[76:79], v[176:179]
  v_exp_f32 v169, v169
  v_mfma_f32_16x16x32_bf16 v[180:183], a[108:111], a[76:79], v[208:211]
  buffer_store_dwordx4 a[28:31], v238, s[24:27], s42 offen offset:3072 nt
  s_or_b64 s[36:37], s[36:37], s[66:67]
  v_pk_mul_f32 v[64:65], v[64:65], v[200:201] op_sel_hi:[1,0]
  v_pk_mul_f32 v[66:67], v[66:67], v[200:201] op_sel_hi:[1,0]
  v_pk_mul_f32 v[80:81], v[80:81], v[200:201] op_sel_hi:[1,0]
  v_pk_mul_f32 v[82:83], v[82:83], v[200:201] op_sel_hi:[1,0]
  v_pk_mul_f32 v[68:69], v[68:69], v[200:201] op_sel_hi:[1,0]
  v_pk_mul_f32 v[70:71], v[70:71], v[200:201] op_sel_hi:[1,0]
  v_pk_mul_f32 v[84:85], v[84:85], v[200:201] op_sel_hi:[1,0]
  v_pk_mul_f32 v[86:87], v[86:87], v[200:201] op_sel_hi:[1,0]
  v_pk_mul_f32 v[72:73], v[72:73], v[200:201] op_sel_hi:[1,0]
  v_pk_mul_f32 v[74:75], v[74:75], v[200:201] op_sel_hi:[1,0]
  v_pk_mul_f32 v[88:89], v[88:89], v[200:201] op_sel_hi:[1,0]
  v_pk_mul_f32 v[90:91], v[90:91], v[200:201] op_sel_hi:[1,0]
  v_pk_mul_f32 v[76:77], v[76:77], v[200:201] op_sel_hi:[1,0]
  v_pk_mul_f32 v[78:79], v[78:79], v[200:201] op_sel_hi:[1,0]
  v_pk_mul_f32 v[92:93], v[92:93], v[200:201] op_sel_hi:[1,0]
  v_pk_mul_f32 v[94:95], v[94:95], v[200:201] op_sel_hi:[1,0]
  v_mfma_f32_16x16x32_bf16 v[180:183], a[104:107], a[72:75], v[180:183]
  v_cvt_pk_bf16_f32 v88, v88, v89
  v_cvt_pk_bf16_f32 v89, v90, v91
  v_mfma_f32_16x16x32_bf16 v[180:183], a[100:103], a[68:71], v[180:183]
  v_cvt_pk_bf16_f32 v163, v166, v167
  v_cvt_pk_bf16_f32 v164, v168, v169
  v_cvt_pk_bf16_f32 v64, v64, v65
  v_cvt_pk_bf16_f32 v72, v72, v73
  v_cvt_pk_bf16_f32 v92, v92, v93
  v_mfma_f32_16x16x32_bf16 v[180:183], a[96:99], a[64:67], v[180:183]
  v_cvt_pk_bf16_f32 v73, v74, v75
  v_cvt_pk_bf16_f32 v93, v94, v95
  v_mfma_f32_16x16x32_bf16 v[184:187], a[112:115], a[64:67], v[208:211]
  v_exp_f32 v179, v179
  v_cvt_pk_bf16_f32 v84, v84, v85
  v_cvt_pk_bf16_f32 v85, v86, v87
  v_mfma_f32_16x16x32_bf16 v[184:187], a[116:119], a[68:71], v[184:187]
  ds_write2st64_b64 v246, v[72:73], v[88:89] offset0:16 offset1:20
  v_cvt_pk_bf16_f32 v65, v66, v67
  v_mfma_f32_16x16x32_bf16 v[184:187], a[120:123], a[72:75], v[184:187]
  v_cvt_pk_bf16_f32 v76, v76, v77
  v_cvt_pk_bf16_f32 v77, v78, v79
  v_mfma_f32_16x16x32_bf16 v[184:187], a[124:127], a[76:79], v[184:187]
  v_exp_f32 v170, v170
  v_mfma_f32_16x16x32_bf16 v[96:99], a[144:147], v[160:163], v[96:99]
  ds_write2st64_b64 v247, v[76:77], v[92:93] offset0:16 offset1:20
  v_exp_f32 v183, v183
  v_cvt_pk_bf16_f32 v80, v80, v81
  v_cvt_pk_bf16_f32 v81, v82, v83
  v_mfma_f32_16x16x32_bf16 v[100:103], a[148:151], v[160:163], v[100:103]
  v_mov_b32 v167, 0
  v_exp_f32 v178, v178
  v_cvt_pk_bf16_f32 v68, v68, v69
  v_mfma_f32_16x16x32_bf16 v[104:107], a[152:155], v[160:163], v[104:107]
  v_exp_f32 v181, v181
  v_cvt_pk_bf16_f32 v69, v70, v71
  v_mfma_f32_16x16x32_bf16 v[108:111], a[156:159], v[160:163], v[108:111]
  v_exp_f32 v182, v182
  v_mfma_f32_16x16x32_bf16 v[112:115], a[160:163], v[160:163], v[112:115]
  v_mov_b32 v166, 0
  v_cvt_pk_bf16_f32 v165, v170, v171
  v_mfma_f32_16x16x32_bf16 v[116:119], a[164:167], v[160:163], v[116:119]
  ds_write2st64_b64 v245, v[68:69], v[84:85] offset0:16 offset1:20
  v_mfma_f32_16x16x32_bf16 v[120:123], a[168:171], v[160:163], v[120:123]
  ds_write2st64_b64 v244, v[64:65], v[80:81] offset0:16 offset1:20
  v_exp_f32 v184, v184
  v_mfma_f32_16x16x32_bf16 v[124:127], a[172:175], v[160:163], v[124:127]
  ds_read_b128 a[32:35], v239 offset:8192
  v_exp_f32 v177, v177
  v_smfmac_f32_16x16x64_bf16 a[220:223], a[228:231], v[160:167], v254
  ds_read_b128 a[36:39], v255 offset:8704
  v_mfma_f32_16x16x16_bf16 v[96:99], a[176:177], v[164:165], v[96:99]
  v_exp_f32 v176, v176
  v_mfma_f32_16x16x16_bf16 v[100:103], a[180:181], v[164:165], v[100:103]
  ds_read_b128 a[40:43], v239 offset:9216
  v_cvt_pk_bf16_f32 v176, v176, v177
  v_mfma_f32_16x16x16_bf16 v[104:107], a[184:185], v[164:165], v[104:107]
  ds_read_b128 a[44:47], v255 offset:9728
  v_exp_f32 v187, v187
  v_mfma_f32_16x16x16_bf16 v[108:111], a[188:189], v[164:165], v[108:111]
  v_cvt_pk_bf16_f32 v177, v178, v179
  v_exp_f32 v185, v185
  v_exp_f32 v186, v186
  v_mfma_f32_16x16x16_bf16 v[112:115], a[192:193], v[164:165], v[112:115]
  s_waitcnt lgkmcnt(3)
  buffer_store_dwordx4 a[32:35], v238, s[24:27], s43 offen offset:0 nt
  v_mfma_f32_16x16x16_bf16 v[116:119], a[196:197], v[164:165], v[116:119]
  s_waitcnt lgkmcnt(2)
  buffer_store_dwordx4 a[36:39], v238, s[24:27], s43 offen offset:1024 nt
  v_exp_f32 v180, v180
  v_mfma_f32_16x16x16_bf16 v[120:123], a[200:201], v[164:165], v[120:123]
  v_cvt_pk_bf16_f32 v178, v180, v181
  v_cvt_pk_bf16_f32 v179, v182, v183
  v_mfma_f32_16x16x16_bf16 v[124:127], a[204:205], v[164:165], v[124:127]
  v_mov_b32 v183, 0
  v_accvgpr_read_b32 v205, a220
  v_accvgpr_read_b32 v206, a221
  v_add_f32 v205, v205, v206
  v_mfma_f32_16x16x32_bf16 v[128:131], a[144:147], v[176:179], v[128:131]
  v_rcp_f32 v204, v205
  v_mfma_f32_16x16x32_bf16 v[132:135], a[148:151], v[176:179], v[132:135]
  v_subrev_u32 v205, 0x1c800000, v205
  v_cmp_lt_u32 s[66:67], s69, v205
  v_mfma_f32_16x16x32_bf16 v[136:139], a[152:155], v[176:179], v[136:139]
  s_waitcnt lgkmcnt(0)
  buffer_store_dwordx4 a[40:43], v238, s[24:27], s43 offen offset:2048 nt
  v_mfma_f32_16x16x32_bf16 v[140:143], a[156:159], v[176:179], v[140:143]
  v_cvt_pk_bf16_f32 v180, v184, v185
  v_cvt_pk_bf16_f32 v181, v186, v187
  v_mfma_f32_16x16x32_bf16 v[144:147], a[160:163], v[176:179], v[144:147]
  buffer_store_dwordx4 a[44:47], v238, s[24:27], s43 offen offset:3072 nt
  v_mov_b32 v182, 0
  v_pk_mul_f32 v[104:105], v[104:105], v[204:205] op_sel_hi:[1,0]
  v_pk_mul_f32 v[106:107], v[106:107], v[204:205] op_sel_hi:[1,0]
  v_pk_mul_f32 v[120:121], v[120:121], v[204:205] op_sel_hi:[1,0]
  v_pk_mul_f32 v[122:123], v[122:123], v[204:205] op_sel_hi:[1,0]
  v_pk_mul_f32 v[108:109], v[108:109], v[204:205] op_sel_hi:[1,0]
  v_pk_mul_f32 v[110:111], v[110:111], v[204:205] op_sel_hi:[1,0]
  v_pk_mul_f32 v[124:125], v[124:125], v[204:205] op_sel_hi:[1,0]
  v_pk_mul_f32 v[126:127], v[126:127], v[204:205] op_sel_hi:[1,0]
  v_mfma_f32_16x16x32_bf16 v[148:151], a[164:167], v[176:179], v[148:151]
  v_cvt_pk_bf16_f32 v104, v104, v105
  v_cvt_pk_bf16_f32 v105, v106, v107
  v_cvt_pk_bf16_f32 v120, v120, v121
  v_cvt_pk_bf16_f32 v121, v122, v123
  v_mfma_f32_16x16x32_bf16 v[152:155], a[168:171], v[176:179], v[152:155]
  ds_write2st64_b64 v246, v[104:105], v[120:121] offset0:24 offset1:28
  v_pk_mul_f32 v[96:97], v[96:97], v[204:205] op_sel_hi:[1,0]
  v_pk_mul_f32 v[98:99], v[98:99], v[204:205] op_sel_hi:[1,0]
  v_pk_mul_f32 v[112:113], v[112:113], v[204:205] op_sel_hi:[1,0]
  v_pk_mul_f32 v[114:115], v[114:115], v[204:205] op_sel_hi:[1,0]
  v_pk_mul_f32 v[100:101], v[100:101], v[204:205] op_sel_hi:[1,0]
  v_pk_mul_f32 v[102:103], v[102:103], v[204:205] op_sel_hi:[1,0]
  v_pk_mul_f32 v[116:117], v[116:117], v[204:205] op_sel_hi:[1,0]
  v_pk_mul_f32 v[118:119], v[118:119], v[204:205] op_sel_hi:[1,0]
  v_mfma_f32_16x16x32_bf16 v[156:159], a[172:175], v[176:179], v[156:159]
  v_cvt_pk_bf16_f32 v116, v116, v117
  v_cvt_pk_bf16_f32 v117, v118, v119
  v_smfmac_f32_16x16x64_bf16 a[224:227], a[228:231], v[176:183], v254
  v_cvt_pk_bf16_f32 v96, v96, v97
  v_cvt_pk_bf16_f32 v112, v112, v113
  v_cvt_pk_bf16_f32 v113, v114, v115
  v_cvt_pk_bf16_f32 v108, v108, v109
  v_cvt_pk_bf16_f32 v109, v110, v111
  v_mfma_f32_16x16x16_bf16 v[128:131], a[176:177], v[180:181], v[128:131]
  v_cvt_pk_bf16_f32 v97, v98, v99
  v_cvt_pk_bf16_f32 v100, v100, v101
  v_cvt_pk_bf16_f32 v124, v124, v125
  v_cvt_pk_bf16_f32 v125, v126, v127
  v_mfma_f32_16x16x16_bf16 v[132:135], a[180:181], v[180:181], v[132:135]
  s_or_b64 s[36:37], s[36:37], s[66:67]
  v_cvt_pk_bf16_f32 v101, v102, v103
  v_mfma_f32_16x16x16_bf16 v[136:139], a[184:185], v[180:181], v[136:139]
  ds_write2st64_b64 v244, v[96:97], v[112:113] offset0:24 offset1:28
  v_mfma_f32_16x16x16_bf16 v[140:143], a[188:189], v[180:181], v[140:143]
  ds_write2st64_b64 v245, v[100:101], v[116:117] offset0:24 offset1:28
  v_mfma_f32_16x16x16_bf16 v[144:147], a[192:193], v[180:181], v[144:147]
  ds_write2st64_b64 v247, v[108:109], v[124:125] offset0:24 offset1:28
  v_mfma_f32_16x16x16_bf16 v[148:151], a[196:197], v[180:181], v[148:151]
  ds_read_b128 a[48:51], v239 offset:12288
  ds_read_b128 a[52:55], v255 offset:12800
  v_mfma_f32_16x16x16_bf16 v[152:155], a[200:201], v[180:181], v[152:155]
  ds_read_b128 a[56:59], v239 offset:13312
  v_accvgpr_read_b32 v209, a224
  v_accvgpr_read_b32 v210, a225
  v_mfma_f32_16x16x16_bf16 v[156:159], a[204:205], v[180:181], v[156:159]
  ds_read_b128 a[60:63], v255 offset:13824
  v_add_f32 v209, v209, v210
  v_rcp_f32 v208, v209
  v_subrev_u32 v209, 0x1c800000, v209
  v_cmp_lt_u32 s[66:67], s69, v209
  s_nop 0
  s_or_b64 s[36:37], s[36:37], s[66:67]
  v_pk_mul_f32 v[128:129], v[128:129], v[208:209] op_sel_hi:[1,0]
  v_pk_mul_f32 v[130:131], v[130:131], v[208:209] op_sel_hi:[1,0]
  v_pk_mul_f32 v[144:145], v[144:145], v[208:209] op_sel_hi:[1,0]
  v_pk_mul_f32 v[146:147], v[146:147], v[208:209] op_sel_hi:[1,0]
  v_pk_mul_f32 v[132:133], v[132:133], v[208:209] op_sel_hi:[1,0]
  v_pk_mul_f32 v[134:135], v[134:135], v[208:209] op_sel_hi:[1,0]
  v_pk_mul_f32 v[148:149], v[148:149], v[208:209] op_sel_hi:[1,0]
  v_pk_mul_f32 v[150:151], v[150:151], v[208:209] op_sel_hi:[1,0]
  v_cvt_pk_bf16_f32 v128, v128, v129
  s_waitcnt lgkmcnt(3)
  buffer_store_dwordx4 a[48:51], v238, s[24:27], s44 offen offset:0 nt
  s_waitcnt lgkmcnt(2)
  buffer_store_dwordx4 a[52:55], v238, s[24:27], s44 offen offset:1024 nt
  s_waitcnt lgkmcnt(1)
  buffer_store_dwordx4 a[56:59], v238, s[24:27], s44 offen offset:2048 nt
  s_waitcnt lgkmcnt(0)
  buffer_store_dwordx4 a[60:63], v238, s[24:27], s44 offen offset:3072 nt
  v_cvt_pk_bf16_f32 v129, v130, v131
  v_cvt_pk_bf16_f32 v144, v144, v145
  v_cvt_pk_bf16_f32 v145, v146, v147
  ds_write2st64_b64 v244, v[128:129], v[144:145] offset0:32 offset1:36
  v_cvt_pk_bf16_f32 v132, v132, v133
  v_cvt_pk_bf16_f32 v133, v134, v135
  v_cvt_pk_bf16_f32 v148, v148, v149
  v_cvt_pk_bf16_f32 v149, v150, v151
  ds_write2st64_b64 v245, v[132:133], v[148:149] offset0:32 offset1:36
  v_pk_mul_f32 v[136:137], v[136:137], v[208:209] op_sel_hi:[1,0]
  v_pk_mul_f32 v[138:139], v[138:139], v[208:209] op_sel_hi:[1,0]
  v_pk_mul_f32 v[152:153], v[152:153], v[208:209] op_sel_hi:[1,0]
  v_pk_mul_f32 v[154:155], v[154:155], v[208:209] op_sel_hi:[1,0]
  v_pk_mul_f32 v[140:141], v[140:141], v[208:209] op_sel_hi:[1,0]
  v_pk_mul_f32 v[142:143], v[142:143], v[208:209] op_sel_hi:[1,0]
  v_pk_mul_f32 v[156:157], v[156:157], v[208:209] op_sel_hi:[1,0]
  v_pk_mul_f32 v[158:159], v[158:159], v[208:209] op_sel_hi:[1,0]
  v_cvt_pk_bf16_f32 v136, v136, v137
  v_cvt_pk_bf16_f32 v137, v138, v139
  v_cvt_pk_bf16_f32 v152, v152, v153
  v_cvt_pk_bf16_f32 v153, v154, v155
  ds_write2st64_b64 v246, v[136:137], v[152:153] offset0:32 offset1:36
  v_cvt_pk_bf16_f32 v140, v140, v141
  v_cvt_pk_bf16_f32 v141, v142, v143
  v_cvt_pk_bf16_f32 v156, v156, v157
  v_cvt_pk_bf16_f32 v157, v158, v159
  ds_write2st64_b64 v247, v[140:141], v[156:157] offset0:32 offset1:36
  ds_read_b128 a[64:67], v239 offset:16384
  ds_read_b128 a[68:71], v255 offset:16896
  ds_read_b128 a[72:75], v239 offset:17408
  ds_read_b128 a[76:79], v255 offset:17920
  s_waitcnt lgkmcnt(3)
  buffer_store_dwordx4 a[64:67], v238, s[24:27], s45 offen offset:0 nt
  s_waitcnt lgkmcnt(2)
  buffer_store_dwordx4 a[68:71], v238, s[24:27], s45 offen offset:1024 nt
  s_waitcnt lgkmcnt(1)
  buffer_store_dwordx4 a[72:75], v238, s[24:27], s45 offen offset:2048 nt
  s_waitcnt lgkmcnt(0)
  buffer_store_dwordx4 a[76:79], v238, s[24:27], s45 offen offset:3072 nt
  s_cmp_lg_u64 s[36:37], 0
  s_cselect_b32 s46, 16, 0
  s_or_b32 s35, s35, s46

L_SLOW:
  s_bfe_u32 s35, s35, 0x40001
  s_cmp_eq_u32 s35, 0
  s_cbranch_scc1 L_END
  s_waitcnt vmcnt(0) lgkmcnt(0)
  s_sub_u32 s6, s6, s30
  s_subb_u32 s7, s7, 0
  s_sub_u32 s8, s8, s30
  s_subb_u32 s9, s9, 0
  v_mbcnt_lo_u32_b32 v151, -1, 0
  v_mbcnt_hi_u32_b32 v151, -1, v151
  v_lshrrev_b32 v150, 4, v151
  v_and_b32 v152, 15, v151
  v_lshlrev_b32 v153, 4, v150
  v_lshl_add_u32 v100, v152, 8, v153
  v_and_b32 v153, 1, v150
  v_lshlrev_b32 v238, 5, v153
  v_lshrrev_b32 v153, 1, v150
  v_lshl_add_u32 v238, v153, 4, v238
  v_lshl_add_u32 v238, v152, 8, v238
  v_mov_b32 v101, v236
  v_mov_b32 v102, v237
  s_sub_u32 s46, s31, 16640
  v_mov_b32 v153, s46
  v_add_u32 v104, v153, v224
  v_add_u32 v105, v153, v225
  v_add_u32 v106, v153, v226
  v_add_u32 v107, v153, v227
  v_add_u32 v108, v153, v228
  v_add_u32 v109, v153, v229
  v_add_u32 v110, v153, v230
  v_add_u32 v111, v153, v231

  v_mov_b32 v112, 0x3f803f80
  v_mov_b32 v113, 0x3f803f80
  s_mov_b32 s38, s41
  s_mov_b32 s14, s49
  s_mov_b32 s18, 159744
  s_mov_b32 s22, 159744
  s_mov_b32 s26, s49
  s_mov_b32 m0, s31
L_SP:
  s_and_b32 s46, s35, 1
  s_cmp_eq_u32 s46, 0
  s_cbranch_scc1 L_SP_NEXT
  s_add_u32 s12, s4, s38
  s_addc_u32 s13, s5, 0
  s_add_u32 s16, s6, s38
  s_addc_u32 s17, s7, 0
  s_add_u32 s20, s8, s38
  s_addc_u32 s21, s9, 0
  s_add_u32 s24, s10, s38
  s_addc_u32 s25, s11, 0
  s_mov_b32 s51, 0
L_SQ:
  s_mov_b32 s46, s51
  buffer_load_dwordx4 v[0:3], v100, s[12:15], s46 offen offset:0
  buffer_load_dwordx4 v[4:7], v100, s[12:15], s46 offen offset:64
  buffer_load_dwordx4 v[8:11], v100, s[12:15], s46 offen offset:128
  buffer_load_dwordx4 v[12:15], v100, s[12:15], s46 offen offset:192

  v_mov_b32 v76, 0xff800000
  s_mov_b32 s52, 0
L_SA:
  buffer_load_dwordx4 v[16:19], v100, s[16:19], s52 offen offset:0
  buffer_load_dwordx4 v[20:23], v100, s[16:19], s52 offen offset:64
  buffer_load_dwordx4 v[24:27], v100, s[16:19], s52 offen offset:128
  buffer_load_dwordx4 v[28:31], v100, s[16:19], s52 offen offset:192
  s_waitcnt vmcnt(0)
  v_mfma_f32_16x16x32_bf16 v[32:35], v[16:19], v[0:3], 0
  v_mfma_f32_16x16x32_bf16 v[32:35], v[20:23], v[4:7], v[32:35]
  v_mfma_f32_16x16x32_bf16 v[32:35], v[24:27], v[8:11], v[32:35]
  v_mfma_f32_16x16x32_bf16 v[32:35], v[28:31], v[12:15], v[32:35]
  s_nop 7
  s_nop 1
  v_max3_f32 v76, v76, v32, v33
  v_max3_f32 v76, v76, v34, v35
  s_add_u32 s52, s52, 4096
  s_cmp_lt_u32 s52, 159744
  s_cbranch_scc1 L_SA
  v_mov_b32 v77, v76
  s_nop 1
  v_permlane16_swap_b32 v76, v77
  v_max_f32 v76, v76, v77
  v_mov_b32 v77, v76
  s_nop 1
  v_permlane32_swap_b32 v76, v77
  v_max_f32 v76, v76, v77
  v_mov_b32 v40, 0
  v_mov_b32 v41, 0
  v_mov_b32 v42, 0
  v_mov_b32 v43, 0
  v_mov_b32 v44, 0
  v_mov_b32 v45, 0
  v_mov_b32 v46, 0
  v_mov_b32 v47, 0
  v_mov_b32 v48, 0
  v_mov_b32 v49, 0
  v_mov_b32 v50, 0
  v_mov_b32 v51, 0
  v_mov_b32 v52, 0
  v_mov_b32 v53, 0
  v_mov_b32 v54, 0
  v_mov_b32 v55, 0
  v_mov_b32 v56, 0
  v_mov_b32 v57, 0
  v_mov_b32 v58, 0
  v_mov_b32 v59, 0
  v_mov_b32 v60, 0
  v_mov_b32 v61, 0
  v_mov_b32 v62, 0
  v_mov_b32 v63, 0
  v_mov_b32 v64, 0
  v_mov_b32 v65, 0
  v_mov_b32 v66, 0
  v_mov_b32 v67, 0
  v_mov_b32 v68, 0
  v_mov_b32 v69, 0
  v_mov_b32 v70, 0
  v_mov_b32 v71, 0
  v_mov_b32 v72, 0
  v_mov_b32 v73, 0
  v_mov_b32 v74, 0
  v_mov_b32 v75, 0

  s_mov_b32 s52, 0
L_SB:
  buffer_load_dwordx4 v[16:19], v100, s[16:19], s52 offen offset:0
  buffer_load_dwordx4 v[20:23], v100, s[16:19], s52 offen offset:64
  buffer_load_dwordx4 v[24:27], v100, s[16:19], s52 offen offset:128
  buffer_load_dwordx4 v[28:31], v100, s[16:19], s52 offen offset:192
  buffer_load_dwordx4 v101, s[20:23], s52 offen lds
  buffer_load_dwordx4 v102, s[20:23], s52 offen offset:1024 lds
  buffer_load_dwordx4 v101, s[20:23], s52 offen offset:2048 lds
  buffer_load_dwordx4 v102, s[20:23], s52 offen offset:3072 lds
  s_waitcnt vmcnt(0)
  ds_read_b64_tr_b16 v[80:81], v104
  ds_read_b64_tr_b16 v[82:83], v105
  ds_read_b64_tr_b16 v[84:85], v106
  ds_read_b64_tr_b16 v[86:87], v107
  ds_read_b64_tr_b16 v[88:89], v108
  ds_read_b64_tr_b16 v[90:91], v109
  ds_read_b64_tr_b16 v[92:93], v110
  ds_read_b64_tr_b16 v[94:95], v111
  v_mfma_f32_16x16x32_bf16 v[32:35], v[16:19], v[0:3], 0
  v_mfma_f32_16x16x32_bf16 v[32:35], v[20:23], v[4:7], v[32:35]
  v_mfma_f32_16x16x32_bf16 v[32:35], v[24:27], v[8:11], v[32:35]
  v_mfma_f32_16x16x32_bf16 v[32:35], v[28:31], v[12:15], v[32:35]
  s_nop 7
  s_nop 1
  v_sub_f32 v32, v32, v76
  v_mul_f32 v32, s33, v32
  v_sub_f32 v33, v33, v76
  v_mul_f32 v33, s33, v33
  v_sub_f32 v34, v34, v76
  v_mul_f32 v34, s33, v34
  v_sub_f32 v35, v35, v76
  v_mul_f32 v35, s33, v35
  v_exp_f32 v32, v32
  v_exp_f32 v33, v33
  v_exp_f32 v34, v34
  v_exp_f32 v35, v35
  s_nop 0
  v_cvt_pk_bf16_f32 v36, v32, v33
  v_cvt_pk_bf16_f32 v37, v34, v35
  s_waitcnt lgkmcnt(0)
  s_nop 1
  v_mfma_f32_16x16x16_bf16 v[40:43], v[80:81], v[36:37], v[40:43]
  v_mfma_f32_16x16x16_bf16 v[44:47], v[82:83], v[36:37], v[44:47]
  v_mfma_f32_16x16x16_bf16 v[48:51], v[84:85], v[36:37], v[48:51]
  v_mfma_f32_16x16x16_bf16 v[52:55], v[86:87], v[36:37], v[52:55]
  v_mfma_f32_16x16x16_bf16 v[56:59], v[88:89], v[36:37], v[56:59]
  v_mfma_f32_16x16x16_bf16 v[60:63], v[90:91], v[36:37], v[60:63]
  v_mfma_f32_16x16x16_bf16 v[64:67], v[92:93], v[36:37], v[64:67]
  v_mfma_f32_16x16x16_bf16 v[68:71], v[94:95], v[36:37], v[68:71]
  v_mfma_f32_16x16x16_bf16 v[72:75], v[112:113], v[36:37], v[72:75]
  s_add_u32 s52, s52, 4096
  s_cmp_lt_u32 s52, 159744
  s_cbranch_scc1 L_SB
  s_nop 7
  s_nop 1
  v_rcp_f32 v76, v72
  s_nop 0
  v_mul_f32 v40, v40, v76
  v_mul_f32 v41, v41, v76
  v_mul_f32 v42, v42, v76
  v_mul_f32 v43, v43, v76
  v_mul_f32 v44, v44, v76
  v_mul_f32 v45, v45, v76
  v_mul_f32 v46, v46, v76
  v_mul_f32 v47, v47, v76
  v_cvt_pk_bf16_f32 v40, v40, v41
  v_cvt_pk_bf16_f32 v41, v42, v43
  v_cvt_pk_bf16_f32 v42, v44, v45
  v_cvt_pk_bf16_f32 v43, v46, v47
  s_nop 1
  v_permlane16_swap_b32 v40, v42
  v_permlane16_swap_b32 v41, v43
  buffer_store_dwordx4 v[40:43], v238, s[24:27], s51 offen offset:0
  v_mul_f32 v48, v48, v76
  v_mul_f32 v49, v49, v76
  v_mul_f32 v50, v50, v76
  v_mul_f32 v51, v51, v76
  v_mul_f32 v52, v52, v76
  v_mul_f32 v53, v53, v76
  v_mul_f32 v54, v54, v76
  v_mul_f32 v55, v55, v76
  v_cvt_pk_bf16_f32 v48, v48, v49
  v_cvt_pk_bf16_f32 v49, v50, v51
  v_cvt_pk_bf16_f32 v50, v52, v53
  v_cvt_pk_bf16_f32 v51, v54, v55
  s_nop 1
  v_permlane16_swap_b32 v48, v50
  v_permlane16_swap_b32 v49, v51
  buffer_store_dwordx4 v[48:51], v238, s[24:27], s51 offen offset:64
  v_mul_f32 v56, v56, v76
  v_mul_f32 v57, v57, v76
  v_mul_f32 v58, v58, v76
  v_mul_f32 v59, v59, v76
  v_mul_f32 v60, v60, v76
  v_mul_f32 v61, v61, v76
  v_mul_f32 v62, v62, v76
  v_mul_f32 v63, v63, v76
  v_cvt_pk_bf16_f32 v56, v56, v57
  v_cvt_pk_bf16_f32 v57, v58, v59
  v_cvt_pk_bf16_f32 v58, v60, v61
  v_cvt_pk_bf16_f32 v59, v62, v63
  s_nop 1
  v_permlane16_swap_b32 v56, v58
  v_permlane16_swap_b32 v57, v59
  buffer_store_dwordx4 v[56:59], v238, s[24:27], s51 offen offset:128
  v_mul_f32 v64, v64, v76
  v_mul_f32 v65, v65, v76
  v_mul_f32 v66, v66, v76
  v_mul_f32 v67, v67, v76
  v_mul_f32 v68, v68, v76
  v_mul_f32 v69, v69, v76
  v_mul_f32 v70, v70, v76
  v_mul_f32 v71, v71, v76
  v_cvt_pk_bf16_f32 v64, v64, v65
  v_cvt_pk_bf16_f32 v65, v66, v67
  v_cvt_pk_bf16_f32 v66, v68, v69
  v_cvt_pk_bf16_f32 v67, v70, v71
  s_nop 1
  v_permlane16_swap_b32 v64, v66
  v_permlane16_swap_b32 v65, v67
  buffer_store_dwordx4 v[64:67], v238, s[24:27], s51 offen offset:192
  s_waitcnt vmcnt(0)
  s_add_u32 s51, s51, 4096
  s_cmp_lt_u32 s51, 20480
  s_cbranch_scc1 L_SQ
L_SP_NEXT:
  s_add_u32 s38, s38, 20447232
  s_lshr_b32 s35, s35, 1
  s_cmp_lg_u32 s35, 0
  s_cbranch_scc1 L_SP
L_END:
  s_endpgm
L_SPIN0:
  ds_read_b32 v251, v250
  s_waitcnt lgkmcnt(0)
  v_cmp_gt_u32 vcc, v252, v251
  s_cmp_eq_u32 s68, 0
  s_cbranch_scc1 L_BACK0
  s_sub_u32 s68, s68, 1
  s_nop 2
  s_cbranch_vccnz L_SPIN0
  s_branch L_BACK0
L_SPIN1:
  ds_read_b32 v251, v250
  s_waitcnt lgkmcnt(0)
  v_cmp_gt_u32 vcc, v252, v251
  s_cmp_eq_u32 s68, 0
  s_cbranch_scc1 L_BACK1
  s_sub_u32 s68, s68, 1
  s_nop 2
  s_cbranch_vccnz L_SPIN1
  s_branch L_BACK1
L_SPIN2:
  ds_read_b32 v251, v250
  s_waitcnt lgkmcnt(0)
  v_cmp_gt_u32 vcc, v252, v251
  s_cmp_eq_u32 s68, 0
  s_cbranch_scc1 L_BACK2
  s_sub_u32 s68, s68, 1
  s_nop 2
  s_cbranch_vccnz L_SPIN2
  s_branch L_BACK2
L_SPIN3:
  ds_read_b32 v251, v250
  s_waitcnt lgkmcnt(0)
  v_cmp_gt_u32 vcc, v252, v251
  s_cmp_eq_u32 s68, 0
  s_cbranch_scc1 L_BACK3
  s_sub_u32 s68, s68, 1
  s_nop 2
  s_cbranch_vccnz L_SPIN3
  s_branch L_BACK3
L_SPIN4:
  ds_read_b32 v251, v250
  s_waitcnt lgkmcnt(0)
  v_cmp_gt_u32 vcc, v252, v251
  s_cmp_eq_u32 s68, 0
  s_cbranch_scc1 L_BACK4
  s_sub_u32 s68, s68, 1
  s_nop 2
  s_cbranch_vccnz L_SPIN4
  s_branch L_BACK4
L_SPIN5:
  ds_read_b32 v251, v250
  s_waitcnt lgkmcnt(0)
  v_cmp_gt_u32 vcc, v252, v251
  s_cmp_eq_u32 s68, 0
  s_cbranch_scc1 L_BACK5
  s_sub_u32 s68, s68, 1
  s_nop 2
  s_cbranch_vccnz L_SPIN5
  s_branch L_BACK5
L_SPIN6:
  ds_read_b32 v251, v250
  s_waitcnt lgkmcnt(0)
  v_cmp_gt_u32 vcc, v252, v251
  s_cmp_eq_u32 s68, 0
  s_cbranch_scc1 L_BACK6
  s_sub_u32 s68, s68, 1
  s_nop 2
  s_cbranch_vccnz L_SPIN6
  s_branch L_BACK6
L_SPIN7:
  ds_read_b32 v251, v250
  s_waitcnt lgkmcnt(0)
  v_cmp_gt_u32 vcc, v252, v251
  s_cmp_eq_u32 s68, 0
  s_cbranch_scc1 L_BACK7
  s_sub_u32 s68, s68, 1
  s_nop 2
  s_cbranch_vccnz L_SPIN7
  s_branch L_BACK7
L_SPIN8:
  ds_read_b32 v251, v250
  s_waitcnt lgkmcnt(0)
  v_cmp_gt_u32 vcc, v252, v251
  s_cmp_eq_u32 s68, 0
  s_cbranch_scc1 L_BACK8
  s_sub_u32 s68, s68, 1
  s_nop 2
  s_cbranch_vccnz L_SPIN8
  s_branch L_BACK8
L_SPIN9:
  ds_read_b32 v251, v250
  s_waitcnt lgkmcnt(0)
  v_cmp_gt_u32 vcc, v252, v251
  s_cmp_eq_u32 s68, 0
  s_cbranch_scc1 L_BACK9
  s_sub_u32 s68, s68, 1
  s_nop 2
  s_cbranch_vccnz L_SPIN9
  s_branch L_BACK9
L_SPIN10:
  ds_read_b32 v251, v250
  s_waitcnt lgkmcnt(0)
  v_cmp_gt_u32 vcc, v252, v251
  s_cmp_eq_u32 s68, 0
  s_cbranch_scc1 L_BACK10
  s_sub_u32 s68, s68, 1
  s_nop 2
  s_cbranch_vccnz L_SPIN10
  s_branch L_BACK10
L_SPIN11:
  ds_read_b32 v251, v250
  s_waitcnt lgkmcnt(0)
  v_cmp_gt_u32 vcc, v252, v251
  s_cmp_eq_u32 s68, 0
  s_cbranch_scc1 L_BACK11
  s_sub_u32 s68, s68, 1
  s_nop 2
  s_cbranch_vccnz L_SPIN11
  s_branch L_BACK11
L_SPIN12:
  ds_read_b32 v251, v250
  s_waitcnt lgkmcnt(0)
  v_cmp_gt_u32 vcc, v252, v251
  s_cmp_eq_u32 s68, 0
  s_cbranch_scc1 L_BACK12
  s_sub_u32 s68, s68, 1
  s_nop 2
  s_cbranch_vccnz L_SPIN12
  s_branch L_BACK12
L_SPIN13:
  ds_read_b32 v251, v250
  s_waitcnt lgkmcnt(0)
  v_cmp_gt_u32 vcc, v252, v251
  s_cmp_eq_u32 s68, 0
  s_cbranch_scc1 L_BACK13
  s_sub_u32 s68, s68, 1
  s_nop 2
  s_cbranch_vccnz L_SPIN13
  s_branch L_BACK13
L_SPIN14:
  ds_read_b32 v251, v250
  s_waitcnt lgkmcnt(0)
  v_cmp_gt_u32 vcc, v252, v251
  s_cmp_eq_u32 s68, 0
  s_cbranch_scc1 L_BACK14
  s_sub_u32 s68, s68, 1
  s_nop 2
  s_cbranch_vccnz L_SPIN14
  s_branch L_BACK14
L_SPIN15:
  ds_read_b32 v251, v250
  s_waitcnt lgkmcnt(0)
  v_cmp_gt_u32 vcc, v252, v251
  s_cmp_eq_u32 s68, 0
  s_cbranch_scc1 L_BACK15
  s_sub_u32 s68, s68, 1
  s_nop 2
  s_cbranch_vccnz L_SPIN15
  s_branch L_BACK15
L_SPIN16:
  ds_read_b32 v251, v250
  s_waitcnt lgkmcnt(0)
  v_cmp_gt_u32 vcc, v252, v251
  s_cmp_eq_u32 s68, 0
  s_cbranch_scc1 L_BACK16
  s_sub_u32 s68, s68, 1
  s_nop 2
  s_cbranch_vccnz L_SPIN16
  s_branch L_BACK16
L_SPIN17:
  ds_read_b32 v251, v250
  s_waitcnt lgkmcnt(0)
  v_cmp_gt_u32 vcc, v252, v251
  s_cmp_eq_u32 s68, 0
  s_cbranch_scc1 L_BACK17
  s_sub_u32 s68, s68, 1
  s_nop 2
  s_cbranch_vccnz L_SPIN17
  s_branch L_BACK17
L_SPIN18:
  ds_read_b32 v251, v250
  s_waitcnt lgkmcnt(0)
  v_cmp_gt_u32 vcc, v252, v251
  s_cmp_eq_u32 s68, 0
  s_cbranch_scc1 L_BACK18
  s_sub_u32 s68, s68, 1
  s_nop 2
  s_cbranch_vccnz L_SPIN18
  s_branch L_BACK18
L_SPIN19:
  ds_read_b32 v251, v250
  s_waitcnt lgkmcnt(0)
  v_cmp_gt_u32 vcc, v252, v251
  s_cmp_eq_u32 s68, 0
  s_cbranch_scc1 L_BACK19
  s_sub_u32 s68, s68, 1
  s_nop 2
  s_cbranch_vccnz L_SPIN19
  s_branch L_BACK19
L_SPIN999:
  ds_read_b32 v251, v250
  s_waitcnt lgkmcnt(0)
  v_cmp_gt_u32 vcc, v252, v251
  s_cmp_eq_u32 s68, 0
  s_cbranch_scc1 L_BACK999
  s_sub_u32 s68, s68, 1
  s_nop 2
  s_cbranch_vccnz L_SPIN999
  s_branch L_BACK999

.section .rodata,"a"
.p2align 6
.amdhsa_kernel standalone__mha_softmax__near_ridge_kernel
  .amdhsa_next_free_vgpr 512
  .amdhsa_next_free_sgpr 102
  .amdhsa_accum_offset 256
  .amdhsa_group_segment_fixed_size 0
  .amdhsa_kernarg_size 48
  .amdhsa_user_sgpr_count 2
  .amdhsa_user_sgpr_kernarg_segment_ptr 1
  .amdhsa_system_sgpr_workgroup_id_x 1
.end_amdhsa_kernel
```
